```python
import torch

def _softmax(x, axis=-1):
    return torch.softmax(x, dim=axis)

def _gelu(x):
    return torch.nn.functional.gelu(x, approximate='tanh')

def _silu(x):
    return torch.nn.functional.silu(x)

def _sigmoid(x):
    return torch.sigmoid(x)

def _layernorm(x, axis=-1, eps=1e-05):
    m = x.mean(dim=axis, keepdim=True)
    v = x.var(dim=axis, keepdim=True, unbiased=False)
    return (x - m) / torch.sqrt(v + eps)

def _scatter_add(tgt, idx, src, axis=0):
    return tgt.clone().index_add_(axis, idx, src)

def _segment_sum(src, seg, n):
    out = torch.zeros((n,) + src.shape[1:], dtype=src.dtype)
    return out.index_add_(0, seg, src)

def _pad(x, pw):
    flat = tuple((v for pair in reversed(pw) for v in pair))
    return torch.nn.functional.pad(x, flat)
kernel_name = 'recurrent_scan__memory_aug_recurrent_mem_tr__glu_gated_bilinear__prompt'

def setup_inputs():

    _w = lambda a: (lambda t: t.to(torch.bfloat16) if t.is_floating_point() else t)(torch.as_tensor(a))

    def _A_setup():
        B, S, Dm = (1, 2048, 640)
        H, Dh = (32, 192)
        M, seg = (8, 32)
        seg = min(seg, S)
        S = S // seg * seg
        return {'x': _w((lambda *s: torch.randn(*s, dtype=torch.bfloat16) * 0.1)(B, S, Dm)), 'mem0': _w((lambda *s: torch.randn(*s, dtype=torch.bfloat16) * 1.6)(B, M, Dm)), 'Wq': _w((lambda *s: torch.randn(*s, dtype=torch.bfloat16) * 0.8)(Dm, H, Dh) * Dm ** (-0.5)), 'Wk': _w((lambda *s: torch.randn(*s, dtype=torch.bfloat16) * 0.8)(Dm, H, Dh) * Dm ** (-0.5)), 'Wv': _w((lambda *s: torch.randn(*s, dtype=torch.bfloat16) * 1.6)(Dm, H, Dh) * Dm ** (-0.5)), 'Wo': _w((lambda *s: torch.randn(*s, dtype=torch.bfloat16) * 1.6)(H, Dh, Dm) * (H * Dh) ** (-0.5)), 'seg_len': seg}
    _A_in = _A_setup()

    def _B_setup():
        B, S, D, F = (1, 2048, 640, 1536)
        return {'x': _w((lambda *s: torch.randn(*s, dtype=torch.bfloat16) * 0.1)(B, S, D)), 'w_gate': _w((lambda *s: torch.randn(*s, dtype=torch.bfloat16) * 0.4)(D, F) * D ** (-0.5)), 'w_up': _w((lambda *s: torch.randn(*s, dtype=torch.bfloat16) * 0.4)(D, F) * D ** (-0.5)), 'w_down': _w((lambda *s: torch.randn(*s, dtype=torch.bfloat16) * 0.4)(F, D) * F ** (-0.5))}
    _B_in = _B_setup()
    return {'A_x': _A_in['x'], 'A_mem0': _A_in['mem0'], 'A_Wq': _A_in['Wq'], 'A_Wk': _A_in['Wk'], 'A_Wv': _A_in['Wv'], 'A_Wo': _A_in['Wo'], 'A_seg_len': _A_in['seg_len'], 'B_x': _B_in['x'], 'B_w_gate': _B_in['w_gate'], 'B_w_up': _B_in['w_up'], 'B_w_down': _B_in['w_down']}

def reference(A_x, A_mem0, A_Wq, A_Wk, A_Wv, A_Wo, A_seg_len, B_x, B_w_gate, B_w_up, B_w_down):

    def _A_ref(x, mem0, Wq, Wk, Wv, Wo, seg_len):
        B, S, Dm = x.shape
        H, Dh = (Wq.shape[1], Wq.shape[2])
        M = mem0.shape[1]
        scale = Dh ** (-0.5)
        n_seg = S // seg_len
        L = M + seg_len
        idx = torch.arange(L)
        mask = (idx[:, None] < M) | (idx[:, None] >= idx[None, :])
        mem = mem0
        outs = []
        for s in range(n_seg):
            xs = x[:, s * seg_len:(s + 1) * seg_len, :].clone()
            h = torch.concatenate([mem, xs], axis=1)
            q = torch.einsum('btd,dhe->bhte', h, Wq)
            k = torch.einsum('btd,dhe->bhte', h, Wk)
            v = torch.einsum('btd,dhe->bhte', h, Wv)
            scores = torch.einsum('bhqe,bhke->bhqk', q, k) * scale
            scores = torch.where(mask[None, None], scores, -1000000000.0)
            p = _softmax(scores, axis=-1)
            o = torch.einsum('bhqk,bhke->bhqe', p, v)
            o = torch.einsum('bhte,hed->btd', o, Wo)
            mem = o[:, :M, :].clone()
            outs.append(o[:, M:, :])
        return torch.concatenate(outs, axis=1)

    def _B_ref(x, w_gate, w_up, w_down):
        g = torch.einsum('bsd,df->bsf', x, w_gate)
        u = torch.einsum('bsd,df->bsf', x, w_up)
        h = g * u
        return torch.einsum('bsf,fd->bsd', h, w_down)
    x = A_x
    xn = _layernorm(x, axis=-1)
    s = _A_ref(xn, A_mem0, A_Wq, A_Wk, A_Wv, A_Wo, A_seg_len)
    g = _silu(_B_ref(xn, B_w_gate, B_w_up, B_w_down))
    return x + s * g
```

```asm
; @launch grid=(256,1,1) block=(512,1,1) lds=163840
.amdgcn_target "amdgcn-amd-amdhsa--gfx950"
.text
.globl recurrent_scan__memory_aug_recurrent_mem_tr__glu_gated_bilinear__prompt_kernel
.p2align 8
.type recurrent_scan__memory_aug_recurrent_mem_tr__glu_gated_bilinear__prompt_kernel,@function
recurrent_scan__memory_aug_recurrent_mem_tr__glu_gated_bilinear__prompt_kernel:
    s_cmp_ge_u32 s2, 256
    s_cbranch_scc1 L_exit
    s_load_dwordx16 s[16:31], s[0:1], 0
    s_load_dwordx8 s[32:39], s[0:1], 64
    s_load_dwordx4 s[40:43], s[0:1], 96
    v_lshrrev_b32 v2, 6, v0
    v_and_b32 v1, 63, v0
    v_readfirstlane_b32 s3, v2
    s_mov_b32 s14, s2
    s_mov_b32 s10, 0
    s_waitcnt lgkmcnt(0)
    s_mov_b32 s44, s42
    s_and_b32 s45, s43, 0xffff
    s_mov_b32 s46, 0x10000000
    s_mov_b32 s47, 0x00020000
    s_mov_b32 s56, s40
    s_and_b32 s57, s41, 0xffff
    s_mov_b32 s58, 0x100
    s_mov_b32 s59, 0x00020000
L_restart:
    s_lshl_b32 s60, s3, 6
    v_add_u32 v0, s60, v1
    s_getreg_b32 s60, hwreg(HW_REG_XCC_ID)
    s_cmp_eq_u32 s10, 0
    s_cselect_b32 s60, s60, s14
    s_and_b32 s60, s60, 7
    s_lshr_b32 s61, s14, 3
    s_and_b32 s62, s60, 3
    s_lshl_b32 s62, s62, 1
    s_bfe_u32 s63, s61, 0x10002
    s_and_b32 s64, s61, 3
    s_lshr_b32 s65, s61, 3
    s_cmp_lt_u32 s60, 4
    s_cbranch_scc0 L_rm_bulk
    s_cmp_lt_u32 s61, 24
    s_cbranch_scc0 L_rm_q
    s_cmp_ge_u32 s61, 12
    s_cselect_b32 s63, 1, 0
    s_mul_i32 s64, s63, 12
    s_sub_u32 s5, s61, s64
    s_branch L_rm_done
L_rm_q:
    s_add_u32 s5, s64, 28
    s_branch L_rm_done
L_rm_bulk:
    s_lshl_b32 s66, s65, 2
    s_add_u32 s66, s66, 12
    s_add_u32 s5, s66, s64
L_rm_done:
    s_add_u32 s4, s62, s63
    s_lshl_b32 s2, s5, 3
    s_add_u32 s2, s2, s4
    s_mov_b32 s6, 1
    s_lshl_b32 s8, s4, 8
    s_lshl_b32 s63, s5, 2
    s_add_u32 s8, s8, s63
    s_add_u32 s8, s8, 156762112
    s_lshl_b32 s63, s2, 7
    s_add_u32 s63, s63, 156794880
    s_cmp_lt_u32 s5, 12
    s_cselect_b32 s8, s8, s63
    s_lshl_b32 s63, s4, 7
    s_lshl_b32 s64, s5, 2
    s_add_u32 s63, s63, s64
    s_add_u32 s63, s63, 156766128
    s_lshr_b32 s64, s5, 2
    s_cmp_eq_u32 s64, 5
    s_cselect_b32 s8, s63, s8
    s_cmp_eq_u32 s3, 0
    s_cbranch_scc0 fi_1
    v_mov_b32 v2, 0
    buffer_store_dword v2, v2, s[44:47], s8 offen sc1
fi_1:
    s_mov_b32 s7, 0
    s_cmp_lt_u32 s5, 12
    s_cbranch_scc1 L_chain
    s_cmp_lt_u32 s5, 16
    s_cbranch_scc1 L_k
    s_cmp_lt_u32 s5, 20
    s_cbranch_scc1 L_v
    s_cmp_lt_u32 s5, 24
    s_cbranch_scc1 L_q
    s_cmp_lt_u32 s5, 28
    s_cbranch_scc1 L_o
    s_lshr_b32 s9, s4, 1
    s_and_b32 s15, s4, 1
    s_lshl_b32 s15, s15, 2
    s_add_u32 s15, s15, s5
    s_sub_u32 s15, s15, 28
    s_cmp_lt_u32 s15, 3
    s_cbranch_scc1 L_r
    s_cmp_lt_u32 s15, 5
    s_cbranch_scc1 L_p
    s_mul_i32 s60, s9, 3
    s_add_u32 s60, s60, s15
    s_sub_u32 s60, s60, 5
    s_lshl_b32 s8, s60, 7
    s_add_u32 s8, s8, 156844032
    s_cmp_eq_u32 s3, 0
    s_cbranch_scc0 fi_2
    v_mov_b32 v2, 0
    buffer_store_dword v2, v2, s[44:47], s8 offen sc1
fi_2:
    s_cmp_lt_u32 s60, 10
    s_cbranch_scc0 ep_3
    s_lshl_b32 s63, s60, 3
    s_add_u32 s63, s63, s3
    s_lshl_b32 s63, s63, 9
    s_add_u32 s63, s63, 113606656
    v_lshlrev_b32 v24, 3, v1
    v_mov_b32 v26, -1
    v_mov_b32 v27, -1
    buffer_store_dwordx2 v[26:27], v24, s[44:47], s63 offen sc1
    s_add_u32 s63, s63, 40960
    buffer_store_dwordx2 v[26:27], v24, s[44:47], s63 offen sc1
    s_add_u32 s63, s63, 40960
    buffer_store_dwordx2 v[26:27], v24, s[44:47], s63 offen sc1
    s_add_u32 s63, s63, 40960
    buffer_store_dwordx2 v[26:27], v24, s[44:47], s63 offen sc1
    s_add_u32 s63, s63, 2498560
    buffer_store_dwordx2 v[26:27], v24, s[44:47], s63 offen sc1
    s_add_u32 s63, s63, 40960
    buffer_store_dwordx2 v[26:27], v24, s[44:47], s63 offen sc1
    s_add_u32 s63, s63, 40960
    buffer_store_dwordx2 v[26:27], v24, s[44:47], s63 offen sc1
    s_add_u32 s63, s63, 40960
    buffer_store_dwordx2 v[26:27], v24, s[44:47], s63 offen sc1
    s_add_u32 s63, s63, 2498560
    buffer_store_dwordx2 v[26:27], v24, s[44:47], s63 offen sc1
    s_add_u32 s63, s63, 40960
    buffer_store_dwordx2 v[26:27], v24, s[44:47], s63 offen sc1
    s_add_u32 s63, s63, 40960
    buffer_store_dwordx2 v[26:27], v24, s[44:47], s63 offen sc1
    s_add_u32 s63, s63, 40960
    buffer_store_dwordx2 v[26:27], v24, s[44:47], s63 offen sc1
    s_add_u32 s63, s63, 2498560
    buffer_store_dwordx2 v[26:27], v24, s[44:47], s63 offen sc1
    s_add_u32 s63, s63, 40960
    buffer_store_dwordx2 v[26:27], v24, s[44:47], s63 offen sc1
    s_add_u32 s63, s63, 40960
    buffer_store_dwordx2 v[26:27], v24, s[44:47], s63 offen sc1
    s_add_u32 s63, s63, 40960
    buffer_store_dwordx2 v[26:27], v24, s[44:47], s63 offen sc1
    s_add_u32 s63, s63, 2498560
    buffer_store_dwordx2 v[26:27], v24, s[44:47], s63 offen sc1
    s_add_u32 s63, s63, 40960
    buffer_store_dwordx2 v[26:27], v24, s[44:47], s63 offen sc1
    s_add_u32 s63, s63, 40960
    buffer_store_dwordx2 v[26:27], v24, s[44:47], s63 offen sc1
    s_add_u32 s63, s63, 40960
    buffer_store_dwordx2 v[26:27], v24, s[44:47], s63 offen sc1
    s_add_u32 s63, s63, 2498560
    buffer_store_dwordx2 v[26:27], v24, s[44:47], s63 offen sc1
    s_add_u32 s63, s63, 40960
    buffer_store_dwordx2 v[26:27], v24, s[44:47], s63 offen sc1
    s_add_u32 s63, s63, 40960
    buffer_store_dwordx2 v[26:27], v24, s[44:47], s63 offen sc1
    s_add_u32 s63, s63, 40960
    buffer_store_dwordx2 v[26:27], v24, s[44:47], s63 offen sc1
    s_add_u32 s63, s63, 2498560
    buffer_store_dwordx2 v[26:27], v24, s[44:47], s63 offen sc1
    s_add_u32 s63, s63, 40960
    buffer_store_dwordx2 v[26:27], v24, s[44:47], s63 offen sc1
    s_add_u32 s63, s63, 40960
    buffer_store_dwordx2 v[26:27], v24, s[44:47], s63 offen sc1
    s_add_u32 s63, s63, 40960
    buffer_store_dwordx2 v[26:27], v24, s[44:47], s63 offen sc1
    s_add_u32 s63, s63, 2498560
    buffer_store_dwordx2 v[26:27], v24, s[44:47], s63 offen sc1
    s_add_u32 s63, s63, 40960
    buffer_store_dwordx2 v[26:27], v24, s[44:47], s63 offen sc1
    s_add_u32 s63, s63, 40960
    buffer_store_dwordx2 v[26:27], v24, s[44:47], s63 offen sc1
    s_add_u32 s63, s63, 40960
    buffer_store_dwordx2 v[26:27], v24, s[44:47], s63 offen sc1
    s_add_u32 s63, s63, 2498560
ep_3:
    s_cmp_eq_u32 s15, 7
    s_cbranch_scc0 ei_4
    s_mov_b32 s52, s18
    s_and_b32 s53, s19, 0xffff
    s_mov_b32 s54, 0x2800
    s_mov_b32 s55, 0x00020000
    s_lshl_b32 s63, s9, 17
    s_add_u32 s63, s63, 156237824
    v_add_u32 v2, 0, v0
    v_bfe_u32 v3, v2, 1, 3
    v_mul_u32_u24 v3, 1280, v3
    v_lshrrev_b32 v4, 4, v2
    v_lshlrev_b32 v4, 5, v4
    v_add_u32 v3, v3, v4
    v_and_b32 v4, 1, v2
    v_lshlrev_b32 v4, 4, v4
    v_add_u32 v3, v3, v4
    v_lshlrev_b32 v5, 4, v2
    v_mov_b32 v4, 1073741824
    v_cmp_gt_u32 vcc, 640, v2
    s_nop 1
    v_cndmask_b32 v3, v4, v3, vcc
    v_cndmask_b32 v5, v4, v5, vcc
    buffer_load_dwordx4 v[16:19], v3, s[52:55], 0 offen
    v_add_u32 v2, 512, v0
    v_bfe_u32 v3, v2, 1, 3
    v_mul_u32_u24 v3, 1280, v3
    v_lshrrev_b32 v4, 4, v2
    v_lshlrev_b32 v4, 5, v4
    v_add_u32 v3, v3, v4
    v_and_b32 v4, 1, v2
    v_lshlrev_b32 v4, 4, v4
    v_add_u32 v3, v3, v4
    v_lshlrev_b32 v6, 4, v2
    v_mov_b32 v4, 1073741824
    v_cmp_gt_u32 vcc, 640, v2
    s_nop 1
    v_cndmask_b32 v3, v4, v3, vcc
    v_cndmask_b32 v6, v4, v6, vcc
    buffer_load_dwordx4 v[20:23], v3, s[52:55], 0 offen
    s_waitcnt vmcnt(0)
    v_min_u32 v16, -2, v16
    v_min_u32 v17, -2, v17
    v_min_u32 v18, -2, v18
    v_min_u32 v19, -2, v19
    v_min_u32 v20, -2, v20
    v_min_u32 v21, -2, v21
    v_min_u32 v22, -2, v22
    v_min_u32 v23, -2, v23
    buffer_store_dwordx4 v[16:19], v5, s[44:47], s63 offen sc1
    buffer_store_dwordx4 v[20:23], v6, s[44:47], s63 offen sc1
ei_4:
    s_waitcnt vmcnt(0)
    s_barrier
    s_cmp_eq_u32 s3, 0
    s_cbranch_scc0 arr_5
    s_getreg_b32 s12, hwreg(HW_REG_XCC_ID)
    s_and_b32 s12, s12, 15
    s_cmp_gt_u32 s12, 7
    s_cselect_b32 s13, s14, 0
    s_lshr_b32 s13, s13, 3
    s_add_u32 s12, s12, s13
    s_sub_u32 s12, s12, s14
    s_and_b32 s12, s12, 7
    s_mul_i32 s13, s12, s12
    s_lshl_b32 s12, s12, 9
    s_or_b32 s12, s12, 1
    v_mov_b32 v12, s12
    v_mov_b32 v13, s13
    v_mov_b32 v14, 1073741824
    v_cmp_eq_u32 vcc, 0, v1
    s_nop 1
    v_cndmask_b32 v14, v14, v1, vcc
    buffer_atomic_add_x2 v[12:13], v14, s[56:59], s10 offen sc1
arr_5:
    s_cmp_eq_u32 s2, 247
    s_cbranch_scc0 ei_6
    s_cmp_eq_u32 s3, 0
    s_cbranch_scc0 ei_6
    v_mov_b32 v2, 0
    s_mov_b32 s63, 153747456
    v_and_b32 v3, 7, v1
    v_lshlrev_b32 v3, 7, v3
    v_bfe_u32 v4, v1, 3, 1
    v_lshlrev_b32 v4, 13, v4
    v_add_u32 v3, v3, v4
    s_mov_b32 s70, -1
    s_mov_b32 s71, -1
    s_add_u32 s64, s63, 8192
    buffer_store_dword v2, v3, s[44:47], s63 offen sc1
    s_waitcnt vmcnt(0)
    s_memtime s[88:89]
    s_waitcnt lgkmcnt(0)
    buffer_load_dword v5, v2, s[44:47], s63 offen offset:0 sc1
    s_waitcnt vmcnt(0)
    s_memtime s[90:91]
    s_waitcnt lgkmcnt(0)
    s_sub_u32 s90, s90, s88
    s_min_u32 s70, s70, s90
    s_memtime s[88:89]
    s_waitcnt lgkmcnt(0)
    buffer_load_dword v5, v2, s[44:47], s64 offen offset:0 sc1
    s_waitcnt vmcnt(0)
    s_memtime s[90:91]
    s_waitcnt lgkmcnt(0)
    s_sub_u32 s90, s90, s88
    s_min_u32 s71, s71, s90
    s_memtime s[88:89]
    s_waitcnt lgkmcnt(0)
    buffer_load_dword v5, v2, s[44:47], s63 offen offset:128 sc1
    s_waitcnt vmcnt(0)
    s_memtime s[90:91]
    s_waitcnt lgkmcnt(0)
    s_sub_u32 s90, s90, s88
    s_min_u32 s70, s70, s90
    s_memtime s[88:89]
    s_waitcnt lgkmcnt(0)
    buffer_load_dword v5, v2, s[44:47], s64 offen offset:128 sc1
    s_waitcnt vmcnt(0)
    s_memtime s[90:91]
    s_waitcnt lgkmcnt(0)
    s_sub_u32 s90, s90, s88
    s_min_u32 s71, s71, s90
    s_memtime s[88:89]
    s_waitcnt lgkmcnt(0)
    buffer_load_dword v5, v2, s[44:47], s63 offen offset:256 sc1
    s_waitcnt vmcnt(0)
    s_memtime s[90:91]
    s_waitcnt lgkmcnt(0)
    s_sub_u32 s90, s90, s88
    s_min_u32 s70, s70, s90
    s_memtime s[88:89]
    s_waitcnt lgkmcnt(0)
    buffer_load_dword v5, v2, s[44:47], s64 offen offset:256 sc1
    s_waitcnt vmcnt(0)
    s_memtime s[90:91]
    s_waitcnt lgkmcnt(0)
    s_sub_u32 s90, s90, s88
    s_min_u32 s71, s71, s90
    s_memtime s[88:89]
    s_waitcnt lgkmcnt(0)
    buffer_load_dword v5, v2, s[44:47], s63 offen offset:384 sc1
    s_waitcnt vmcnt(0)
    s_memtime s[90:91]
    s_waitcnt lgkmcnt(0)
    s_sub_u32 s90, s90, s88
    s_min_u32 s70, s70, s90
    s_memtime s[88:89]
    s_waitcnt lgkmcnt(0)
    buffer_load_dword v5, v2, s[44:47], s64 offen offset:384 sc1
    s_waitcnt vmcnt(0)
    s_memtime s[90:91]
    s_waitcnt lgkmcnt(0)
    s_sub_u32 s90, s90, s88
    s_min_u32 s71, s71, s90
    s_cmp_gt_u32 s70, s71
    s_cselect_b32 s64, 2, 1
    v_mov_b32 v3, s64
    buffer_store_dword v3, v2, s[56:59], s10 offen offset:132 sc1
ei_6:
    s_cmp_eq_u32 s2, 247
    s_cbranch_scc1 nsp_7
    s_cmp_eq_u32 s14, 255
    s_cbranch_scc1 nsp_7
nsp_7:
    s_cmp_eq_u32 s14, 255
    s_cbranch_scc0 mso_13
    s_cmp_eq_u32 s3, 0
    s_cbranch_scc0 mso_13
    v_mov_b32 v2, 0
    buffer_load_dword v4, v2, s[56:59], s10 offen offset:128 sc1
    s_waitcnt vmcnt(0)
    v_readfirstlane_b32 s63, v4
    s_cmp_lg_u32 s63, 0
    s_cbranch_scc1 mso_13
    s_mov_b32 s76, 1000000
ms_11:
    buffer_load_dwordx2 v[4:5], v2, s[56:59], s10 offen sc1
    s_sub_u32 s76, s76, 1
    s_cbranch_scc1 msd_12
    s_waitcnt vmcnt(0)
    v_readfirstlane_b32 s63, v4
    v_readfirstlane_b32 s64, v5
    s_and_b32 s65, s63, 511
    s_cmp_eq_u32 s65, 256
    s_cbranch_scc1 msd_12
    s_sleep 4
    s_branch ms_11
msd_12:
    s_lshr_b32 s63, s63, 9
    s_mul_i32 s63, s63, s63
    s_lshl_b32 s64, s64, 8
    s_cmp_eq_u32 s63, s64
    s_cselect_b32 s63, 1, 2
    v_mov_b32 v4, s63
    buffer_store_dword v4, v2, s[56:59], s10 offen offset:128 sc1
mso_13:
    v_mov_b32 v8, 0
    s_cmp_eq_u32 s3, 0
    s_cbranch_scc0 wao_10
    s_mov_b32 s76, 1000000
wa_8:
    buffer_load_dword v9, v8, s[56:59], s10 offen offset:128 sc1
    s_sub_u32 s76, s76, 1
    s_cbranch_scc1 wad_9
    s_waitcnt vmcnt(0)
    v_readfirstlane_b32 s63, v9
    s_cmp_lg_u32 s63, 0
    s_cbranch_scc1 wad_9
    s_sleep 16
    s_branch wa_8
wad_9:
    s_waitcnt vmcnt(0)
    ds_write_b32 v8, v9
    s_waitcnt lgkmcnt(0)
wao_10:
    s_barrier
    ds_read_b32 v9, v8
    s_waitcnt lgkmcnt(0)
    v_readfirstlane_b32 s63, v9
    s_cmp_lg_u32 s63, 1
    s_cselect_b32 s6, 1, 0
    s_waitcnt vmcnt(0)
    s_barrier
    s_cbranch_scc0 wak_14
    s_cmp_eq_u32 s10, 0
    s_mov_b32 s10, 16
    s_cbranch_scc1 L_restart
wak_14:
    s_cmp_eq_u32 s2, 247
    s_cbranch_scc0 ei_15
    s_cmp_eq_u32 s3, 0
    s_cbranch_scc0 ei_15
    v_mov_b32 v2, 0
    s_mov_b32 s75, 1
    v_mov_b32 v4, 156763648
    s_mov_b32 s77, 0
    s_cmp_ge_u32 s77, s75
    s_cbranch_scc1 fwd_17
    s_mov_b32 s76, 4000000
fw_16:
    buffer_load_dword v3, v4, s[44:47], 0 offen sc1
    s_sub_u32 s76, s76, 1
    s_cbranch_scc1 fwd_17
    s_waitcnt vmcnt(0)
    v_cmp_gt_u32 vcc, s75, v3
    s_cbranch_vccz fwo_18
    s_sleep 8
    s_branch fw_16
fwo_18:
    s_mov_b32 s77, s75
fwd_17:
    s_mov_b32 s63, 153748480
    v_and_b32 v3, 7, v1
    v_lshlrev_b32 v3, 7, v3
    v_bfe_u32 v4, v1, 3, 1
    v_lshlrev_b32 v4, 13, v4
    v_add_u32 v3, v3, v4
    s_mov_b32 s70, -1
    s_mov_b32 s71, -1
    s_add_u32 s64, s63, 8192
    buffer_store_dword v2, v3, s[44:47], s63 offen sc1
    s_waitcnt vmcnt(0)
    s_memtime s[88:89]
    s_waitcnt lgkmcnt(0)
    buffer_load_dword v5, v2, s[44:47], s63 offen offset:0 sc1
    s_waitcnt vmcnt(0)
    s_memtime s[90:91]
    s_waitcnt lgkmcnt(0)
    s_sub_u32 s90, s90, s88
    s_min_u32 s70, s70, s90
    s_memtime s[88:89]
    s_waitcnt lgkmcnt(0)
    buffer_load_dword v5, v2, s[44:47], s64 offen offset:0 sc1
    s_waitcnt vmcnt(0)
    s_memtime s[90:91]
    s_waitcnt lgkmcnt(0)
    s_sub_u32 s90, s90, s88
    s_min_u32 s71, s71, s90
    s_memtime s[88:89]
    s_waitcnt lgkmcnt(0)
    buffer_load_dword v5, v2, s[44:47], s63 offen offset:128 sc1
    s_waitcnt vmcnt(0)
    s_memtime s[90:91]
    s_waitcnt lgkmcnt(0)
    s_sub_u32 s90, s90, s88
    s_min_u32 s70, s70, s90
    s_memtime s[88:89]
    s_waitcnt lgkmcnt(0)
    buffer_load_dword v5, v2, s[44:47], s64 offen offset:128 sc1
    s_waitcnt vmcnt(0)
    s_memtime s[90:91]
    s_waitcnt lgkmcnt(0)
    s_sub_u32 s90, s90, s88
    s_min_u32 s71, s71, s90
    s_memtime s[88:89]
    s_waitcnt lgkmcnt(0)
    buffer_load_dword v5, v2, s[44:47], s63 offen offset:256 sc1
    s_waitcnt vmcnt(0)
    s_memtime s[90:91]
    s_waitcnt lgkmcnt(0)
    s_sub_u32 s90, s90, s88
    s_min_u32 s70, s70, s90
    s_memtime s[88:89]
    s_waitcnt lgkmcnt(0)
    buffer_load_dword v5, v2, s[44:47], s64 offen offset:256 sc1
    s_waitcnt vmcnt(0)
    s_memtime s[90:91]
    s_waitcnt lgkmcnt(0)
    s_sub_u32 s90, s90, s88
    s_min_u32 s71, s71, s90
    s_memtime s[88:89]
    s_waitcnt lgkmcnt(0)
    buffer_load_dword v5, v2, s[44:47], s63 offen offset:384 sc1
    s_waitcnt vmcnt(0)
    s_memtime s[90:91]
    s_waitcnt lgkmcnt(0)
    s_sub_u32 s90, s90, s88
    s_min_u32 s70, s70, s90
    s_memtime s[88:89]
    s_waitcnt lgkmcnt(0)
    buffer_load_dword v5, v2, s[44:47], s64 offen offset:384 sc1
    s_waitcnt vmcnt(0)
    s_memtime s[90:91]
    s_waitcnt lgkmcnt(0)
    s_sub_u32 s90, s90, s88
    s_min_u32 s71, s71, s90
    s_memtime s[88:89]
    s_waitcnt lgkmcnt(0)
    buffer_load_dword v5, v2, s[44:47], s63 offen offset:512 sc1
    s_waitcnt vmcnt(0)
    s_memtime s[90:91]
    s_waitcnt lgkmcnt(0)
    s_sub_u32 s90, s90, s88
    s_min_u32 s70, s70, s90
    s_memtime s[88:89]
    s_waitcnt lgkmcnt(0)
    buffer_load_dword v5, v2, s[44:47], s64 offen offset:512 sc1
    s_waitcnt vmcnt(0)
    s_memtime s[90:91]
    s_waitcnt lgkmcnt(0)
    s_sub_u32 s90, s90, s88
    s_min_u32 s71, s71, s90
    s_memtime s[88:89]
    s_waitcnt lgkmcnt(0)
    buffer_load_dword v5, v2, s[44:47], s63 offen offset:640 sc1
    s_waitcnt vmcnt(0)
    s_memtime s[90:91]
    s_waitcnt lgkmcnt(0)
    s_sub_u32 s90, s90, s88
    s_min_u32 s70, s70, s90
    s_memtime s[88:89]
    s_waitcnt lgkmcnt(0)
    buffer_load_dword v5, v2, s[44:47], s64 offen offset:640 sc1
    s_waitcnt vmcnt(0)
    s_memtime s[90:91]
    s_waitcnt lgkmcnt(0)
    s_sub_u32 s90, s90, s88
    s_min_u32 s71, s71, s90
    s_memtime s[88:89]
    s_waitcnt lgkmcnt(0)
    buffer_load_dword v5, v2, s[44:47], s63 offen offset:768 sc1
    s_waitcnt vmcnt(0)
    s_memtime s[90:91]
    s_waitcnt lgkmcnt(0)
    s_sub_u32 s90, s90, s88
    s_min_u32 s70, s70, s90
    s_memtime s[88:89]
    s_waitcnt lgkmcnt(0)
    buffer_load_dword v5, v2, s[44:47], s64 offen offset:768 sc1
    s_waitcnt vmcnt(0)
    s_memtime s[90:91]
    s_waitcnt lgkmcnt(0)
    s_sub_u32 s90, s90, s88
    s_min_u32 s71, s71, s90
    s_memtime s[88:89]
    s_waitcnt lgkmcnt(0)
    buffer_load_dword v5, v2, s[44:47], s63 offen offset:896 sc1
    s_waitcnt vmcnt(0)
    s_memtime s[90:91]
    s_waitcnt lgkmcnt(0)
    s_sub_u32 s90, s90, s88
    s_min_u32 s70, s70, s90
    s_memtime s[88:89]
    s_waitcnt lgkmcnt(0)
    buffer_load_dword v5, v2, s[44:47], s64 offen offset:896 sc1
    s_waitcnt vmcnt(0)
    s_memtime s[90:91]
    s_waitcnt lgkmcnt(0)
    s_sub_u32 s90, s90, s88
    s_min_u32 s71, s71, s90
    buffer_store_dword v2, v3, s[44:47], s63 offen sc1
    s_waitcnt vmcnt(0)
    s_memtime s[88:89]
    s_waitcnt lgkmcnt(0)
    buffer_load_dword v5, v2, s[44:47], s63 offen offset:0 sc1
    s_waitcnt vmcnt(0)
    s_memtime s[90:91]
    s_waitcnt lgkmcnt(0)
    s_sub_u32 s90, s90, s88
    s_min_u32 s70, s70, s90
    s_memtime s[88:89]
    s_waitcnt lgkmcnt(0)
    buffer_load_dword v5, v2, s[44:47], s64 offen offset:0 sc1
    s_waitcnt vmcnt(0)
    s_memtime s[90:91]
    s_waitcnt lgkmcnt(0)
    s_sub_u32 s90, s90, s88
    s_min_u32 s71, s71, s90
    s_memtime s[88:89]
    s_waitcnt lgkmcnt(0)
    buffer_load_dword v5, v2, s[44:47], s63 offen offset:128 sc1
    s_waitcnt vmcnt(0)
    s_memtime s[90:91]
    s_waitcnt lgkmcnt(0)
    s_sub_u32 s90, s90, s88
    s_min_u32 s70, s70, s90
    s_memtime s[88:89]
    s_waitcnt lgkmcnt(0)
    buffer_load_dword v5, v2, s[44:47], s64 offen offset:128 sc1
    s_waitcnt vmcnt(0)
    s_memtime s[90:91]
    s_waitcnt lgkmcnt(0)
    s_sub_u32 s90, s90, s88
    s_min_u32 s71, s71, s90
    s_memtime s[88:89]
    s_waitcnt lgkmcnt(0)
    buffer_load_dword v5, v2, s[44:47], s63 offen offset:256 sc1
    s_waitcnt vmcnt(0)
    s_memtime s[90:91]
    s_waitcnt lgkmcnt(0)
    s_sub_u32 s90, s90, s88
    s_min_u32 s70, s70, s90
    s_memtime s[88:89]
    s_waitcnt lgkmcnt(0)
    buffer_load_dword v5, v2, s[44:47], s64 offen offset:256 sc1
    s_waitcnt vmcnt(0)
    s_memtime s[90:91]
    s_waitcnt lgkmcnt(0)
    s_sub_u32 s90, s90, s88
    s_min_u32 s71, s71, s90
    s_memtime s[88:89]
    s_waitcnt lgkmcnt(0)
    buffer_load_dword v5, v2, s[44:47], s63 offen offset:384 sc1
    s_waitcnt vmcnt(0)
    s_memtime s[90:91]
    s_waitcnt lgkmcnt(0)
    s_sub_u32 s90, s90, s88
    s_min_u32 s70, s70, s90
    s_memtime s[88:89]
    s_waitcnt lgkmcnt(0)
    buffer_load_dword v5, v2, s[44:47], s64 offen offset:384 sc1
    s_waitcnt vmcnt(0)
    s_memtime s[90:91]
    s_waitcnt lgkmcnt(0)
    s_sub_u32 s90, s90, s88
    s_min_u32 s71, s71, s90
    s_memtime s[88:89]
    s_waitcnt lgkmcnt(0)
    buffer_load_dword v5, v2, s[44:47], s63 offen offset:512 sc1
    s_waitcnt vmcnt(0)
    s_memtime s[90:91]
    s_waitcnt lgkmcnt(0)
    s_sub_u32 s90, s90, s88
    s_min_u32 s70, s70, s90
    s_memtime s[88:89]
    s_waitcnt lgkmcnt(0)
    buffer_load_dword v5, v2, s[44:47], s64 offen offset:512 sc1
    s_waitcnt vmcnt(0)
    s_memtime s[90:91]
    s_waitcnt lgkmcnt(0)
    s_sub_u32 s90, s90, s88
    s_min_u32 s71, s71, s90
    s_memtime s[88:89]
    s_waitcnt lgkmcnt(0)
    buffer_load_dword v5, v2, s[44:47], s63 offen offset:640 sc1
    s_waitcnt vmcnt(0)
    s_memtime s[90:91]
    s_waitcnt lgkmcnt(0)
    s_sub_u32 s90, s90, s88
    s_min_u32 s70, s70, s90
    s_memtime s[88:89]
    s_waitcnt lgkmcnt(0)
    buffer_load_dword v5, v2, s[44:47], s64 offen offset:640 sc1
    s_waitcnt vmcnt(0)
    s_memtime s[90:91]
    s_waitcnt lgkmcnt(0)
    s_sub_u32 s90, s90, s88
    s_min_u32 s71, s71, s90
    s_memtime s[88:89]
    s_waitcnt lgkmcnt(0)
    buffer_load_dword v5, v2, s[44:47], s63 offen offset:768 sc1
    s_waitcnt vmcnt(0)
    s_memtime s[90:91]
    s_waitcnt lgkmcnt(0)
    s_sub_u32 s90, s90, s88
    s_min_u32 s70, s70, s90
    s_memtime s[88:89]
    s_waitcnt lgkmcnt(0)
    buffer_load_dword v5, v2, s[44:47], s64 offen offset:768 sc1
    s_waitcnt vmcnt(0)
    s_memtime s[90:91]
    s_waitcnt lgkmcnt(0)
    s_sub_u32 s90, s90, s88
    s_min_u32 s71, s71, s90
    s_memtime s[88:89]
    s_waitcnt lgkmcnt(0)
    buffer_load_dword v5, v2, s[44:47], s63 offen offset:896 sc1
    s_waitcnt vmcnt(0)
    s_memtime s[90:91]
    s_waitcnt lgkmcnt(0)
    s_sub_u32 s90, s90, s88
    s_min_u32 s70, s70, s90
    s_memtime s[88:89]
    s_waitcnt lgkmcnt(0)
    buffer_load_dword v5, v2, s[44:47], s64 offen offset:896 sc1
    s_waitcnt vmcnt(0)
    s_memtime s[90:91]
    s_waitcnt lgkmcnt(0)
    s_sub_u32 s90, s90, s88
    s_min_u32 s71, s71, s90
    s_cmp_gt_u32 s70, s71
    s_cselect_b32 s64, 2, 1
    v_mov_b32 v3, s64
    buffer_store_dword v3, v2, s[56:59], s10 offen offset:136 sc1
ei_15:
    s_cmp_lt_u32 s60, 10
    s_cbranch_scc0 L_exit
    s_mov_b32 s52, s16
    s_and_b32 s53, s17, 0xffff
    s_mov_b32 s54, 0x280000
    s_mov_b32 s55, 0x00020000
    s_mov_b32 s48, s38
    s_and_b32 s49, s39, 0xffff
    s_mov_b32 s50, 0x280000
    s_mov_b32 s51, 0x00020000
    s_lshl_b32 s63, s60, 3
    s_add_u32 s63, s63, s3
    s_lshl_b32 s64, s63, 9
    v_lshlrev_b32 v9, 3, v1
    v_add_u32 v9, s64, v9
    s_cmp_ge_u32 s63, 40
    s_cselect_b32 s64, 19200, 0
    s_lshl_b32 s63, s63, 5
    s_add_u32 s63, s63, s64
    v_and_b32 v7, 15, v1
    v_mul_u32_u24 v7, 1280, v7
    v_lshrrev_b32 v10, 4, v1
    v_lshlrev_b32 v10, 3, v10
    v_add3_u32 v7, v7, v10, s63
    v_min_u32 v11, 31, v1
    v_lshlrev_b32 v11, 7, v11
    v_add_u32 v11, 156819456, v11
    v_min_u32 v10, 24, v1
    v_lshlrev_b32 v10, 7, v10
    v_add_u32 v10, 156832256, v10
    s_mov_b32 s77, 0
    s_mov_b32 s78, 0
    s_mov_b32 s73, 0
e_19:
    s_mul_i32 s74, s73, 40960
    s_cmp_lt_u32 s73, 42
    s_cbranch_scc1 e1_20
    s_cmp_gt_u32 s73, 60
    s_cbranch_scc1 eg_23
    s_sub_u32 s75, s73, 41
    s_cmp_eq_u32 s73, 60
    s_cselect_b32 s75, 22, s75
    s_cmp_eq_u32 s3, 0
    s_cbranch_scc0 w0_24
    s_cmp_ge_u32 s78, s75
    s_cbranch_scc1 fwd_26
    s_mov_b32 s76, 4000000
fw_25:
    buffer_load_dword v12, v10, s[44:47], 0 offen sc1
    s_sub_u32 s76, s76, 1
    s_cbranch_scc1 fwd_26
    s_waitcnt vmcnt(0)
    v_cmp_gt_u32 vcc, s75, v12
    s_cbranch_vccz fwo_27
    s_sleep 8
    s_branch fw_25
fwo_27:
    s_add_u32 s76, s75, 4
    v_cmp_gt_u32 vcc, s76, v12
    s_cmp_eq_u64 vcc, 0
    s_cselect_b32 s78, s76, s75
fwd_26:
w0_24:
    s_barrier
eg_23:
    s_add_u32 s70, s74, 104857600
    buffer_load_dwordx2 v[48:49], v7, s[52:55], s74 offen
    buffer_load_dwordx2 v[50:51], v9, s[44:47], s70 offen sc1
e1_20:
    s_add_u32 s75, s73, 1
    s_cmp_ge_u32 s73, 60
    s_cbranch_scc1 ep_28
    s_cmp_eq_u32 s3, 0
    s_cbranch_scc0 w0_30
    s_cmp_ge_u32 s77, s75
    s_cbranch_scc1 fwd_32
    s_mov_b32 s76, 4000000
fw_31:
    buffer_load_dword v12, v11, s[44:47], 0 offen sc1
    s_sub_u32 s76, s76, 1
    s_cbranch_scc1 fwd_32
    s_waitcnt vmcnt(0)
    v_cmp_gt_u32 vcc, s75, v12
    s_cbranch_vccz fwo_33
    s_sleep 3
    s_branch fw_31
fwo_33:
    s_mov_b32 s77, s75
fwd_32:
w0_30:
    s_barrier
    s_add_u32 s70, s74, 111149056
    buffer_load_dwordx2 v[16:17], v9, s[44:47], s70 offen sc1
    s_add_u32 s70, s70, 2621440
    buffer_load_dwordx2 v[18:19], v9, s[44:47], s70 offen sc1
    s_add_u32 s70, s70, 2621440
    buffer_load_dwordx2 v[20:21], v9, s[44:47], s70 offen sc1
    s_add_u32 s70, s70, 2621440
    buffer_load_dwordx2 v[22:23], v9, s[44:47], s70 offen sc1
    s_add_u32 s70, s70, 2621440
    buffer_load_dwordx2 v[24:25], v9, s[44:47], s70 offen sc1
    s_add_u32 s70, s70, 2621440
    buffer_load_dwordx2 v[26:27], v9, s[44:47], s70 offen sc1
    s_add_u32 s70, s70, 2621440
    buffer_load_dwordx2 v[28:29], v9, s[44:47], s70 offen sc1
    s_add_u32 s70, s70, 2621440
    buffer_load_dwordx2 v[30:31], v9, s[44:47], s70 offen sc1
    s_add_u32 s70, s70, 2621440
    s_branch eq_29
ep_28:
    s_mov_b32 s76, 4000000
er_34:
    s_add_u32 s70, s74, 111149056
    buffer_load_dwordx2 v[16:17], v9, s[44:47], s70 offen sc1
    s_add_u32 s70, s70, 2621440
    buffer_load_dwordx2 v[18:19], v9, s[44:47], s70 offen sc1
    s_add_u32 s70, s70, 2621440
    buffer_load_dwordx2 v[20:21], v9, s[44:47], s70 offen sc1
    s_add_u32 s70, s70, 2621440
    buffer_load_dwordx2 v[22:23], v9, s[44:47], s70 offen sc1
    s_add_u32 s70, s70, 2621440
    buffer_load_dwordx2 v[24:25], v9, s[44:47], s70 offen sc1
    s_add_u32 s70, s70, 2621440
    buffer_load_dwordx2 v[26:27], v9, s[44:47], s70 offen sc1
    s_add_u32 s70, s70, 2621440
    buffer_load_dwordx2 v[28:29], v9, s[44:47], s70 offen sc1
    s_add_u32 s70, s70, 2621440
    buffer_load_dwordx2 v[30:31], v9, s[44:47], s70 offen sc1
    s_add_u32 s70, s70, 2621440
    s_sub_u32 s76, s76, 1
    s_cbranch_scc1 eq_29
    s_waitcnt vmcnt(0)
    v_max3_u32 v40, v16, v17, v18
    v_max3_u32 v40, v40, v19, v20
    v_max3_u32 v40, v40, v21, v22
    v_max3_u32 v40, v40, v23, v24
    v_max3_u32 v40, v40, v25, v26
    v_max3_u32 v40, v40, v27, v28
    v_max3_u32 v40, v40, v29, v30
    v_max_u32 v40, v40, v31
    v_cmp_eq_u32 vcc, -1, v40
    s_cbranch_vccz eq_29
    s_sleep 4
    s_branch er_34
eq_29:
    s_waitcnt vmcnt(7)
    v_lshlrev_b32 v32, 16, v16
    v_and_b32 v33, 0xffff0000, v16
    v_lshlrev_b32 v34, 16, v17
    v_and_b32 v35, 0xffff0000, v17
    s_waitcnt vmcnt(6)
    v_lshlrev_b32 v36, 16, v18
    v_and_b32 v37, 0xffff0000, v18
    v_lshlrev_b32 v38, 16, v19
    v_and_b32 v39, 0xffff0000, v19
    v_pk_add_f32 v[32:33], v[32:33], v[36:37]
    v_pk_add_f32 v[34:35], v[34:35], v[38:39]
    s_waitcnt vmcnt(5)
    v_lshlrev_b32 v36, 16, v20
    v_and_b32 v37, 0xffff0000, v20
    v_lshlrev_b32 v38, 16, v21
    v_and_b32 v39, 0xffff0000, v21
    v_pk_add_f32 v[32:33], v[32:33], v[36:37]
    v_pk_add_f32 v[34:35], v[34:35], v[38:39]
    s_waitcnt vmcnt(4)
    v_lshlrev_b32 v36, 16, v22
    v_and_b32 v37, 0xffff0000, v22
    v_lshlrev_b32 v38, 16, v23
    v_and_b32 v39, 0xffff0000, v23
    v_pk_add_f32 v[32:33], v[32:33], v[36:37]
    v_pk_add_f32 v[34:35], v[34:35], v[38:39]
    s_waitcnt vmcnt(3)
    v_lshlrev_b32 v36, 16, v24
    v_and_b32 v37, 0xffff0000, v24
    v_lshlrev_b32 v38, 16, v25
    v_and_b32 v39, 0xffff0000, v25
    v_pk_add_f32 v[32:33], v[32:33], v[36:37]
    v_pk_add_f32 v[34:35], v[34:35], v[38:39]
    s_waitcnt vmcnt(2)
    v_lshlrev_b32 v36, 16, v26
    v_and_b32 v37, 0xffff0000, v26
    v_lshlrev_b32 v38, 16, v27
    v_and_b32 v39, 0xffff0000, v27
    v_pk_add_f32 v[32:33], v[32:33], v[36:37]
    v_pk_add_f32 v[34:35], v[34:35], v[38:39]
    s_waitcnt vmcnt(1)
    v_lshlrev_b32 v36, 16, v28
    v_and_b32 v37, 0xffff0000, v28
    v_lshlrev_b32 v38, 16, v29
    v_and_b32 v39, 0xffff0000, v29
    v_pk_add_f32 v[32:33], v[32:33], v[36:37]
    v_pk_add_f32 v[34:35], v[34:35], v[38:39]
    s_waitcnt vmcnt(0)
    v_lshlrev_b32 v36, 16, v30
    v_and_b32 v37, 0xffff0000, v30
    v_lshlrev_b32 v38, 16, v31
    v_and_b32 v39, 0xffff0000, v31
    v_pk_add_f32 v[32:33], v[32:33], v[36:37]
    v_pk_add_f32 v[34:35], v[34:35], v[38:39]
    s_cmp_lt_u32 s73, 42
    s_cbranch_scc0 e2_21
    v_cvt_pk_bf16_f32 v52, v32, v33
    v_cvt_pk_bf16_f32 v53, v34, v35
    s_add_u32 s70, s74, 188743680
    buffer_store_dwordx2 v[52:53], v9, s[44:47], s70 offen sc1
    s_waitcnt vmcnt(0)
    s_barrier
    s_cmp_eq_u32 s3, 0
    s_cbranch_scc0 fs_35
    v_mov_b32 v2, 0
    v_mov_b32 v3, s75
    buffer_store_dword v3, v2, s[44:47], s8 offen sc1
fs_35:
    s_branch e3_22
e2_21:
    v_cvt_pk_bf16_f32 v32, v32, v32
    v_and_b32 v32, 0xffff0000, v32
    v_cvt_pk_bf16_f32 v33, v33, v33
    v_and_b32 v33, 0xffff0000, v33
    v_cvt_pk_bf16_f32 v34, v34, v34
    v_and_b32 v34, 0xffff0000, v34
    v_cvt_pk_bf16_f32 v35, v35, v35
    v_and_b32 v35, 0xffff0000, v35
    v_lshlrev_b32 v54, 16, v50
    v_lshlrev_b32 v58, 16, v48
    v_mul_f32 v32, v32, v54
    v_cvt_pk_bf16_f32 v32, v32, v32
    v_and_b32 v32, 0xffff0000, v32
    v_add_f32 v32, v32, v58
    v_and_b32 v55, 0xffff0000, v50
    v_and_b32 v59, 0xffff0000, v48
    v_mul_f32 v33, v33, v55
    v_cvt_pk_bf16_f32 v33, v33, v33
    v_and_b32 v33, 0xffff0000, v33
    v_add_f32 v33, v33, v59
    v_lshlrev_b32 v56, 16, v51
    v_lshlrev_b32 v60, 16, v49
    v_mul_f32 v34, v34, v56
    v_cvt_pk_bf16_f32 v34, v34, v34
    v_and_b32 v34, 0xffff0000, v34
    v_add_f32 v34, v34, v60
    v_and_b32 v57, 0xffff0000, v51
    v_and_b32 v61, 0xffff0000, v49
    v_mul_f32 v35, v35, v57
    v_cvt_pk_bf16_f32 v35, v35, v35
    v_and_b32 v35, 0xffff0000, v35
    v_add_f32 v35, v35, v61
    v_cvt_pk_bf16_f32 v52, v32, v33
    v_cvt_pk_bf16_f32 v53, v34, v35
    buffer_store_dwordx2 v[52:53], v7, s[48:51], s74 offen
e3_22:
    s_add_u32 s73, s73, 1
    s_cmp_lt_u32 s73, 64
    s_cbranch_scc1 e_19
    s_endpgm
L_exit:
    s_endpgm
L_k:
    s_lshr_b32 s63, s4, 1
    s_and_b32 s64, s4, 1
    s_lshl_b32 s64, s64, 3
    s_add_u32 s64, s64, s5
    s_sub_u32 s64, s64, 12
    s_cmp_lt_u32 s64, 9
    s_cbranch_scc0 r2_36
    s_mul_i32 s65, s64, 86
    s_lshr_b32 s65, s65, 8
    s_mul_i32 s15, s65, 9
    s_add_u32 s15, s15, s64
    s_mul_i32 s63, s63, 3
    s_add_u32 s15, s15, s63
    s_branch r2_37
r2_36:
    s_mul_i32 s63, s63, 7
    s_add_u32 s63, s63, s64
    s_sub_u32 s63, s63, 9
    s_mul_i32 s65, s63, 52
    s_lshr_b32 s65, s65, 8
    s_mul_i32 s64, s65, 5
    s_sub_u32 s64, s63, s64
    s_mul_i32 s15, s64, 5
    s_add_u32 s15, s15, s65
    s_add_u32 s15, s15, 36
    s_add_u32 s64, s63, 36
    s_cmp_lt_u32 s63, 0
    s_cselect_b32 s15, s15, s64
r2_37:
    s_lshl_b32 s63, s15, 7
    s_add_u32 s63, s63, 156827648
    s_cmp_eq_u32 s3, 0
    s_cbranch_scc0 fi_38
    v_mov_b32 v2, 0
    buffer_store_dword v2, v2, s[44:47], s63 offen sc1
fi_38:
    s_sub_u32 s60, s5, 12
    s_lshl_b32 s61, s4, 2
    s_add_u32 s61, s61, s60
    s_mul_i32 s62, s61, 384
    s_cmp_lt_u32 s3, 4
    s_cbranch_scc0 pw_39
    v_lshrrev_b32 v11, 4, v1
    v_mul_u32_u24 v10, 3072, v11
    v_bfe_u32 v11, v1, 2, 2
    v_mul_u32_u24 v11, 384, v11
    v_add_u32 v10, v10, v11
    v_and_b32 v11, 3, v1
    v_mul_u32_u24 v11, 16, v11
    v_add_u32 v10, v10, v11
    s_lshl_b32 s63, s3, 6
    s_branch pw_40
pw_39:
    v_lshrrev_b32 v11, 4, v1
    v_mul_u32_u24 v10, 3072, v11
    v_bfe_u32 v11, v1, 2, 2
    v_mul_u32_u24 v11, 384, v11
    v_add_u32 v10, v10, v11
    v_and_b32 v11, 3, v1
    v_mul_u32_u24 v11, 8, v11
    v_add_u32 v10, v10, v11
    s_lshl_b32 s63, s3, 5
    s_add_u32 s63, s63, 128
pw_40:
    v_add_u32 v10, s63, v10
    s_mov_b32 s48, s22
    s_and_b32 s49, s23, 0xffff
    s_mov_b32 s50, 0x780000
    s_mov_b32 s51, 0x00020000
    v_add_u32 v5, 0, v1
    v_mul_u32_u24 v6, 2731, v5
    v_lshrrev_b32 v6, 16, v6
    v_mul_u32_u24 v2, 11904, v6
    v_lshlrev_b32 v5, 4, v5
    v_add_u32 v2, v2, v5
    v_add_u32 v5, 64, v1
    v_mul_u32_u24 v6, 2731, v5
    v_lshrrev_b32 v6, 16, v6
    v_mul_u32_u24 v3, 11904, v6
    v_lshlrev_b32 v5, 4, v5
    v_add_u32 v3, v3, v5
    v_add_u32 v5, 128, v1
    v_mul_u32_u24 v6, 2731, v5
    v_lshrrev_b32 v6, 16, v6
    v_mul_u32_u24 v4, 11904, v6
    v_lshlrev_b32 v5, 4, v5
    v_add_u32 v4, v4, v5
    s_mul_i32 s63, s3, 3072
    s_add_u32 s63, s63, 0
    s_mul_i32 s64, s3, 98304
    s_add_u32 s64, s64, s62
    s_add_u32 s64, s64, 0
    s_mov_b32 m0, s63
    s_add_u32 s63, s63, 1024
    buffer_load_dwordx4 v2, s[48:51], s64 offen lds
    s_mov_b32 m0, s63
    s_add_u32 s63, s63, 1024
    buffer_load_dwordx4 v3, s[48:51], s64 offen lds
    s_mov_b32 m0, s63
    s_add_u32 s63, s63, 22528
    buffer_load_dwordx4 v4, s[48:51], s64 offen lds
    s_add_u32 s64, s64, 786432
    s_mov_b32 m0, s63
    s_add_u32 s63, s63, 1024
    buffer_load_dwordx4 v2, s[48:51], s64 offen lds
    s_mov_b32 m0, s63
    s_add_u32 s63, s63, 1024
    buffer_load_dwordx4 v3, s[48:51], s64 offen lds
    s_mov_b32 m0, s63
    s_add_u32 s63, s63, 22528
    buffer_load_dwordx4 v4, s[48:51], s64 offen lds
    s_add_u32 s64, s64, 786432
    s_waitcnt vmcnt(6)
    s_barrier
    s_cmp_eq_u32 s3, 0
    s_cbranch_scc0 arr_41
    s_getreg_b32 s12, hwreg(HW_REG_XCC_ID)
    s_and_b32 s12, s12, 15
    s_cmp_gt_u32 s12, 7
    s_cselect_b32 s13, s14, 0
    s_lshr_b32 s13, s13, 3
    s_add_u32 s12, s12, s13
    s_sub_u32 s12, s12, s14
    s_and_b32 s12, s12, 7
    s_mul_i32 s13, s12, s12
    s_lshl_b32 s12, s12, 9
    s_or_b32 s12, s12, 1
    v_mov_b32 v12, s12
    v_mov_b32 v13, s13
    v_mov_b32 v14, 1073741824
    v_cmp_eq_u32 vcc, 0, v1
    s_nop 1
    v_cndmask_b32 v14, v14, v1, vcc
    buffer_atomic_add_x2 v[12:13], v14, s[56:59], s10 offen sc1
arr_41:
    s_mul_i32 s63, s3, 3072
    s_add_u32 s63, s63, 49152
    s_mul_i32 s64, s3, 98304
    s_add_u32 s64, s64, s62
    s_add_u32 s64, s64, 1572864
    s_mov_b32 m0, s63
    s_add_u32 s63, s63, 1024
    buffer_load_dwordx4 v2, s[48:51], s64 offen lds
    s_mov_b32 m0, s63
    s_add_u32 s63, s63, 1024
    buffer_load_dwordx4 v3, s[48:51], s64 offen lds
    s_mov_b32 m0, s63
    s_add_u32 s63, s63, 22528
    buffer_load_dwordx4 v4, s[48:51], s64 offen lds
    s_add_u32 s64, s64, 786432
    s_mov_b32 m0, s63
    s_add_u32 s63, s63, 1024
    buffer_load_dwordx4 v2, s[48:51], s64 offen lds
    s_mov_b32 m0, s63
    s_add_u32 s63, s63, 1024
    buffer_load_dwordx4 v3, s[48:51], s64 offen lds
    s_mov_b32 m0, s63
    s_add_u32 s63, s63, 22528
    buffer_load_dwordx4 v4, s[48:51], s64 offen lds
    s_add_u32 s64, s64, 786432
    s_mul_i32 s63, s3, 3072
    s_add_u32 s63, s63, 98304
    s_mul_i32 s64, s3, 98304
    s_add_u32 s64, s64, s62
    s_add_u32 s64, s64, 3145728
    s_mov_b32 m0, s63
    s_add_u32 s63, s63, 1024
    buffer_load_dwordx4 v2, s[48:51], s64 offen lds
    s_mov_b32 m0, s63
    s_add_u32 s63, s63, 1024
    buffer_load_dwordx4 v3, s[48:51], s64 offen lds
    s_mov_b32 m0, s63
    s_add_u32 s63, s63, 22528
    buffer_load_dwordx4 v4, s[48:51], s64 offen lds
    s_add_u32 s64, s64, 786432
    s_mov_b32 m0, s63
    s_add_u32 s63, s63, 1024
    buffer_load_dwordx4 v2, s[48:51], s64 offen lds
    s_mov_b32 m0, s63
    s_add_u32 s63, s63, 1024
    buffer_load_dwordx4 v3, s[48:51], s64 offen lds
    s_mov_b32 m0, s63
    s_add_u32 s63, s63, 22528
    buffer_load_dwordx4 v4, s[48:51], s64 offen lds
    s_add_u32 s64, s64, 786432
    s_waitcnt vmcnt(12)
    s_barrier
    s_cmp_lt_u32 s3, 4
    s_cbranch_scc0 rd_42
    v_add_u32 v11, 0, v10
    ds_read_b64_tr_b16 v[96:97], v11 offset:0
    ds_read_b64_tr_b16 v[98:99], v11 offset:1536
    ds_read_b64_tr_b16 v[176:177], v11 offset:8
    ds_read_b64_tr_b16 v[178:179], v11 offset:1544
    ds_read_b64_tr_b16 v[100:101], v11 offset:12288
    ds_read_b64_tr_b16 v[102:103], v11 offset:13824
    ds_read_b64_tr_b16 v[180:181], v11 offset:12296
    ds_read_b64_tr_b16 v[182:183], v11 offset:13832
    s_waitcnt lgkmcnt(6)
    ds_read_b64_tr_b16 v[104:105], v11 offset:24576
    ds_read_b64_tr_b16 v[106:107], v11 offset:26112
    ds_read_b64_tr_b16 v[184:185], v11 offset:24584
    ds_read_b64_tr_b16 v[186:187], v11 offset:26120
    ds_read_b64_tr_b16 v[108:109], v11 offset:36864
    ds_read_b64_tr_b16 v[110:111], v11 offset:38400
    ds_read_b64_tr_b16 v[188:189], v11 offset:36872
    ds_read_b64_tr_b16 v[190:191], v11 offset:38408
    s_waitcnt lgkmcnt(6)
rd_42:
    s_cmp_lt_u32 s3, 4
    s_cbranch_scc1 rd_43
    v_add_u32 v11, 0, v10
    ds_read_b64_tr_b16 v[96:97], v11 offset:0
    ds_read_b64_tr_b16 v[98:99], v11 offset:1536
    ds_read_b64_tr_b16 v[100:101], v11 offset:12288
    ds_read_b64_tr_b16 v[102:103], v11 offset:13824
    ds_read_b64_tr_b16 v[104:105], v11 offset:24576
    ds_read_b64_tr_b16 v[106:107], v11 offset:26112
    ds_read_b64_tr_b16 v[108:109], v11 offset:36864
    ds_read_b64_tr_b16 v[110:111], v11 offset:38400
    s_waitcnt lgkmcnt(6)
rd_43:
    s_waitcnt lgkmcnt(0)
    s_barrier
    s_mul_i32 s63, s3, 3072
    s_add_u32 s63, s63, 0
    s_mul_i32 s64, s3, 98304
    s_add_u32 s64, s64, s62
    s_add_u32 s64, s64, 4718592
    s_mov_b32 m0, s63
    s_add_u32 s63, s63, 1024
    buffer_load_dwordx4 v2, s[48:51], s64 offen lds
    s_mov_b32 m0, s63
    s_add_u32 s63, s63, 1024
    buffer_load_dwordx4 v3, s[48:51], s64 offen lds
    s_mov_b32 m0, s63
    s_add_u32 s63, s63, 22528
    buffer_load_dwordx4 v4, s[48:51], s64 offen lds
    s_add_u32 s64, s64, 786432
    s_mov_b32 m0, s63
    s_add_u32 s63, s63, 1024
    buffer_load_dwordx4 v2, s[48:51], s64 offen lds
    s_mov_b32 m0, s63
    s_add_u32 s63, s63, 1024
    buffer_load_dwordx4 v3, s[48:51], s64 offen lds
    s_mov_b32 m0, s63
    s_add_u32 s63, s63, 22528
    buffer_load_dwordx4 v4, s[48:51], s64 offen lds
    s_add_u32 s64, s64, 786432
    s_waitcnt vmcnt(12)
    s_barrier
    s_cmp_lt_u32 s3, 4
    s_cbranch_scc0 rd_44
    v_add_u32 v11, 49152, v10
    ds_read_b64_tr_b16 v[112:113], v11 offset:0
    ds_read_b64_tr_b16 v[114:115], v11 offset:1536
    ds_read_b64_tr_b16 v[192:193], v11 offset:8
    ds_read_b64_tr_b16 v[194:195], v11 offset:1544
    ds_read_b64_tr_b16 v[116:117], v11 offset:12288
    ds_read_b64_tr_b16 v[118:119], v11 offset:13824
    ds_read_b64_tr_b16 v[196:197], v11 offset:12296
    ds_read_b64_tr_b16 v[198:199], v11 offset:13832
    s_waitcnt lgkmcnt(6)
    ds_read_b64_tr_b16 v[120:121], v11 offset:24576
    ds_read_b64_tr_b16 v[122:123], v11 offset:26112
    ds_read_b64_tr_b16 v[200:201], v11 offset:24584
    ds_read_b64_tr_b16 v[202:203], v11 offset:26120
    ds_read_b64_tr_b16 v[124:125], v11 offset:36864
    ds_read_b64_tr_b16 v[126:127], v11 offset:38400
    ds_read_b64_tr_b16 v[204:205], v11 offset:36872
    ds_read_b64_tr_b16 v[206:207], v11 offset:38408
    s_waitcnt lgkmcnt(6)
rd_44:
    s_cmp_lt_u32 s3, 4
    s_cbranch_scc1 rd_45
    v_add_u32 v11, 49152, v10
    ds_read_b64_tr_b16 v[112:113], v11 offset:0
    ds_read_b64_tr_b16 v[114:115], v11 offset:1536
    ds_read_b64_tr_b16 v[116:117], v11 offset:12288
    ds_read_b64_tr_b16 v[118:119], v11 offset:13824
    ds_read_b64_tr_b16 v[120:121], v11 offset:24576
    ds_read_b64_tr_b16 v[122:123], v11 offset:26112
    ds_read_b64_tr_b16 v[124:125], v11 offset:36864
    ds_read_b64_tr_b16 v[126:127], v11 offset:38400
    s_waitcnt lgkmcnt(6)
rd_45:
    s_waitcnt lgkmcnt(0)
    s_barrier
    s_mul_i32 s63, s3, 3072
    s_add_u32 s63, s63, 49152
    s_mul_i32 s64, s3, 98304
    s_add_u32 s64, s64, s62
    s_add_u32 s64, s64, 6291456
    s_mov_b32 m0, s63
    s_add_u32 s63, s63, 1024
    buffer_load_dwordx4 v2, s[48:51], s64 offen lds
    s_mov_b32 m0, s63
    s_add_u32 s63, s63, 1024
    buffer_load_dwordx4 v3, s[48:51], s64 offen lds
    s_mov_b32 m0, s63
    s_add_u32 s63, s63, 22528
    buffer_load_dwordx4 v4, s[48:51], s64 offen lds
    s_add_u32 s64, s64, 786432
    s_mov_b32 m0, s63
    s_add_u32 s63, s63, 1024
    buffer_load_dwordx4 v2, s[48:51], s64 offen lds
    s_mov_b32 m0, s63
    s_add_u32 s63, s63, 1024
    buffer_load_dwordx4 v3, s[48:51], s64 offen lds
    s_mov_b32 m0, s63
    s_add_u32 s63, s63, 22528
    buffer_load_dwordx4 v4, s[48:51], s64 offen lds
    s_add_u32 s64, s64, 786432
    s_waitcnt vmcnt(12)
    s_barrier
    s_cmp_lt_u32 s3, 4
    s_cbranch_scc0 rd_46
    v_add_u32 v11, 98304, v10
    ds_read_b64_tr_b16 v[128:129], v11 offset:0
    ds_read_b64_tr_b16 v[130:131], v11 offset:1536
    ds_read_b64_tr_b16 v[208:209], v11 offset:8
    ds_read_b64_tr_b16 v[210:211], v11 offset:1544
    ds_read_b64_tr_b16 v[132:133], v11 offset:12288
    ds_read_b64_tr_b16 v[134:135], v11 offset:13824
    ds_read_b64_tr_b16 v[212:213], v11 offset:12296
    ds_read_b64_tr_b16 v[214:215], v11 offset:13832
    s_waitcnt lgkmcnt(6)
    ds_read_b64_tr_b16 v[136:137], v11 offset:24576
    ds_read_b64_tr_b16 v[138:139], v11 offset:26112
    ds_read_b64_tr_b16 v[216:217], v11 offset:24584
    ds_read_b64_tr_b16 v[218:219], v11 offset:26120
    ds_read_b64_tr_b16 v[140:141], v11 offset:36864
    ds_read_b64_tr_b16 v[142:143], v11 offset:38400
    ds_read_b64_tr_b16 v[220:221], v11 offset:36872
    ds_read_b64_tr_b16 v[222:223], v11 offset:38408
    s_waitcnt lgkmcnt(6)
rd_46:
    s_cmp_lt_u32 s3, 4
    s_cbranch_scc1 rd_47
    v_add_u32 v11, 98304, v10
    ds_read_b64_tr_b16 v[128:129], v11 offset:0
    ds_read_b64_tr_b16 v[130:131], v11 offset:1536
    ds_read_b64_tr_b16 v[132:133], v11 offset:12288
    ds_read_b64_tr_b16 v[134:135], v11 offset:13824
    ds_read_b64_tr_b16 v[136:137], v11 offset:24576
    ds_read_b64_tr_b16 v[138:139], v11 offset:26112
    ds_read_b64_tr_b16 v[140:141], v11 offset:36864
    ds_read_b64_tr_b16 v[142:143], v11 offset:38400
    s_waitcnt lgkmcnt(6)
rd_47:
    s_waitcnt lgkmcnt(0)
    s_barrier
    s_waitcnt vmcnt(6)
    s_barrier
    s_cmp_lt_u32 s3, 4
    s_cbranch_scc0 rd_48
    v_add_u32 v11, 0, v10
    ds_read_b64_tr_b16 v[144:145], v11 offset:0
    ds_read_b64_tr_b16 v[146:147], v11 offset:1536
    ds_read_b64_tr_b16 v[224:225], v11 offset:8
    ds_read_b64_tr_b16 v[226:227], v11 offset:1544
    ds_read_b64_tr_b16 v[148:149], v11 offset:12288
    ds_read_b64_tr_b16 v[150:151], v11 offset:13824
    ds_read_b64_tr_b16 v[228:229], v11 offset:12296
    ds_read_b64_tr_b16 v[230:231], v11 offset:13832
    s_waitcnt lgkmcnt(6)
    ds_read_b64_tr_b16 v[152:153], v11 offset:24576
    ds_read_b64_tr_b16 v[154:155], v11 offset:26112
    ds_read_b64_tr_b16 v[232:233], v11 offset:24584
    ds_read_b64_tr_b16 v[234:235], v11 offset:26120
    ds_read_b64_tr_b16 v[156:157], v11 offset:36864
    ds_read_b64_tr_b16 v[158:159], v11 offset:38400
    ds_read_b64_tr_b16 v[236:237], v11 offset:36872
    ds_read_b64_tr_b16 v[238:239], v11 offset:38408
    s_waitcnt lgkmcnt(6)
rd_48:
    s_cmp_lt_u32 s3, 4
    s_cbranch_scc1 rd_49
    v_add_u32 v11, 0, v10
    ds_read_b64_tr_b16 v[144:145], v11 offset:0
    ds_read_b64_tr_b16 v[146:147], v11 offset:1536
    ds_read_b64_tr_b16 v[148:149], v11 offset:12288
    ds_read_b64_tr_b16 v[150:151], v11 offset:13824
    ds_read_b64_tr_b16 v[152:153], v11 offset:24576
    ds_read_b64_tr_b16 v[154:155], v11 offset:26112
    ds_read_b64_tr_b16 v[156:157], v11 offset:36864
    ds_read_b64_tr_b16 v[158:159], v11 offset:38400
    s_waitcnt lgkmcnt(6)
rd_49:
    s_waitcnt lgkmcnt(0)
    s_barrier
    s_waitcnt vmcnt(0)
    s_barrier
    s_cmp_lt_u32 s3, 4
    s_cbranch_scc0 rd_50
    v_add_u32 v11, 49152, v10
    ds_read_b64_tr_b16 v[160:161], v11 offset:0
    ds_read_b64_tr_b16 v[162:163], v11 offset:1536
    ds_read_b64_tr_b16 v[240:241], v11 offset:8
    ds_read_b64_tr_b16 v[242:243], v11 offset:1544
    ds_read_b64_tr_b16 v[164:165], v11 offset:12288
    ds_read_b64_tr_b16 v[166:167], v11 offset:13824
    ds_read_b64_tr_b16 v[244:245], v11 offset:12296
    ds_read_b64_tr_b16 v[246:247], v11 offset:13832
    s_waitcnt lgkmcnt(6)
    ds_read_b64_tr_b16 v[168:169], v11 offset:24576
    ds_read_b64_tr_b16 v[170:171], v11 offset:26112
    ds_read_b64_tr_b16 v[248:249], v11 offset:24584
    ds_read_b64_tr_b16 v[250:251], v11 offset:26120
    ds_read_b64_tr_b16 v[172:173], v11 offset:36864
    ds_read_b64_tr_b16 v[174:175], v11 offset:38400
    ds_read_b64_tr_b16 v[252:253], v11 offset:36872
    ds_read_b64_tr_b16 v[254:255], v11 offset:38408
    s_waitcnt lgkmcnt(6)
rd_50:
    s_cmp_lt_u32 s3, 4
    s_cbranch_scc1 rd_51
    v_add_u32 v11, 49152, v10
    ds_read_b64_tr_b16 v[160:161], v11 offset:0
    ds_read_b64_tr_b16 v[162:163], v11 offset:1536
    ds_read_b64_tr_b16 v[164:165], v11 offset:12288
    ds_read_b64_tr_b16 v[166:167], v11 offset:13824
    ds_read_b64_tr_b16 v[168:169], v11 offset:24576
    ds_read_b64_tr_b16 v[170:171], v11 offset:26112
    ds_read_b64_tr_b16 v[172:173], v11 offset:36864
    ds_read_b64_tr_b16 v[174:175], v11 offset:38400
    s_waitcnt lgkmcnt(6)
rd_51:
    s_waitcnt lgkmcnt(0)
    s_barrier
    v_mov_b32 v8, 0
    s_cmp_eq_u32 s3, 0
    s_cbranch_scc0 wao_54
    s_mov_b32 s76, 1000000
wa_52:
    buffer_load_dword v9, v8, s[56:59], s10 offen offset:128 sc1
    s_sub_u32 s76, s76, 1
    s_cbranch_scc1 wad_53
    s_waitcnt vmcnt(0)
    v_readfirstlane_b32 s63, v9
    s_cmp_lg_u32 s63, 0
    s_cbranch_scc1 wad_53
    s_sleep 2
    s_branch wa_52
wad_53:
    s_waitcnt vmcnt(0)
    ds_write_b32 v8, v9
    s_waitcnt lgkmcnt(0)
wao_54:
    s_barrier
    ds_read_b32 v9, v8
    s_waitcnt lgkmcnt(0)
    v_readfirstlane_b32 s63, v9
    s_cmp_lg_u32 s63, 1
    s_cselect_b32 s6, 1, 0
    s_waitcnt vmcnt(0)
    s_barrier
    s_cbranch_scc0 wak_55
    s_cmp_eq_u32 s10, 0
    s_mov_b32 s10, 16
    s_cbranch_scc1 L_restart
wak_55:
    v_lshlrev_b32 v7, 4, v1
    s_mul_i32 s63, s61, 12288
    s_add_u32 s63, s63, 4194304
    v_mov_b32 v11, v7
    s_cmp_lt_u32 s3, 4
    s_cbranch_scc0 kv_56
    s_lshl_b32 s64, s3, 10
    s_branch kv_57
kv_56:
    s_sub_u32 s65, s3, 4
    s_lshl_b32 s64, s65, 9
    s_add_u32 s64, s64, 4096
    v_lshrrev_b32 v11, 5, v1
    v_lshlrev_b32 v11, 8, v11
    v_and_b32 v10, 15, v1
    v_lshlrev_b32 v10, 4, v10
    v_add_u32 v11, v11, v10
    v_bfe_u32 v10, v1, 4, 1
    v_lshlrev_b32 v10, 3, v10
    v_add_u32 v11, v11, v10
kv_57:
    s_add_u32 s63, s63, s64
    v_add_u32 v9, s63, v11
    v_add_u32 v10, 6144, v9
    v_lshrrev_b32 v12, 1, v1
    v_and_b32 v13, 1, v1
    v_lshlrev_b32 v13, 7, v13
    s_cmp_lt_u32 s15, 36
    s_cbranch_scc0 ft_58
    s_mov_b32 s48, s32
    s_and_b32 s49, s33, 0xffff
    s_mov_b32 s50, 0x1e0000
    s_mov_b32 s51, 0x00020000
    s_mov_b32 s52, s34
    s_and_b32 s53, s35, 0xffff
    s_mov_b32 s54, 0x1e0000
    s_mov_b32 s55, 0x00020000
    s_mul_i32 s63, s15, 43
    s_lshr_b32 s63, s63, 9
    s_mul_i32 s63, s63, 12
    s_sub_u32 s63, s15, s63
    v_mul_u32_u24 v12, 3072, v12
    s_mov_b32 s66, 98304
    s_mov_b32 s67, 0
    s_branch ft_59
ft_58:
    s_mov_b32 s48, s36
    s_and_b32 s49, s37, 0xffff
    s_mov_b32 s50, 0x1e0000
    s_mov_b32 s51, 0x00020000
    s_mov_b32 s52, s36
    s_and_b32 s53, s37, 0xffff
    s_mov_b32 s54, 0x1e0000
    s_mov_b32 s55, 0x00020000
    s_sub_u32 s63, s15, 36
    s_mul_i32 s64, s63, 52
    s_lshr_b32 s64, s64, 8
    s_mul_i32 s64, s64, 5
    s_sub_u32 s63, s63, s64
    v_mul_u32_u24 v12, 1280, v12
    s_mov_b32 s66, 40960
    s_mov_b32 s67, 983040
ft_59:
    s_lshl_b32 s63, s63, 8
    v_add3_u32 v12, v12, v13, s63
    v_lshlrev_b32 v7, 4, v1
    s_mov_b32 s73, 0
    s_add_u32 s70, s73, 0
    s_mul_i32 s70, s70, 40960
    s_mov_b32 s71, 0
    s_lshl_b32 s63, s3, 10
    s_add_u32 s64, s63, s70
    s_add_u32 s63, s63, s71
    s_mov_b32 m0, s63
    s_add_u32 s63, s63, 8192
    buffer_load_dwordx4 v7, s[44:47], s64 offen sc1 lds
    s_add_u32 s64, s64, 8192
    s_mov_b32 m0, s63
    s_add_u32 s63, s63, 8192
    buffer_load_dwordx4 v7, s[44:47], s64 offen sc1 lds
    s_add_u32 s64, s64, 8192
    s_mov_b32 m0, s63
    s_add_u32 s63, s63, 8192
    buffer_load_dwordx4 v7, s[44:47], s64 offen sc1 lds
    s_add_u32 s64, s64, 8192
    s_mov_b32 m0, s63
    s_add_u32 s63, s63, 8192
    buffer_load_dwordx4 v7, s[44:47], s64 offen sc1 lds
    s_add_u32 s64, s64, 8192
    s_mov_b32 m0, s63
    s_add_u32 s63, s63, 8192
    buffer_load_dwordx4 v7, s[44:47], s64 offen sc1 lds
    s_add_u32 s64, s64, 8192
    s_add_u32 s70, s70, 40960
    s_mov_b32 s71, 40960
    s_lshl_b32 s63, s3, 10
    s_add_u32 s64, s63, s70
    s_add_u32 s63, s63, s71
    s_mov_b32 m0, s63
    s_add_u32 s63, s63, 8192
    buffer_load_dwordx4 v7, s[44:47], s64 offen sc1 lds
    s_add_u32 s64, s64, 8192
    s_mov_b32 m0, s63
    s_add_u32 s63, s63, 8192
    buffer_load_dwordx4 v7, s[44:47], s64 offen sc1 lds
    s_add_u32 s64, s64, 8192
    s_mov_b32 m0, s63
    s_add_u32 s63, s63, 8192
    buffer_load_dwordx4 v7, s[44:47], s64 offen sc1 lds
    s_add_u32 s64, s64, 8192
    s_mov_b32 m0, s63
    s_add_u32 s63, s63, 8192
    buffer_load_dwordx4 v7, s[44:47], s64 offen sc1 lds
    s_add_u32 s64, s64, 8192
    s_mov_b32 m0, s63
    s_add_u32 s63, s63, 8192
    buffer_load_dwordx4 v7, s[44:47], s64 offen sc1 lds
    s_add_u32 s64, s64, 8192
    s_mov_b32 s79, 0
    s_mov_b32 s80, 81920
    s_cmp_lt_u32 s3, 4
    s_cbranch_scc0 xp_60
    s_setprio 1
xp_60:
    s_waitcnt vmcnt(5)
    s_mov_b32 s78, s73
    s_branch xb_63
xst_62:
    s_waitcnt vmcnt(0)
    s_mov_b32 s78, s73
    .p2align 6
xb_63:
    s_barrier
    s_cmp_eq_u32 s3, 0
    s_cbranch_scc0 fs_64
    v_mov_b32 v2, 0
    v_mov_b32 v3, s78
    buffer_store_dword v3, v2, s[44:47], s8 offen sc1
fs_64:
    s_cmp_ge_u32 s73, 64
    s_cbranch_scc1 L_ph2
    s_add_u32 s72, s73, 2
    s_min_u32 s72, s72, 63
    s_mul_i32 s70, s72, 40960
    s_lshl_b32 s63, s3, 10
    s_add_u32 s70, s70, s63
    v_add_u32 v8, s79, v7
    s_add_u32 s71, s80, s63
    s_mov_b32 s80, s79
    s_add_u32 s79, s79, 40960
    s_cmp_eq_u32 s79, 122880
    s_cselect_b32 s79, 0, s79
    s_cmp_eq_u32 s3, 7
    s_cbranch_scc0 xt_65
    s_sub_u32 s64, s73, 38
    s_cmp_lt_u32 s64, 24
    s_cbranch_scc0 xt_65
    s_mul_i32 s64, s64, s66
    s_add_u32 s65, s64, s67
    buffer_load_dword v13, v12, s[48:51], s64 offen
    buffer_load_dword v13, v12, s[52:55], s65 offen
xt_65:
    s_cmp_lt_u32 s3, 4
    s_cbranch_scc0 xs_61
    s_mul_i32 s74, s73, 393216
    ds_read_b128 v[16:19], v8 offset:0
    ds_read_b128 v[20:23], v8 offset:1024
    ds_read_b128 v[24:27], v8 offset:2048
    ds_read_b128 v[28:31], v8 offset:3072
    ds_read_b128 v[32:35], v8 offset:4096
    ds_read_b128 v[36:39], v8 offset:5120
    ds_read_b128 v[40:43], v8 offset:6144
    ds_read_b128 v[44:47], v8 offset:7168
    s_waitcnt lgkmcnt(7)
    v_mfma_f32_16x16x32_bf16 v[48:51], v[96:99], v[16:19], 0
    v_mfma_f32_16x16x32_bf16 v[52:55], v[176:179], v[16:19], 0
    ds_read_b128 v[16:19], v8 offset:8192
    s_waitcnt lgkmcnt(7)
    v_mfma_f32_16x16x32_bf16 v[48:51], v[100:103], v[20:23], v[48:51]
    v_mfma_f32_16x16x32_bf16 v[52:55], v[180:183], v[20:23], v[52:55]
    ds_read_b128 v[20:23], v8 offset:9216
    s_mov_b32 m0, s71
    s_add_u32 s71, s71, 8192
    buffer_load_dwordx4 v7, s[44:47], s70 offen sc1 lds
    s_add_u32 s70, s70, 8192
    s_waitcnt lgkmcnt(7)
    v_mfma_f32_16x16x32_bf16 v[48:51], v[104:107], v[24:27], v[48:51]
    v_mfma_f32_16x16x32_bf16 v[52:55], v[184:187], v[24:27], v[52:55]
    ds_read_b128 v[24:27], v8 offset:10240
    s_waitcnt lgkmcnt(7)
    v_mfma_f32_16x16x32_bf16 v[48:51], v[108:111], v[28:31], v[48:51]
    v_mfma_f32_16x16x32_bf16 v[52:55], v[188:191], v[28:31], v[52:55]
    ds_read_b128 v[28:31], v8 offset:11264
    s_waitcnt lgkmcnt(7)
    v_mfma_f32_16x16x32_bf16 v[48:51], v[112:115], v[32:35], v[48:51]
    v_mfma_f32_16x16x32_bf16 v[52:55], v[192:195], v[32:35], v[52:55]
    ds_read_b128 v[32:35], v8 offset:12288
    s_waitcnt lgkmcnt(7)
    v_mfma_f32_16x16x32_bf16 v[48:51], v[116:119], v[36:39], v[48:51]
    v_mfma_f32_16x16x32_bf16 v[52:55], v[196:199], v[36:39], v[52:55]
    ds_read_b128 v[36:39], v8 offset:13312
    s_waitcnt lgkmcnt(7)
    v_mfma_f32_16x16x32_bf16 v[48:51], v[120:123], v[40:43], v[48:51]
    v_mfma_f32_16x16x32_bf16 v[52:55], v[200:203], v[40:43], v[52:55]
    ds_read_b128 v[40:43], v8 offset:14336
    s_waitcnt lgkmcnt(7)
    v_mfma_f32_16x16x32_bf16 v[48:51], v[124:127], v[44:47], v[48:51]
    v_mfma_f32_16x16x32_bf16 v[52:55], v[204:207], v[44:47], v[52:55]
    ds_read_b128 v[44:47], v8 offset:15360
    s_mov_b32 m0, s71
    s_add_u32 s71, s71, 8192
    buffer_load_dwordx4 v7, s[44:47], s70 offen sc1 lds
    s_add_u32 s70, s70, 8192
    s_waitcnt lgkmcnt(7)
    v_mfma_f32_16x16x32_bf16 v[48:51], v[128:131], v[16:19], v[48:51]
    v_mfma_f32_16x16x32_bf16 v[52:55], v[208:211], v[16:19], v[52:55]
    ds_read_b128 v[16:19], v8 offset:16384
    s_waitcnt lgkmcnt(7)
    v_mfma_f32_16x16x32_bf16 v[48:51], v[132:135], v[20:23], v[48:51]
    v_mfma_f32_16x16x32_bf16 v[52:55], v[212:215], v[20:23], v[52:55]
    ds_read_b128 v[20:23], v8 offset:17408
    s_waitcnt lgkmcnt(7)
    v_mfma_f32_16x16x32_bf16 v[48:51], v[136:139], v[24:27], v[48:51]
    v_mfma_f32_16x16x32_bf16 v[52:55], v[216:219], v[24:27], v[52:55]
    ds_read_b128 v[24:27], v8 offset:18432
    s_waitcnt lgkmcnt(7)
    v_mfma_f32_16x16x32_bf16 v[48:51], v[140:143], v[28:31], v[48:51]
    v_mfma_f32_16x16x32_bf16 v[52:55], v[220:223], v[28:31], v[52:55]
    ds_read_b128 v[28:31], v8 offset:19456
    s_waitcnt lgkmcnt(7)
    v_mfma_f32_16x16x32_bf16 v[48:51], v[144:147], v[32:35], v[48:51]
    v_mfma_f32_16x16x32_bf16 v[52:55], v[224:227], v[32:35], v[52:55]
    ds_read_b128 v[32:35], v8 offset:20480
    s_waitcnt lgkmcnt(7)
    v_mfma_f32_16x16x32_bf16 v[48:51], v[148:151], v[36:39], v[48:51]
    v_mfma_f32_16x16x32_bf16 v[52:55], v[228:231], v[36:39], v[52:55]
    ds_read_b128 v[36:39], v8 offset:21504
    s_mov_b32 m0, s71
    s_add_u32 s71, s71, 8192
    buffer_load_dwordx4 v7, s[44:47], s70 offen sc1 lds
    s_add_u32 s70, s70, 8192
    s_waitcnt lgkmcnt(7)
    v_mfma_f32_16x16x32_bf16 v[48:51], v[152:155], v[40:43], v[48:51]
    v_mfma_f32_16x16x32_bf16 v[52:55], v[232:235], v[40:43], v[52:55]
    ds_read_b128 v[40:43], v8 offset:22528
    s_waitcnt lgkmcnt(7)
    v_mfma_f32_16x16x32_bf16 v[48:51], v[156:159], v[44:47], v[48:51]
    v_mfma_f32_16x16x32_bf16 v[52:55], v[236:239], v[44:47], v[52:55]
    ds_read_b128 v[44:47], v8 offset:23552
    s_waitcnt lgkmcnt(7)
    v_mfma_f32_16x16x32_bf16 v[48:51], v[160:163], v[16:19], v[48:51]
    v_mfma_f32_16x16x32_bf16 v[52:55], v[240:243], v[16:19], v[52:55]
    ds_read_b128 v[16:19], v8 offset:24576
    s_waitcnt lgkmcnt(7)
    v_mfma_f32_16x16x32_bf16 v[48:51], v[164:167], v[20:23], v[48:51]
    v_mfma_f32_16x16x32_bf16 v[52:55], v[244:247], v[20:23], v[52:55]
    ds_read_b128 v[20:23], v8 offset:25600
    s_waitcnt lgkmcnt(7)
    v_mfma_f32_16x16x32_bf16 v[48:51], v[168:171], v[24:27], v[48:51]
    v_mfma_f32_16x16x32_bf16 v[52:55], v[248:251], v[24:27], v[52:55]
    ds_read_b128 v[24:27], v8 offset:26624
    s_waitcnt lgkmcnt(7)
    v_mfma_f32_16x16x32_bf16 v[48:51], v[172:175], v[28:31], v[48:51]
    v_mfma_f32_16x16x32_bf16 v[52:55], v[252:255], v[28:31], v[52:55]
    ds_read_b128 v[28:31], v8 offset:27648
    s_mov_b32 m0, s71
    s_add_u32 s71, s71, 8192
    buffer_load_dwordx4 v7, s[44:47], s70 offen sc1 lds
    s_add_u32 s70, s70, 8192
    s_waitcnt lgkmcnt(7)
    v_mfma_f32_16x16x32_bf16 v[56:59], v[96:99], v[32:35], 0
    v_mfma_f32_16x16x32_bf16 v[60:63], v[176:179], v[32:35], 0
    ds_read_b128 v[32:35], v8 offset:28672
    s_waitcnt lgkmcnt(7)
    v_mfma_f32_16x16x32_bf16 v[56:59], v[100:103], v[36:39], v[56:59]
    v_mfma_f32_16x16x32_bf16 v[60:63], v[180:183], v[36:39], v[60:63]
    ds_read_b128 v[36:39], v8 offset:29696
    s_waitcnt lgkmcnt(7)
    v_mfma_f32_16x16x32_bf16 v[56:59], v[104:107], v[40:43], v[56:59]
    v_mfma_f32_16x16x32_bf16 v[60:63], v[184:187], v[40:43], v[60:63]
    ds_read_b128 v[40:43], v8 offset:30720
    s_waitcnt lgkmcnt(7)
    v_mfma_f32_16x16x32_bf16 v[56:59], v[108:111], v[44:47], v[56:59]
    v_mfma_f32_16x16x32_bf16 v[60:63], v[188:191], v[44:47], v[60:63]
    ds_read_b128 v[44:47], v8 offset:31744
    s_waitcnt lgkmcnt(7)
    v_mfma_f32_16x16x32_bf16 v[56:59], v[112:115], v[16:19], v[56:59]
    v_mfma_f32_16x16x32_bf16 v[60:63], v[192:195], v[16:19], v[60:63]
    ds_read_b128 v[16:19], v8 offset:32768
    s_waitcnt lgkmcnt(7)
    v_mfma_f32_16x16x32_bf16 v[56:59], v[116:119], v[20:23], v[56:59]
    v_mfma_f32_16x16x32_bf16 v[60:63], v[196:199], v[20:23], v[60:63]
    ds_read_b128 v[20:23], v8 offset:33792
    s_mov_b32 m0, s71
    s_add_u32 s71, s71, 8192
    buffer_load_dwordx4 v7, s[44:47], s70 offen sc1 lds
    s_add_u32 s70, s70, 8192
    s_waitcnt lgkmcnt(7)
    v_mfma_f32_16x16x32_bf16 v[56:59], v[120:123], v[24:27], v[56:59]
    v_mfma_f32_16x16x32_bf16 v[60:63], v[200:203], v[24:27], v[60:63]
    ds_read_b128 v[24:27], v8 offset:34816
    s_waitcnt lgkmcnt(7)
    v_mfma_f32_16x16x32_bf16 v[56:59], v[124:127], v[28:31], v[56:59]
    v_mfma_f32_16x16x32_bf16 v[60:63], v[204:207], v[28:31], v[60:63]
    ds_read_b128 v[28:31], v8 offset:35840
    s_waitcnt lgkmcnt(7)
    v_mfma_f32_16x16x32_bf16 v[56:59], v[128:131], v[32:35], v[56:59]
    v_mfma_f32_16x16x32_bf16 v[60:63], v[208:211], v[32:35], v[60:63]
    ds_read_b128 v[32:35], v8 offset:36864
    s_waitcnt lgkmcnt(7)
    v_mfma_f32_16x16x32_bf16 v[56:59], v[132:135], v[36:39], v[56:59]
    v_mfma_f32_16x16x32_bf16 v[60:63], v[212:215], v[36:39], v[60:63]
    ds_read_b128 v[36:39], v8 offset:37888
    s_waitcnt lgkmcnt(7)
    v_mfma_f32_16x16x32_bf16 v[56:59], v[136:139], v[40:43], v[56:59]
    v_mfma_f32_16x16x32_bf16 v[60:63], v[216:219], v[40:43], v[60:63]
    ds_read_b128 v[40:43], v8 offset:38912
    s_waitcnt lgkmcnt(7)
    v_mfma_f32_16x16x32_bf16 v[56:59], v[140:143], v[44:47], v[56:59]
    v_mfma_f32_16x16x32_bf16 v[60:63], v[220:223], v[44:47], v[60:63]
    ds_read_b128 v[44:47], v8 offset:39936
    s_waitcnt lgkmcnt(7)
    v_mfma_f32_16x16x32_bf16 v[56:59], v[144:147], v[16:19], v[56:59]
    v_mfma_f32_16x16x32_bf16 v[60:63], v[224:227], v[16:19], v[60:63]
    s_waitcnt lgkmcnt(6)
    v_mfma_f32_16x16x32_bf16 v[56:59], v[148:151], v[20:23], v[56:59]
    v_mfma_f32_16x16x32_bf16 v[60:63], v[228:231], v[20:23], v[60:63]
    s_waitcnt lgkmcnt(5)
    v_mfma_f32_16x16x32_bf16 v[56:59], v[152:155], v[24:27], v[56:59]
    v_mfma_f32_16x16x32_bf16 v[60:63], v[232:235], v[24:27], v[60:63]
    s_waitcnt lgkmcnt(4)
    v_mfma_f32_16x16x32_bf16 v[56:59], v[156:159], v[28:31], v[56:59]
    v_mfma_f32_16x16x32_bf16 v[60:63], v[236:239], v[28:31], v[60:63]
    s_waitcnt lgkmcnt(3)
    v_mfma_f32_16x16x32_bf16 v[56:59], v[160:163], v[32:35], v[56:59]
    v_mfma_f32_16x16x32_bf16 v[60:63], v[240:243], v[32:35], v[60:63]
    s_waitcnt lgkmcnt(2)
    v_mfma_f32_16x16x32_bf16 v[56:59], v[164:167], v[36:39], v[56:59]
    v_mfma_f32_16x16x32_bf16 v[60:63], v[244:247], v[36:39], v[60:63]
    s_waitcnt lgkmcnt(1)
    v_mfma_f32_16x16x32_bf16 v[56:59], v[168:171], v[40:43], v[56:59]
    v_mfma_f32_16x16x32_bf16 v[60:63], v[248:251], v[40:43], v[60:63]
    s_waitcnt lgkmcnt(0)
    v_mfma_f32_16x16x32_bf16 v[56:59], v[172:175], v[44:47], v[56:59]
    v_mfma_f32_16x16x32_bf16 v[60:63], v[252:255], v[44:47], v[60:63]
    s_nop 7
    v_cvt_pk_bf16_f32 v64, v48, v49
    v_cvt_pk_bf16_f32 v65, v50, v51
    v_cvt_pk_bf16_f32 v66, v52, v53
    v_cvt_pk_bf16_f32 v67, v54, v55
    v_cvt_pk_bf16_f32 v68, v56, v57
    v_cvt_pk_bf16_f32 v69, v58, v59
    v_cvt_pk_bf16_f32 v70, v60, v61
    v_cvt_pk_bf16_f32 v71, v62, v63
    buffer_store_dwordx4 v[64:67], v9, s[44:47], s74 offen sc1
    buffer_store_dwordx4 v[68:71], v10, s[44:47], s74 offen sc1
    s_mov_b32 s78, s73
    s_add_u32 s73, s73, 1
    s_cmp_ge_u32 s73, 64
    s_cbranch_scc1 xst_62
    s_cmp_lt_u32 s73, 6
    s_cbranch_scc1 xst_62
    s_waitcnt vmcnt(7)
    s_branch xb_63
    .p2align 6
xs_61:
    s_mul_i32 s74, s73, 393216
    ds_read_b128 v[16:19], v8 offset:0
    ds_read_b128 v[20:23], v8 offset:1024
    ds_read_b128 v[24:27], v8 offset:2048
    ds_read_b128 v[28:31], v8 offset:3072
    ds_read_b128 v[32:35], v8 offset:4096
    ds_read_b128 v[36:39], v8 offset:5120
    ds_read_b128 v[40:43], v8 offset:6144
    ds_read_b128 v[44:47], v8 offset:7168
    s_waitcnt lgkmcnt(7)
    v_mfma_f32_16x16x32_bf16 v[48:51], v[96:99], v[16:19], 0
    ds_read_b128 v[16:19], v8 offset:8192
    s_waitcnt lgkmcnt(7)
    v_mfma_f32_16x16x32_bf16 v[48:51], v[100:103], v[20:23], v[48:51]
    ds_read_b128 v[20:23], v8 offset:9216
    s_mov_b32 m0, s71
    s_add_u32 s71, s71, 8192
    buffer_load_dwordx4 v7, s[44:47], s70 offen sc1 lds
    s_add_u32 s70, s70, 8192
    s_waitcnt lgkmcnt(7)
    v_mfma_f32_16x16x32_bf16 v[48:51], v[104:107], v[24:27], v[48:51]
    ds_read_b128 v[24:27], v8 offset:10240
    s_waitcnt lgkmcnt(7)
    v_mfma_f32_16x16x32_bf16 v[48:51], v[108:111], v[28:31], v[48:51]
    ds_read_b128 v[28:31], v8 offset:11264
    s_waitcnt lgkmcnt(7)
    v_mfma_f32_16x16x32_bf16 v[48:51], v[112:115], v[32:35], v[48:51]
    ds_read_b128 v[32:35], v8 offset:12288
    s_waitcnt lgkmcnt(7)
    v_mfma_f32_16x16x32_bf16 v[48:51], v[116:119], v[36:39], v[48:51]
    ds_read_b128 v[36:39], v8 offset:13312
    s_waitcnt lgkmcnt(7)
    v_mfma_f32_16x16x32_bf16 v[48:51], v[120:123], v[40:43], v[48:51]
    ds_read_b128 v[40:43], v8 offset:14336
    s_waitcnt lgkmcnt(7)
    v_mfma_f32_16x16x32_bf16 v[48:51], v[124:127], v[44:47], v[48:51]
    ds_read_b128 v[44:47], v8 offset:15360
    s_mov_b32 m0, s71
    s_add_u32 s71, s71, 8192
    buffer_load_dwordx4 v7, s[44:47], s70 offen sc1 lds
    s_add_u32 s70, s70, 8192
    s_waitcnt lgkmcnt(7)
    v_mfma_f32_16x16x32_bf16 v[48:51], v[128:131], v[16:19], v[48:51]
    ds_read_b128 v[16:19], v8 offset:16384
    s_waitcnt lgkmcnt(7)
    v_mfma_f32_16x16x32_bf16 v[48:51], v[132:135], v[20:23], v[48:51]
    ds_read_b128 v[20:23], v8 offset:17408
    s_waitcnt lgkmcnt(7)
    v_mfma_f32_16x16x32_bf16 v[48:51], v[136:139], v[24:27], v[48:51]
    ds_read_b128 v[24:27], v8 offset:18432
    s_waitcnt lgkmcnt(7)
    v_mfma_f32_16x16x32_bf16 v[48:51], v[140:143], v[28:31], v[48:51]
    ds_read_b128 v[28:31], v8 offset:19456
    s_waitcnt lgkmcnt(7)
    v_mfma_f32_16x16x32_bf16 v[48:51], v[144:147], v[32:35], v[48:51]
    ds_read_b128 v[32:35], v8 offset:20480
    s_waitcnt lgkmcnt(7)
    v_mfma_f32_16x16x32_bf16 v[48:51], v[148:151], v[36:39], v[48:51]
    ds_read_b128 v[36:39], v8 offset:21504
    s_mov_b32 m0, s71
    s_add_u32 s71, s71, 8192
    buffer_load_dwordx4 v7, s[44:47], s70 offen sc1 lds
    s_add_u32 s70, s70, 8192
    s_waitcnt lgkmcnt(7)
    v_mfma_f32_16x16x32_bf16 v[48:51], v[152:155], v[40:43], v[48:51]
    ds_read_b128 v[40:43], v8 offset:22528
    s_waitcnt lgkmcnt(7)
    v_mfma_f32_16x16x32_bf16 v[48:51], v[156:159], v[44:47], v[48:51]
    ds_read_b128 v[44:47], v8 offset:23552
    s_waitcnt lgkmcnt(7)
    v_mfma_f32_16x16x32_bf16 v[48:51], v[160:163], v[16:19], v[48:51]
    ds_read_b128 v[16:19], v8 offset:24576
    s_waitcnt lgkmcnt(7)
    v_mfma_f32_16x16x32_bf16 v[48:51], v[164:167], v[20:23], v[48:51]
    ds_read_b128 v[20:23], v8 offset:25600
    s_waitcnt lgkmcnt(7)
    v_mfma_f32_16x16x32_bf16 v[48:51], v[168:171], v[24:27], v[48:51]
    ds_read_b128 v[24:27], v8 offset:26624
    s_waitcnt lgkmcnt(7)
    v_mfma_f32_16x16x32_bf16 v[48:51], v[172:175], v[28:31], v[48:51]
    ds_read_b128 v[28:31], v8 offset:27648
    s_mov_b32 m0, s71
    s_add_u32 s71, s71, 8192
    buffer_load_dwordx4 v7, s[44:47], s70 offen sc1 lds
    s_add_u32 s70, s70, 8192
    s_waitcnt lgkmcnt(7)
    v_mfma_f32_16x16x32_bf16 v[52:55], v[96:99], v[32:35], 0
    ds_read_b128 v[32:35], v8 offset:28672
    s_waitcnt lgkmcnt(7)
    v_mfma_f32_16x16x32_bf16 v[52:55], v[100:103], v[36:39], v[52:55]
    ds_read_b128 v[36:39], v8 offset:29696
    s_waitcnt lgkmcnt(7)
    v_mfma_f32_16x16x32_bf16 v[52:55], v[104:107], v[40:43], v[52:55]
    ds_read_b128 v[40:43], v8 offset:30720
    s_waitcnt lgkmcnt(7)
    v_mfma_f32_16x16x32_bf16 v[52:55], v[108:111], v[44:47], v[52:55]
    ds_read_b128 v[44:47], v8 offset:31744
    s_waitcnt lgkmcnt(7)
    v_mfma_f32_16x16x32_bf16 v[52:55], v[112:115], v[16:19], v[52:55]
    ds_read_b128 v[16:19], v8 offset:32768
    s_waitcnt lgkmcnt(7)
    v_mfma_f32_16x16x32_bf16 v[52:55], v[116:119], v[20:23], v[52:55]
    ds_read_b128 v[20:23], v8 offset:33792
    s_mov_b32 m0, s71
    s_add_u32 s71, s71, 8192
    buffer_load_dwordx4 v7, s[44:47], s70 offen sc1 lds
    s_add_u32 s70, s70, 8192
    s_waitcnt lgkmcnt(7)
    v_mfma_f32_16x16x32_bf16 v[52:55], v[120:123], v[24:27], v[52:55]
    ds_read_b128 v[24:27], v8 offset:34816
    s_waitcnt lgkmcnt(7)
    v_mfma_f32_16x16x32_bf16 v[52:55], v[124:127], v[28:31], v[52:55]
    ds_read_b128 v[28:31], v8 offset:35840
    s_waitcnt lgkmcnt(7)
    v_mfma_f32_16x16x32_bf16 v[52:55], v[128:131], v[32:35], v[52:55]
    ds_read_b128 v[32:35], v8 offset:36864
    s_waitcnt lgkmcnt(7)
    v_mfma_f32_16x16x32_bf16 v[52:55], v[132:135], v[36:39], v[52:55]
    ds_read_b128 v[36:39], v8 offset:37888
    s_waitcnt lgkmcnt(7)
    v_mfma_f32_16x16x32_bf16 v[52:55], v[136:139], v[40:43], v[52:55]
    ds_read_b128 v[40:43], v8 offset:38912
    s_waitcnt lgkmcnt(7)
    v_mfma_f32_16x16x32_bf16 v[52:55], v[140:143], v[44:47], v[52:55]
    ds_read_b128 v[44:47], v8 offset:39936
    s_waitcnt lgkmcnt(7)
    v_mfma_f32_16x16x32_bf16 v[52:55], v[144:147], v[16:19], v[52:55]
    s_waitcnt lgkmcnt(6)
    v_mfma_f32_16x16x32_bf16 v[52:55], v[148:151], v[20:23], v[52:55]
    s_waitcnt lgkmcnt(5)
    v_mfma_f32_16x16x32_bf16 v[52:55], v[152:155], v[24:27], v[52:55]
    s_waitcnt lgkmcnt(4)
    v_mfma_f32_16x16x32_bf16 v[52:55], v[156:159], v[28:31], v[52:55]
    s_waitcnt lgkmcnt(3)
    v_mfma_f32_16x16x32_bf16 v[52:55], v[160:163], v[32:35], v[52:55]
    s_waitcnt lgkmcnt(2)
    v_mfma_f32_16x16x32_bf16 v[52:55], v[164:167], v[36:39], v[52:55]
    s_waitcnt lgkmcnt(1)
    v_mfma_f32_16x16x32_bf16 v[52:55], v[168:171], v[40:43], v[52:55]
    s_waitcnt lgkmcnt(0)
    v_mfma_f32_16x16x32_bf16 v[52:55], v[172:175], v[44:47], v[52:55]
    s_nop 7
    v_cvt_pk_bf16_f32 v64, v48, v49
    v_cvt_pk_bf16_f32 v65, v50, v51
    v_cvt_pk_bf16_f32 v66, v52, v53
    v_cvt_pk_bf16_f32 v67, v54, v55
    buffer_store_dwordx2 v[64:65], v9, s[44:47], s74 offen sc1
    buffer_store_dwordx2 v[66:67], v10, s[44:47], s74 offen sc1
    s_mov_b32 s78, s73
    s_add_u32 s73, s73, 1
    s_cmp_ge_u32 s73, 64
    s_cbranch_scc1 xst_62
    s_cmp_lt_u32 s73, 6
    s_cbranch_scc1 xst_62
    s_waitcnt vmcnt(7)
    s_branch xb_63
L_v:
    s_lshr_b32 s63, s4, 1
    s_and_b32 s64, s4, 1
    s_lshl_b32 s64, s64, 3
    s_add_u32 s64, s64, s5
    s_sub_u32 s64, s64, 12
    s_cmp_lt_u32 s64, 9
    s_cbranch_scc0 r2_66
    s_mul_i32 s65, s64, 86
    s_lshr_b32 s65, s65, 8
    s_mul_i32 s15, s65, 9
    s_add_u32 s15, s15, s64
    s_mul_i32 s63, s63, 3
    s_add_u32 s15, s15, s63
    s_branch r2_67
r2_66:
    s_mul_i32 s63, s63, 7
    s_add_u32 s63, s63, s64
    s_sub_u32 s63, s63, 9
    s_mul_i32 s65, s63, 52
    s_lshr_b32 s65, s65, 8
    s_mul_i32 s64, s65, 5
    s_sub_u32 s64, s63, s64
    s_mul_i32 s15, s64, 5
    s_add_u32 s15, s15, s65
    s_add_u32 s15, s15, 36
    s_add_u32 s64, s63, 36
    s_cmp_lt_u32 s63, 0
    s_cselect_b32 s15, s15, s64
r2_67:
    s_lshl_b32 s63, s15, 7
    s_add_u32 s63, s63, 156827648
    s_cmp_eq_u32 s3, 0
    s_cbranch_scc0 fi_68
    v_mov_b32 v2, 0
    buffer_store_dword v2, v2, s[44:47], s63 offen sc1
fi_68:
    s_sub_u32 s60, s5, 16
    s_lshl_b32 s61, s4, 2
    s_add_u32 s61, s61, s60
    s_mul_i32 s62, s61, 384
    s_cmp_lt_u32 s3, 4
    s_cbranch_scc0 pw_69
    v_lshrrev_b32 v11, 4, v1
    v_mul_u32_u24 v10, 3072, v11
    v_bfe_u32 v11, v1, 2, 2
    v_mul_u32_u24 v11, 384, v11
    v_add_u32 v10, v10, v11
    v_and_b32 v11, 3, v1
    v_mul_u32_u24 v11, 8, v11
    v_add_u32 v10, v10, v11
    s_lshl_b32 s63, s3, 6
    s_branch pw_70
pw_69:
    v_lshrrev_b32 v11, 4, v1
    v_mul_u32_u24 v10, 3072, v11
    v_bfe_u32 v11, v1, 2, 2
    v_mul_u32_u24 v11, 384, v11
    v_add_u32 v10, v10, v11
    v_and_b32 v11, 3, v1
    v_mul_u32_u24 v11, 8, v11
    v_add_u32 v10, v10, v11
    s_lshl_b32 s63, s3, 5
    s_add_u32 s63, s63, 128
pw_70:
    v_add_u32 v10, s63, v10
    s_mov_b32 s48, s24
    s_and_b32 s49, s25, 0xffff
    s_mov_b32 s50, 0x780000
    s_mov_b32 s51, 0x00020000
    v_add_u32 v5, 0, v1
    v_mul_u32_u24 v6, 2731, v5
    v_lshrrev_b32 v6, 16, v6
    v_mul_u32_u24 v2, 11904, v6
    v_lshlrev_b32 v5, 4, v5
    v_add_u32 v2, v2, v5
    v_add_u32 v5, 64, v1
    v_mul_u32_u24 v6, 2731, v5
    v_lshrrev_b32 v6, 16, v6
    v_mul_u32_u24 v3, 11904, v6
    v_lshlrev_b32 v5, 4, v5
    v_add_u32 v3, v3, v5
    v_add_u32 v5, 128, v1
    v_mul_u32_u24 v6, 2731, v5
    v_lshrrev_b32 v6, 16, v6
    v_mul_u32_u24 v4, 11904, v6
    v_lshlrev_b32 v5, 4, v5
    v_add_u32 v4, v4, v5
    s_mul_i32 s63, s3, 3072
    s_add_u32 s63, s63, 0
    s_mul_i32 s64, s3, 98304
    s_add_u32 s64, s64, s62
    s_add_u32 s64, s64, 0
    s_mov_b32 m0, s63
    s_add_u32 s63, s63, 1024
    buffer_load_dwordx4 v2, s[48:51], s64 offen lds
    s_mov_b32 m0, s63
    s_add_u32 s63, s63, 1024
    buffer_load_dwordx4 v3, s[48:51], s64 offen lds
    s_mov_b32 m0, s63
    s_add_u32 s63, s63, 22528
    buffer_load_dwordx4 v4, s[48:51], s64 offen lds
    s_add_u32 s64, s64, 786432
    s_mov_b32 m0, s63
    s_add_u32 s63, s63, 1024
    buffer_load_dwordx4 v2, s[48:51], s64 offen lds
    s_mov_b32 m0, s63
    s_add_u32 s63, s63, 1024
    buffer_load_dwordx4 v3, s[48:51], s64 offen lds
    s_mov_b32 m0, s63
    s_add_u32 s63, s63, 22528
    buffer_load_dwordx4 v4, s[48:51], s64 offen lds
    s_add_u32 s64, s64, 786432
    s_waitcnt vmcnt(6)
    s_barrier
    s_cmp_eq_u32 s3, 0
    s_cbranch_scc0 arr_71
    s_getreg_b32 s12, hwreg(HW_REG_XCC_ID)
    s_and_b32 s12, s12, 15
    s_cmp_gt_u32 s12, 7
    s_cselect_b32 s13, s14, 0
    s_lshr_b32 s13, s13, 3
    s_add_u32 s12, s12, s13
    s_sub_u32 s12, s12, s14
    s_and_b32 s12, s12, 7
    s_mul_i32 s13, s12, s12
    s_lshl_b32 s12, s12, 9
    s_or_b32 s12, s12, 1
    v_mov_b32 v12, s12
    v_mov_b32 v13, s13
    v_mov_b32 v14, 1073741824
    v_cmp_eq_u32 vcc, 0, v1
    s_nop 1
    v_cndmask_b32 v14, v14, v1, vcc
    buffer_atomic_add_x2 v[12:13], v14, s[56:59], s10 offen sc1
arr_71:
    s_mul_i32 s63, s3, 3072
    s_add_u32 s63, s63, 49152
    s_mul_i32 s64, s3, 98304
    s_add_u32 s64, s64, s62
    s_add_u32 s64, s64, 1572864
    s_mov_b32 m0, s63
    s_add_u32 s63, s63, 1024
    buffer_load_dwordx4 v2, s[48:51], s64 offen lds
    s_mov_b32 m0, s63
    s_add_u32 s63, s63, 1024
    buffer_load_dwordx4 v3, s[48:51], s64 offen lds
    s_mov_b32 m0, s63
    s_add_u32 s63, s63, 22528
    buffer_load_dwordx4 v4, s[48:51], s64 offen lds
    s_add_u32 s64, s64, 786432
    s_mov_b32 m0, s63
    s_add_u32 s63, s63, 1024
    buffer_load_dwordx4 v2, s[48:51], s64 offen lds
    s_mov_b32 m0, s63
    s_add_u32 s63, s63, 1024
    buffer_load_dwordx4 v3, s[48:51], s64 offen lds
    s_mov_b32 m0, s63
    s_add_u32 s63, s63, 22528
    buffer_load_dwordx4 v4, s[48:51], s64 offen lds
    s_add_u32 s64, s64, 786432
    s_mul_i32 s63, s3, 3072
    s_add_u32 s63, s63, 98304
    s_mul_i32 s64, s3, 98304
    s_add_u32 s64, s64, s62
    s_add_u32 s64, s64, 3145728
    s_mov_b32 m0, s63
    s_add_u32 s63, s63, 1024
    buffer_load_dwordx4 v2, s[48:51], s64 offen lds
    s_mov_b32 m0, s63
    s_add_u32 s63, s63, 1024
    buffer_load_dwordx4 v3, s[48:51], s64 offen lds
    s_mov_b32 m0, s63
    s_add_u32 s63, s63, 22528
    buffer_load_dwordx4 v4, s[48:51], s64 offen lds
    s_add_u32 s64, s64, 786432
    s_mov_b32 m0, s63
    s_add_u32 s63, s63, 1024
    buffer_load_dwordx4 v2, s[48:51], s64 offen lds
    s_mov_b32 m0, s63
    s_add_u32 s63, s63, 1024
    buffer_load_dwordx4 v3, s[48:51], s64 offen lds
    s_mov_b32 m0, s63
    s_add_u32 s63, s63, 22528
    buffer_load_dwordx4 v4, s[48:51], s64 offen lds
    s_add_u32 s64, s64, 786432
    s_waitcnt vmcnt(12)
    s_barrier
    s_cmp_lt_u32 s3, 4
    s_cbranch_scc0 rd_72
    v_add_u32 v11, 0, v10
    ds_read_b64_tr_b16 v[96:97], v11 offset:0
    ds_read_b64_tr_b16 v[98:99], v11 offset:1536
    ds_read_b64_tr_b16 v[176:177], v11 offset:32
    ds_read_b64_tr_b16 v[178:179], v11 offset:1568
    ds_read_b64_tr_b16 v[100:101], v11 offset:12288
    ds_read_b64_tr_b16 v[102:103], v11 offset:13824
    ds_read_b64_tr_b16 v[180:181], v11 offset:12320
    ds_read_b64_tr_b16 v[182:183], v11 offset:13856
    s_waitcnt lgkmcnt(6)
    ds_read_b64_tr_b16 v[104:105], v11 offset:24576
    ds_read_b64_tr_b16 v[106:107], v11 offset:26112
    ds_read_b64_tr_b16 v[184:185], v11 offset:24608
    ds_read_b64_tr_b16 v[186:187], v11 offset:26144
    ds_read_b64_tr_b16 v[108:109], v11 offset:36864
    ds_read_b64_tr_b16 v[110:111], v11 offset:38400
    ds_read_b64_tr_b16 v[188:189], v11 offset:36896
    ds_read_b64_tr_b16 v[190:191], v11 offset:38432
    s_waitcnt lgkmcnt(6)
rd_72:
    s_cmp_lt_u32 s3, 4
    s_cbranch_scc1 rd_73
    v_add_u32 v11, 0, v10
    ds_read_b64_tr_b16 v[96:97], v11 offset:0
    ds_read_b64_tr_b16 v[98:99], v11 offset:1536
    ds_read_b64_tr_b16 v[100:101], v11 offset:12288
    ds_read_b64_tr_b16 v[102:103], v11 offset:13824
    ds_read_b64_tr_b16 v[104:105], v11 offset:24576
    ds_read_b64_tr_b16 v[106:107], v11 offset:26112
    ds_read_b64_tr_b16 v[108:109], v11 offset:36864
    ds_read_b64_tr_b16 v[110:111], v11 offset:38400
    s_waitcnt lgkmcnt(6)
rd_73:
    s_waitcnt lgkmcnt(0)
    s_barrier
    s_mul_i32 s63, s3, 3072
    s_add_u32 s63, s63, 0
    s_mul_i32 s64, s3, 98304
    s_add_u32 s64, s64, s62
    s_add_u32 s64, s64, 4718592
    s_mov_b32 m0, s63
    s_add_u32 s63, s63, 1024
    buffer_load_dwordx4 v2, s[48:51], s64 offen lds
    s_mov_b32 m0, s63
    s_add_u32 s63, s63, 1024
    buffer_load_dwordx4 v3, s[48:51], s64 offen lds
    s_mov_b32 m0, s63
    s_add_u32 s63, s63, 22528
    buffer_load_dwordx4 v4, s[48:51], s64 offen lds
    s_add_u32 s64, s64, 786432
    s_mov_b32 m0, s63
    s_add_u32 s63, s63, 1024
    buffer_load_dwordx4 v2, s[48:51], s64 offen lds
    s_mov_b32 m0, s63
    s_add_u32 s63, s63, 1024
    buffer_load_dwordx4 v3, s[48:51], s64 offen lds
    s_mov_b32 m0, s63
    s_add_u32 s63, s63, 22528
    buffer_load_dwordx4 v4, s[48:51], s64 offen lds
    s_add_u32 s64, s64, 786432
    s_waitcnt vmcnt(12)
    s_barrier
    s_cmp_lt_u32 s3, 4
    s_cbranch_scc0 rd_74
    v_add_u32 v11, 49152, v10
    ds_read_b64_tr_b16 v[112:113], v11 offset:0
    ds_read_b64_tr_b16 v[114:115], v11 offset:1536
    ds_read_b64_tr_b16 v[192:193], v11 offset:32
    ds_read_b64_tr_b16 v[194:195], v11 offset:1568
    ds_read_b64_tr_b16 v[116:117], v11 offset:12288
    ds_read_b64_tr_b16 v[118:119], v11 offset:13824
    ds_read_b64_tr_b16 v[196:197], v11 offset:12320
    ds_read_b64_tr_b16 v[198:199], v11 offset:13856
    s_waitcnt lgkmcnt(6)
    ds_read_b64_tr_b16 v[120:121], v11 offset:24576
    ds_read_b64_tr_b16 v[122:123], v11 offset:26112
    ds_read_b64_tr_b16 v[200:201], v11 offset:24608
    ds_read_b64_tr_b16 v[202:203], v11 offset:26144
    ds_read_b64_tr_b16 v[124:125], v11 offset:36864
    ds_read_b64_tr_b16 v[126:127], v11 offset:38400
    ds_read_b64_tr_b16 v[204:205], v11 offset:36896
    ds_read_b64_tr_b16 v[206:207], v11 offset:38432
    s_waitcnt lgkmcnt(6)
rd_74:
    s_cmp_lt_u32 s3, 4
    s_cbranch_scc1 rd_75
    v_add_u32 v11, 49152, v10
    ds_read_b64_tr_b16 v[112:113], v11 offset:0
    ds_read_b64_tr_b16 v[114:115], v11 offset:1536
    ds_read_b64_tr_b16 v[116:117], v11 offset:12288
    ds_read_b64_tr_b16 v[118:119], v11 offset:13824
    ds_read_b64_tr_b16 v[120:121], v11 offset:24576
    ds_read_b64_tr_b16 v[122:123], v11 offset:26112
    ds_read_b64_tr_b16 v[124:125], v11 offset:36864
    ds_read_b64_tr_b16 v[126:127], v11 offset:38400
    s_waitcnt lgkmcnt(6)
rd_75:
    s_waitcnt lgkmcnt(0)
    s_barrier
    s_mul_i32 s63, s3, 3072
    s_add_u32 s63, s63, 49152
    s_mul_i32 s64, s3, 98304
    s_add_u32 s64, s64, s62
    s_add_u32 s64, s64, 6291456
    s_mov_b32 m0, s63
    s_add_u32 s63, s63, 1024
    buffer_load_dwordx4 v2, s[48:51], s64 offen lds
    s_mov_b32 m0, s63
    s_add_u32 s63, s63, 1024
    buffer_load_dwordx4 v3, s[48:51], s64 offen lds
    s_mov_b32 m0, s63
    s_add_u32 s63, s63, 22528
    buffer_load_dwordx4 v4, s[48:51], s64 offen lds
    s_add_u32 s64, s64, 786432
    s_mov_b32 m0, s63
    s_add_u32 s63, s63, 1024
    buffer_load_dwordx4 v2, s[48:51], s64 offen lds
    s_mov_b32 m0, s63
    s_add_u32 s63, s63, 1024
    buffer_load_dwordx4 v3, s[48:51], s64 offen lds
    s_mov_b32 m0, s63
    s_add_u32 s63, s63, 22528
    buffer_load_dwordx4 v4, s[48:51], s64 offen lds
    s_add_u32 s64, s64, 786432
    s_waitcnt vmcnt(12)
    s_barrier
    s_cmp_lt_u32 s3, 4
    s_cbranch_scc0 rd_76
    v_add_u32 v11, 98304, v10
    ds_read_b64_tr_b16 v[128:129], v11 offset:0
    ds_read_b64_tr_b16 v[130:131], v11 offset:1536
    ds_read_b64_tr_b16 v[208:209], v11 offset:32
    ds_read_b64_tr_b16 v[210:211], v11 offset:1568
    ds_read_b64_tr_b16 v[132:133], v11 offset:12288
    ds_read_b64_tr_b16 v[134:135], v11 offset:13824
    ds_read_b64_tr_b16 v[212:213], v11 offset:12320
    ds_read_b64_tr_b16 v[214:215], v11 offset:13856
    s_waitcnt lgkmcnt(6)
    ds_read_b64_tr_b16 v[136:137], v11 offset:24576
    ds_read_b64_tr_b16 v[138:139], v11 offset:26112
    ds_read_b64_tr_b16 v[216:217], v11 offset:24608
    ds_read_b64_tr_b16 v[218:219], v11 offset:26144
    ds_read_b64_tr_b16 v[140:141], v11 offset:36864
    ds_read_b64_tr_b16 v[142:143], v11 offset:38400
    ds_read_b64_tr_b16 v[220:221], v11 offset:36896
    ds_read_b64_tr_b16 v[222:223], v11 offset:38432
    s_waitcnt lgkmcnt(6)
rd_76:
    s_cmp_lt_u32 s3, 4
    s_cbranch_scc1 rd_77
    v_add_u32 v11, 98304, v10
    ds_read_b64_tr_b16 v[128:129], v11 offset:0
    ds_read_b64_tr_b16 v[130:131], v11 offset:1536
    ds_read_b64_tr_b16 v[132:133], v11 offset:12288
    ds_read_b64_tr_b16 v[134:135], v11 offset:13824
    ds_read_b64_tr_b16 v[136:137], v11 offset:24576
    ds_read_b64_tr_b16 v[138:139], v11 offset:26112
    ds_read_b64_tr_b16 v[140:141], v11 offset:36864
    ds_read_b64_tr_b16 v[142:143], v11 offset:38400
    s_waitcnt lgkmcnt(6)
rd_77:
    s_waitcnt lgkmcnt(0)
    s_barrier
    s_waitcnt vmcnt(6)
    s_barrier
    s_cmp_lt_u32 s3, 4
    s_cbranch_scc0 rd_78
    v_add_u32 v11, 0, v10
    ds_read_b64_tr_b16 v[144:145], v11 offset:0
    ds_read_b64_tr_b16 v[146:147], v11 offset:1536
    ds_read_b64_tr_b16 v[224:225], v11 offset:32
    ds_read_b64_tr_b16 v[226:227], v11 offset:1568
    ds_read_b64_tr_b16 v[148:149], v11 offset:12288
    ds_read_b64_tr_b16 v[150:151], v11 offset:13824
    ds_read_b64_tr_b16 v[228:229], v11 offset:12320
    ds_read_b64_tr_b16 v[230:231], v11 offset:13856
    s_waitcnt lgkmcnt(6)
    ds_read_b64_tr_b16 v[152:153], v11 offset:24576
    ds_read_b64_tr_b16 v[154:155], v11 offset:26112
    ds_read_b64_tr_b16 v[232:233], v11 offset:24608
    ds_read_b64_tr_b16 v[234:235], v11 offset:26144
    ds_read_b64_tr_b16 v[156:157], v11 offset:36864
    ds_read_b64_tr_b16 v[158:159], v11 offset:38400
    ds_read_b64_tr_b16 v[236:237], v11 offset:36896
    ds_read_b64_tr_b16 v[238:239], v11 offset:38432
    s_waitcnt lgkmcnt(6)
rd_78:
    s_cmp_lt_u32 s3, 4
    s_cbranch_scc1 rd_79
    v_add_u32 v11, 0, v10
    ds_read_b64_tr_b16 v[144:145], v11 offset:0
    ds_read_b64_tr_b16 v[146:147], v11 offset:1536
    ds_read_b64_tr_b16 v[148:149], v11 offset:12288
    ds_read_b64_tr_b16 v[150:151], v11 offset:13824
    ds_read_b64_tr_b16 v[152:153], v11 offset:24576
    ds_read_b64_tr_b16 v[154:155], v11 offset:26112
    ds_read_b64_tr_b16 v[156:157], v11 offset:36864
    ds_read_b64_tr_b16 v[158:159], v11 offset:38400
    s_waitcnt lgkmcnt(6)
rd_79:
    s_waitcnt lgkmcnt(0)
    s_barrier
    s_waitcnt vmcnt(0)
    s_barrier
    s_cmp_lt_u32 s3, 4
    s_cbranch_scc0 rd_80
    v_add_u32 v11, 49152, v10
    ds_read_b64_tr_b16 v[160:161], v11 offset:0
    ds_read_b64_tr_b16 v[162:163], v11 offset:1536
    ds_read_b64_tr_b16 v[240:241], v11 offset:32
    ds_read_b64_tr_b16 v[242:243], v11 offset:1568
    ds_read_b64_tr_b16 v[164:165], v11 offset:12288
    ds_read_b64_tr_b16 v[166:167], v11 offset:13824
    ds_read_b64_tr_b16 v[244:245], v11 offset:12320
    ds_read_b64_tr_b16 v[246:247], v11 offset:13856
    s_waitcnt lgkmcnt(6)
    ds_read_b64_tr_b16 v[168:169], v11 offset:24576
    ds_read_b64_tr_b16 v[170:171], v11 offset:26112
    ds_read_b64_tr_b16 v[248:249], v11 offset:24608
    ds_read_b64_tr_b16 v[250:251], v11 offset:26144
    ds_read_b64_tr_b16 v[172:173], v11 offset:36864
    ds_read_b64_tr_b16 v[174:175], v11 offset:38400
    ds_read_b64_tr_b16 v[252:253], v11 offset:36896
    ds_read_b64_tr_b16 v[254:255], v11 offset:38432
    s_waitcnt lgkmcnt(6)
rd_80:
    s_cmp_lt_u32 s3, 4
    s_cbranch_scc1 rd_81
    v_add_u32 v11, 49152, v10
    ds_read_b64_tr_b16 v[160:161], v11 offset:0
    ds_read_b64_tr_b16 v[162:163], v11 offset:1536
    ds_read_b64_tr_b16 v[164:165], v11 offset:12288
    ds_read_b64_tr_b16 v[166:167], v11 offset:13824
    ds_read_b64_tr_b16 v[168:169], v11 offset:24576
    ds_read_b64_tr_b16 v[170:171], v11 offset:26112
    ds_read_b64_tr_b16 v[172:173], v11 offset:36864
    ds_read_b64_tr_b16 v[174:175], v11 offset:38400
    s_waitcnt lgkmcnt(6)
rd_81:
    s_waitcnt lgkmcnt(0)
    s_barrier
    v_mov_b32 v8, 0
    s_cmp_eq_u32 s3, 0
    s_cbranch_scc0 wao_84
    s_mov_b32 s76, 1000000
wa_82:
    buffer_load_dword v9, v8, s[56:59], s10 offen offset:128 sc1
    s_sub_u32 s76, s76, 1
    s_cbranch_scc1 wad_83
    s_waitcnt vmcnt(0)
    v_readfirstlane_b32 s63, v9
    s_cmp_lg_u32 s63, 0
    s_cbranch_scc1 wad_83
    s_sleep 2
    s_branch wa_82
wad_83:
    s_waitcnt vmcnt(0)
    ds_write_b32 v8, v9
    s_waitcnt lgkmcnt(0)
wao_84:
    s_barrier
    ds_read_b32 v9, v8
    s_waitcnt lgkmcnt(0)
    v_readfirstlane_b32 s63, v9
    s_cmp_lg_u32 s63, 1
    s_cselect_b32 s6, 1, 0
    s_waitcnt vmcnt(0)
    s_barrier
    s_cbranch_scc0 wak_85
    s_cmp_eq_u32 s10, 0
    s_mov_b32 s10, 16
    s_cbranch_scc1 L_restart
wak_85:
    v_lshlrev_b32 v7, 4, v1
    s_mul_i32 s63, s61, 12288
    s_add_u32 s63, s63, 29360128
    v_mov_b32 v11, v7
    s_cmp_lt_u32 s3, 4
    s_cbranch_scc0 kv_86
    s_lshl_b32 s64, s3, 11
    s_branch kv_87
kv_86:
    s_sub_u32 s65, s3, 4
    s_add_u32 s64, s65, 8
    s_lshl_b32 s64, s64, 10
kv_87:
    s_add_u32 s63, s63, s64
    v_add_u32 v9, s63, v11
    v_add_u32 v10, 6144, v9
    v_lshrrev_b32 v12, 1, v1
    v_and_b32 v13, 1, v1
    v_lshlrev_b32 v13, 7, v13
    s_cmp_lt_u32 s15, 36
    s_cbranch_scc0 ft_88
    s_mov_b32 s48, s32
    s_and_b32 s49, s33, 0xffff
    s_mov_b32 s50, 0x1e0000
    s_mov_b32 s51, 0x00020000
    s_mov_b32 s52, s34
    s_and_b32 s53, s35, 0xffff
    s_mov_b32 s54, 0x1e0000
    s_mov_b32 s55, 0x00020000
    s_mul_i32 s63, s15, 43
    s_lshr_b32 s63, s63, 9
    s_mul_i32 s63, s63, 12
    s_sub_u32 s63, s15, s63
    v_mul_u32_u24 v12, 3072, v12
    s_mov_b32 s66, 98304
    s_mov_b32 s67, 0
    s_branch ft_89
ft_88:
    s_mov_b32 s48, s36
    s_and_b32 s49, s37, 0xffff
    s_mov_b32 s50, 0x1e0000
    s_mov_b32 s51, 0x00020000
    s_mov_b32 s52, s36
    s_and_b32 s53, s37, 0xffff
    s_mov_b32 s54, 0x1e0000
    s_mov_b32 s55, 0x00020000
    s_sub_u32 s63, s15, 36
    s_mul_i32 s64, s63, 52
    s_lshr_b32 s64, s64, 8
    s_mul_i32 s64, s64, 5
    s_sub_u32 s63, s63, s64
    v_mul_u32_u24 v12, 1280, v12
    s_mov_b32 s66, 40960
    s_mov_b32 s67, 983040
ft_89:
    s_lshl_b32 s63, s63, 8
    v_add3_u32 v12, v12, v13, s63
    v_lshlrev_b32 v7, 4, v1
    s_mov_b32 s73, 0
    s_add_u32 s70, s73, 0
    s_mul_i32 s70, s70, 40960
    s_mov_b32 s71, 0
    s_lshl_b32 s63, s3, 10
    s_add_u32 s64, s63, s70
    s_add_u32 s63, s63, s71
    s_mov_b32 m0, s63
    s_add_u32 s63, s63, 8192
    buffer_load_dwordx4 v7, s[44:47], s64 offen sc1 lds
    s_add_u32 s64, s64, 8192
    s_mov_b32 m0, s63
    s_add_u32 s63, s63, 8192
    buffer_load_dwordx4 v7, s[44:47], s64 offen sc1 lds
    s_add_u32 s64, s64, 8192
    s_mov_b32 m0, s63
    s_add_u32 s63, s63, 8192
    buffer_load_dwordx4 v7, s[44:47], s64 offen sc1 lds
    s_add_u32 s64, s64, 8192
    s_mov_b32 m0, s63
    s_add_u32 s63, s63, 8192
    buffer_load_dwordx4 v7, s[44:47], s64 offen sc1 lds
    s_add_u32 s64, s64, 8192
    s_mov_b32 m0, s63
    s_add_u32 s63, s63, 8192
    buffer_load_dwordx4 v7, s[44:47], s64 offen sc1 lds
    s_add_u32 s64, s64, 8192
    s_add_u32 s70, s70, 40960
    s_mov_b32 s71, 40960
    s_lshl_b32 s63, s3, 10
    s_add_u32 s64, s63, s70
    s_add_u32 s63, s63, s71
    s_mov_b32 m0, s63
    s_add_u32 s63, s63, 8192
    buffer_load_dwordx4 v7, s[44:47], s64 offen sc1 lds
    s_add_u32 s64, s64, 8192
    s_mov_b32 m0, s63
    s_add_u32 s63, s63, 8192
    buffer_load_dwordx4 v7, s[44:47], s64 offen sc1 lds
    s_add_u32 s64, s64, 8192
    s_mov_b32 m0, s63
    s_add_u32 s63, s63, 8192
    buffer_load_dwordx4 v7, s[44:47], s64 offen sc1 lds
    s_add_u32 s64, s64, 8192
    s_mov_b32 m0, s63
    s_add_u32 s63, s63, 8192
    buffer_load_dwordx4 v7, s[44:47], s64 offen sc1 lds
    s_add_u32 s64, s64, 8192
    s_mov_b32 m0, s63
    s_add_u32 s63, s63, 8192
    buffer_load_dwordx4 v7, s[44:47], s64 offen sc1 lds
    s_add_u32 s64, s64, 8192
    s_mov_b32 s79, 0
    s_mov_b32 s80, 81920
    s_cmp_lt_u32 s3, 4
    s_cbranch_scc0 xp_90
    s_setprio 1
xp_90:
    s_waitcnt vmcnt(5)
    s_mov_b32 s78, s73
    s_branch xb_93
xst_92:
    s_waitcnt vmcnt(0)
    s_mov_b32 s78, s73
    .p2align 6
xb_93:
    s_barrier
    s_cmp_eq_u32 s3, 0
    s_cbranch_scc0 fs_94
    v_mov_b32 v2, 0
    v_mov_b32 v3, s78
    buffer_store_dword v3, v2, s[44:47], s8 offen sc1
fs_94:
    s_cmp_ge_u32 s73, 64
    s_cbranch_scc1 L_ph2
    s_add_u32 s72, s73, 2
    s_min_u32 s72, s72, 63
    s_mul_i32 s70, s72, 40960
    s_lshl_b32 s63, s3, 10
    s_add_u32 s70, s70, s63
    v_add_u32 v8, s79, v7
    s_add_u32 s71, s80, s63
    s_mov_b32 s80, s79
    s_add_u32 s79, s79, 40960
    s_cmp_eq_u32 s79, 122880
    s_cselect_b32 s79, 0, s79
    s_cmp_eq_u32 s3, 7
    s_cbranch_scc0 xt_95
    s_sub_u32 s64, s73, 38
    s_cmp_lt_u32 s64, 24
    s_cbranch_scc0 xt_95
    s_mul_i32 s64, s64, s66
    s_add_u32 s65, s64, s67
    buffer_load_dword v13, v12, s[48:51], s64 offen
    buffer_load_dword v13, v12, s[52:55], s65 offen
xt_95:
    s_cmp_lt_u32 s3, 4
    s_cbranch_scc0 xs_91
    s_mul_i32 s74, s73, 393216
    ds_read_b128 v[16:19], v8 offset:0
    ds_read_b128 v[20:23], v8 offset:1024
    ds_read_b128 v[24:27], v8 offset:2048
    ds_read_b128 v[28:31], v8 offset:3072
    ds_read_b128 v[32:35], v8 offset:4096
    ds_read_b128 v[36:39], v8 offset:5120
    ds_read_b128 v[40:43], v8 offset:6144
    ds_read_b128 v[44:47], v8 offset:7168
    s_waitcnt lgkmcnt(7)
    v_mfma_f32_16x16x32_bf16 v[48:51], v[16:19], v[96:99], 0
    v_mfma_f32_16x16x32_bf16 v[52:55], v[16:19], v[176:179], 0
    ds_read_b128 v[16:19], v8 offset:8192
    s_waitcnt lgkmcnt(7)
    v_mfma_f32_16x16x32_bf16 v[48:51], v[20:23], v[100:103], v[48:51]
    v_mfma_f32_16x16x32_bf16 v[52:55], v[20:23], v[180:183], v[52:55]
    ds_read_b128 v[20:23], v8 offset:9216
    s_mov_b32 m0, s71
    s_add_u32 s71, s71, 8192
    buffer_load_dwordx4 v7, s[44:47], s70 offen sc1 lds
    s_add_u32 s70, s70, 8192
    s_waitcnt lgkmcnt(7)
    v_mfma_f32_16x16x32_bf16 v[48:51], v[24:27], v[104:107], v[48:51]
    v_mfma_f32_16x16x32_bf16 v[52:55], v[24:27], v[184:187], v[52:55]
    ds_read_b128 v[24:27], v8 offset:10240
    s_waitcnt lgkmcnt(7)
    v_mfma_f32_16x16x32_bf16 v[48:51], v[28:31], v[108:111], v[48:51]
    v_mfma_f32_16x16x32_bf16 v[52:55], v[28:31], v[188:191], v[52:55]
    ds_read_b128 v[28:31], v8 offset:11264
    s_waitcnt lgkmcnt(7)
    v_mfma_f32_16x16x32_bf16 v[48:51], v[32:35], v[112:115], v[48:51]
    v_mfma_f32_16x16x32_bf16 v[52:55], v[32:35], v[192:195], v[52:55]
    ds_read_b128 v[32:35], v8 offset:12288
    s_waitcnt lgkmcnt(7)
    v_mfma_f32_16x16x32_bf16 v[48:51], v[36:39], v[116:119], v[48:51]
    v_mfma_f32_16x16x32_bf16 v[52:55], v[36:39], v[196:199], v[52:55]
    ds_read_b128 v[36:39], v8 offset:13312
    s_waitcnt lgkmcnt(7)
    v_mfma_f32_16x16x32_bf16 v[48:51], v[40:43], v[120:123], v[48:51]
    v_mfma_f32_16x16x32_bf16 v[52:55], v[40:43], v[200:203], v[52:55]
    ds_read_b128 v[40:43], v8 offset:14336
    s_waitcnt lgkmcnt(7)
    v_mfma_f32_16x16x32_bf16 v[48:51], v[44:47], v[124:127], v[48:51]
    v_mfma_f32_16x16x32_bf16 v[52:55], v[44:47], v[204:207], v[52:55]
    ds_read_b128 v[44:47], v8 offset:15360
    s_mov_b32 m0, s71
    s_add_u32 s71, s71, 8192
    buffer_load_dwordx4 v7, s[44:47], s70 offen sc1 lds
    s_add_u32 s70, s70, 8192
    s_waitcnt lgkmcnt(7)
    v_mfma_f32_16x16x32_bf16 v[48:51], v[16:19], v[128:131], v[48:51]
    v_mfma_f32_16x16x32_bf16 v[52:55], v[16:19], v[208:211], v[52:55]
    ds_read_b128 v[16:19], v8 offset:16384
    s_waitcnt lgkmcnt(7)
    v_mfma_f32_16x16x32_bf16 v[48:51], v[20:23], v[132:135], v[48:51]
    v_mfma_f32_16x16x32_bf16 v[52:55], v[20:23], v[212:215], v[52:55]
    ds_read_b128 v[20:23], v8 offset:17408
    s_waitcnt lgkmcnt(7)
    v_mfma_f32_16x16x32_bf16 v[48:51], v[24:27], v[136:139], v[48:51]
    v_mfma_f32_16x16x32_bf16 v[52:55], v[24:27], v[216:219], v[52:55]
    ds_read_b128 v[24:27], v8 offset:18432
    s_waitcnt lgkmcnt(7)
    v_mfma_f32_16x16x32_bf16 v[48:51], v[28:31], v[140:143], v[48:51]
    v_mfma_f32_16x16x32_bf16 v[52:55], v[28:31], v[220:223], v[52:55]
    ds_read_b128 v[28:31], v8 offset:19456
    s_waitcnt lgkmcnt(7)
    v_mfma_f32_16x16x32_bf16 v[48:51], v[32:35], v[144:147], v[48:51]
    v_mfma_f32_16x16x32_bf16 v[52:55], v[32:35], v[224:227], v[52:55]
    ds_read_b128 v[32:35], v8 offset:20480
    s_waitcnt lgkmcnt(7)
    v_mfma_f32_16x16x32_bf16 v[48:51], v[36:39], v[148:151], v[48:51]
    v_mfma_f32_16x16x32_bf16 v[52:55], v[36:39], v[228:231], v[52:55]
    ds_read_b128 v[36:39], v8 offset:21504
    s_mov_b32 m0, s71
    s_add_u32 s71, s71, 8192
    buffer_load_dwordx4 v7, s[44:47], s70 offen sc1 lds
    s_add_u32 s70, s70, 8192
    s_waitcnt lgkmcnt(7)
    v_mfma_f32_16x16x32_bf16 v[48:51], v[40:43], v[152:155], v[48:51]
    v_mfma_f32_16x16x32_bf16 v[52:55], v[40:43], v[232:235], v[52:55]
    ds_read_b128 v[40:43], v8 offset:22528
    s_waitcnt lgkmcnt(7)
    v_mfma_f32_16x16x32_bf16 v[48:51], v[44:47], v[156:159], v[48:51]
    v_mfma_f32_16x16x32_bf16 v[52:55], v[44:47], v[236:239], v[52:55]
    ds_read_b128 v[44:47], v8 offset:23552
    s_waitcnt lgkmcnt(7)
    v_mfma_f32_16x16x32_bf16 v[48:51], v[16:19], v[160:163], v[48:51]
    v_mfma_f32_16x16x32_bf16 v[52:55], v[16:19], v[240:243], v[52:55]
    ds_read_b128 v[16:19], v8 offset:24576
    s_waitcnt lgkmcnt(7)
    v_mfma_f32_16x16x32_bf16 v[48:51], v[20:23], v[164:167], v[48:51]
    v_mfma_f32_16x16x32_bf16 v[52:55], v[20:23], v[244:247], v[52:55]
    ds_read_b128 v[20:23], v8 offset:25600
    s_waitcnt lgkmcnt(7)
    v_mfma_f32_16x16x32_bf16 v[48:51], v[24:27], v[168:171], v[48:51]
    v_mfma_f32_16x16x32_bf16 v[52:55], v[24:27], v[248:251], v[52:55]
    ds_read_b128 v[24:27], v8 offset:26624
    s_waitcnt lgkmcnt(7)
    v_mfma_f32_16x16x32_bf16 v[48:51], v[28:31], v[172:175], v[48:51]
    v_mfma_f32_16x16x32_bf16 v[52:55], v[28:31], v[252:255], v[52:55]
    ds_read_b128 v[28:31], v8 offset:27648
    s_mov_b32 m0, s71
    s_add_u32 s71, s71, 8192
    buffer_load_dwordx4 v7, s[44:47], s70 offen sc1 lds
    s_add_u32 s70, s70, 8192
    s_waitcnt lgkmcnt(7)
    v_mfma_f32_16x16x32_bf16 v[56:59], v[32:35], v[96:99], 0
    v_mfma_f32_16x16x32_bf16 v[60:63], v[32:35], v[176:179], 0
    ds_read_b128 v[32:35], v8 offset:28672
    s_waitcnt lgkmcnt(7)
    v_mfma_f32_16x16x32_bf16 v[56:59], v[36:39], v[100:103], v[56:59]
    v_mfma_f32_16x16x32_bf16 v[60:63], v[36:39], v[180:183], v[60:63]
    ds_read_b128 v[36:39], v8 offset:29696
    s_waitcnt lgkmcnt(7)
    v_mfma_f32_16x16x32_bf16 v[56:59], v[40:43], v[104:107], v[56:59]
    v_mfma_f32_16x16x32_bf16 v[60:63], v[40:43], v[184:187], v[60:63]
    ds_read_b128 v[40:43], v8 offset:30720
    s_waitcnt lgkmcnt(7)
    v_mfma_f32_16x16x32_bf16 v[56:59], v[44:47], v[108:111], v[56:59]
    v_mfma_f32_16x16x32_bf16 v[60:63], v[44:47], v[188:191], v[60:63]
    ds_read_b128 v[44:47], v8 offset:31744
    s_waitcnt lgkmcnt(7)
    v_mfma_f32_16x16x32_bf16 v[56:59], v[16:19], v[112:115], v[56:59]
    v_mfma_f32_16x16x32_bf16 v[60:63], v[16:19], v[192:195], v[60:63]
    ds_read_b128 v[16:19], v8 offset:32768
    s_waitcnt lgkmcnt(7)
    v_mfma_f32_16x16x32_bf16 v[56:59], v[20:23], v[116:119], v[56:59]
    v_mfma_f32_16x16x32_bf16 v[60:63], v[20:23], v[196:199], v[60:63]
    ds_read_b128 v[20:23], v8 offset:33792
    s_mov_b32 m0, s71
    s_add_u32 s71, s71, 8192
    buffer_load_dwordx4 v7, s[44:47], s70 offen sc1 lds
    s_add_u32 s70, s70, 8192
    s_waitcnt lgkmcnt(7)
    v_mfma_f32_16x16x32_bf16 v[56:59], v[24:27], v[120:123], v[56:59]
    v_mfma_f32_16x16x32_bf16 v[60:63], v[24:27], v[200:203], v[60:63]
    ds_read_b128 v[24:27], v8 offset:34816
    s_waitcnt lgkmcnt(7)
    v_mfma_f32_16x16x32_bf16 v[56:59], v[28:31], v[124:127], v[56:59]
    v_mfma_f32_16x16x32_bf16 v[60:63], v[28:31], v[204:207], v[60:63]
    ds_read_b128 v[28:31], v8 offset:35840
    s_waitcnt lgkmcnt(7)
    v_mfma_f32_16x16x32_bf16 v[56:59], v[32:35], v[128:131], v[56:59]
    v_mfma_f32_16x16x32_bf16 v[60:63], v[32:35], v[208:211], v[60:63]
    ds_read_b128 v[32:35], v8 offset:36864
    s_waitcnt lgkmcnt(7)
    v_mfma_f32_16x16x32_bf16 v[56:59], v[36:39], v[132:135], v[56:59]
    v_mfma_f32_16x16x32_bf16 v[60:63], v[36:39], v[212:215], v[60:63]
    ds_read_b128 v[36:39], v8 offset:37888
    s_waitcnt lgkmcnt(7)
    v_mfma_f32_16x16x32_bf16 v[56:59], v[40:43], v[136:139], v[56:59]
    v_mfma_f32_16x16x32_bf16 v[60:63], v[40:43], v[216:219], v[60:63]
    ds_read_b128 v[40:43], v8 offset:38912
    s_waitcnt lgkmcnt(7)
    v_mfma_f32_16x16x32_bf16 v[56:59], v[44:47], v[140:143], v[56:59]
    v_mfma_f32_16x16x32_bf16 v[60:63], v[44:47], v[220:223], v[60:63]
    ds_read_b128 v[44:47], v8 offset:39936
    s_waitcnt lgkmcnt(7)
    v_mfma_f32_16x16x32_bf16 v[56:59], v[16:19], v[144:147], v[56:59]
    v_mfma_f32_16x16x32_bf16 v[60:63], v[16:19], v[224:227], v[60:63]
    s_waitcnt lgkmcnt(6)
    v_mfma_f32_16x16x32_bf16 v[56:59], v[20:23], v[148:151], v[56:59]
    v_mfma_f32_16x16x32_bf16 v[60:63], v[20:23], v[228:231], v[60:63]
    s_waitcnt lgkmcnt(5)
    v_mfma_f32_16x16x32_bf16 v[56:59], v[24:27], v[152:155], v[56:59]
    v_mfma_f32_16x16x32_bf16 v[60:63], v[24:27], v[232:235], v[60:63]
    s_waitcnt lgkmcnt(4)
    v_mfma_f32_16x16x32_bf16 v[56:59], v[28:31], v[156:159], v[56:59]
    v_mfma_f32_16x16x32_bf16 v[60:63], v[28:31], v[236:239], v[60:63]
    s_waitcnt lgkmcnt(3)
    v_mfma_f32_16x16x32_bf16 v[56:59], v[32:35], v[160:163], v[56:59]
    v_mfma_f32_16x16x32_bf16 v[60:63], v[32:35], v[240:243], v[60:63]
    s_waitcnt lgkmcnt(2)
    v_mfma_f32_16x16x32_bf16 v[56:59], v[36:39], v[164:167], v[56:59]
    v_mfma_f32_16x16x32_bf16 v[60:63], v[36:39], v[244:247], v[60:63]
    s_waitcnt lgkmcnt(1)
    v_mfma_f32_16x16x32_bf16 v[56:59], v[40:43], v[168:171], v[56:59]
    v_mfma_f32_16x16x32_bf16 v[60:63], v[40:43], v[248:251], v[60:63]
    s_waitcnt lgkmcnt(0)
    v_mfma_f32_16x16x32_bf16 v[56:59], v[44:47], v[172:175], v[56:59]
    v_mfma_f32_16x16x32_bf16 v[60:63], v[44:47], v[252:255], v[60:63]
    s_nop 7
    v_cvt_pk_bf16_f32 v64, v48, v49
    v_cvt_pk_bf16_f32 v65, v50, v51
    v_cvt_pk_bf16_f32 v66, v56, v57
    v_cvt_pk_bf16_f32 v67, v58, v59
    v_cvt_pk_bf16_f32 v68, v52, v53
    v_cvt_pk_bf16_f32 v69, v54, v55
    v_cvt_pk_bf16_f32 v70, v60, v61
    v_cvt_pk_bf16_f32 v71, v62, v63
    buffer_store_dwordx4 v[64:67], v9, s[44:47], s74 offen sc1
    buffer_store_dwordx4 v[68:71], v9, s[44:47], s74 offen offset:1024 sc1
    s_mov_b32 s78, s73
    s_add_u32 s73, s73, 1
    s_cmp_ge_u32 s73, 64
    s_cbranch_scc1 xst_92
    s_cmp_lt_u32 s73, 6
    s_cbranch_scc1 xst_92
    s_waitcnt vmcnt(7)
    s_branch xb_93
    .p2align 6
xs_91:
    s_mul_i32 s74, s73, 393216
    ds_read_b128 v[16:19], v8 offset:0
    ds_read_b128 v[20:23], v8 offset:1024
    ds_read_b128 v[24:27], v8 offset:2048
    ds_read_b128 v[28:31], v8 offset:3072
    ds_read_b128 v[32:35], v8 offset:4096
    ds_read_b128 v[36:39], v8 offset:5120
    ds_read_b128 v[40:43], v8 offset:6144
    ds_read_b128 v[44:47], v8 offset:7168
    s_waitcnt lgkmcnt(7)
    v_mfma_f32_16x16x32_bf16 v[48:51], v[16:19], v[96:99], 0
    ds_read_b128 v[16:19], v8 offset:8192
    s_waitcnt lgkmcnt(7)
    v_mfma_f32_16x16x32_bf16 v[48:51], v[20:23], v[100:103], v[48:51]
    ds_read_b128 v[20:23], v8 offset:9216
    s_mov_b32 m0, s71
    s_add_u32 s71, s71, 8192
    buffer_load_dwordx4 v7, s[44:47], s70 offen sc1 lds
    s_add_u32 s70, s70, 8192
    s_waitcnt lgkmcnt(7)
    v_mfma_f32_16x16x32_bf16 v[48:51], v[24:27], v[104:107], v[48:51]
    ds_read_b128 v[24:27], v8 offset:10240
    s_waitcnt lgkmcnt(7)
    v_mfma_f32_16x16x32_bf16 v[48:51], v[28:31], v[108:111], v[48:51]
    ds_read_b128 v[28:31], v8 offset:11264
    s_waitcnt lgkmcnt(7)
    v_mfma_f32_16x16x32_bf16 v[48:51], v[32:35], v[112:115], v[48:51]
    ds_read_b128 v[32:35], v8 offset:12288
    s_waitcnt lgkmcnt(7)
    v_mfma_f32_16x16x32_bf16 v[48:51], v[36:39], v[116:119], v[48:51]
    ds_read_b128 v[36:39], v8 offset:13312
    s_waitcnt lgkmcnt(7)
    v_mfma_f32_16x16x32_bf16 v[48:51], v[40:43], v[120:123], v[48:51]
    ds_read_b128 v[40:43], v8 offset:14336
    s_waitcnt lgkmcnt(7)
    v_mfma_f32_16x16x32_bf16 v[48:51], v[44:47], v[124:127], v[48:51]
    ds_read_b128 v[44:47], v8 offset:15360
    s_mov_b32 m0, s71
    s_add_u32 s71, s71, 8192
    buffer_load_dwordx4 v7, s[44:47], s70 offen sc1 lds
    s_add_u32 s70, s70, 8192
    s_waitcnt lgkmcnt(7)
    v_mfma_f32_16x16x32_bf16 v[48:51], v[16:19], v[128:131], v[48:51]
    ds_read_b128 v[16:19], v8 offset:16384
    s_waitcnt lgkmcnt(7)
    v_mfma_f32_16x16x32_bf16 v[48:51], v[20:23], v[132:135], v[48:51]
    ds_read_b128 v[20:23], v8 offset:17408
    s_waitcnt lgkmcnt(7)
    v_mfma_f32_16x16x32_bf16 v[48:51], v[24:27], v[136:139], v[48:51]
    ds_read_b128 v[24:27], v8 offset:18432
    s_waitcnt lgkmcnt(7)
    v_mfma_f32_16x16x32_bf16 v[48:51], v[28:31], v[140:143], v[48:51]
    ds_read_b128 v[28:31], v8 offset:19456
    s_waitcnt lgkmcnt(7)
    v_mfma_f32_16x16x32_bf16 v[48:51], v[32:35], v[144:147], v[48:51]
    ds_read_b128 v[32:35], v8 offset:20480
    s_waitcnt lgkmcnt(7)
    v_mfma_f32_16x16x32_bf16 v[48:51], v[36:39], v[148:151], v[48:51]
    ds_read_b128 v[36:39], v8 offset:21504
    s_mov_b32 m0, s71
    s_add_u32 s71, s71, 8192
    buffer_load_dwordx4 v7, s[44:47], s70 offen sc1 lds
    s_add_u32 s70, s70, 8192
    s_waitcnt lgkmcnt(7)
    v_mfma_f32_16x16x32_bf16 v[48:51], v[40:43], v[152:155], v[48:51]
    ds_read_b128 v[40:43], v8 offset:22528
    s_waitcnt lgkmcnt(7)
    v_mfma_f32_16x16x32_bf16 v[48:51], v[44:47], v[156:159], v[48:51]
    ds_read_b128 v[44:47], v8 offset:23552
    s_waitcnt lgkmcnt(7)
    v_mfma_f32_16x16x32_bf16 v[48:51], v[16:19], v[160:163], v[48:51]
    ds_read_b128 v[16:19], v8 offset:24576
    s_waitcnt lgkmcnt(7)
    v_mfma_f32_16x16x32_bf16 v[48:51], v[20:23], v[164:167], v[48:51]
    ds_read_b128 v[20:23], v8 offset:25600
    s_waitcnt lgkmcnt(7)
    v_mfma_f32_16x16x32_bf16 v[48:51], v[24:27], v[168:171], v[48:51]
    ds_read_b128 v[24:27], v8 offset:26624
    s_waitcnt lgkmcnt(7)
    v_mfma_f32_16x16x32_bf16 v[48:51], v[28:31], v[172:175], v[48:51]
    ds_read_b128 v[28:31], v8 offset:27648
    s_mov_b32 m0, s71
    s_add_u32 s71, s71, 8192
    buffer_load_dwordx4 v7, s[44:47], s70 offen sc1 lds
    s_add_u32 s70, s70, 8192
    s_waitcnt lgkmcnt(7)
    v_mfma_f32_16x16x32_bf16 v[52:55], v[32:35], v[96:99], 0
    ds_read_b128 v[32:35], v8 offset:28672
    s_waitcnt lgkmcnt(7)
    v_mfma_f32_16x16x32_bf16 v[52:55], v[36:39], v[100:103], v[52:55]
    ds_read_b128 v[36:39], v8 offset:29696
    s_waitcnt lgkmcnt(7)
    v_mfma_f32_16x16x32_bf16 v[52:55], v[40:43], v[104:107], v[52:55]
    ds_read_b128 v[40:43], v8 offset:30720
    s_waitcnt lgkmcnt(7)
    v_mfma_f32_16x16x32_bf16 v[52:55], v[44:47], v[108:111], v[52:55]
    ds_read_b128 v[44:47], v8 offset:31744
    s_waitcnt lgkmcnt(7)
    v_mfma_f32_16x16x32_bf16 v[52:55], v[16:19], v[112:115], v[52:55]
    ds_read_b128 v[16:19], v8 offset:32768
    s_waitcnt lgkmcnt(7)
    v_mfma_f32_16x16x32_bf16 v[52:55], v[20:23], v[116:119], v[52:55]
    ds_read_b128 v[20:23], v8 offset:33792
    s_mov_b32 m0, s71
    s_add_u32 s71, s71, 8192
    buffer_load_dwordx4 v7, s[44:47], s70 offen sc1 lds
    s_add_u32 s70, s70, 8192
    s_waitcnt lgkmcnt(7)
    v_mfma_f32_16x16x32_bf16 v[52:55], v[24:27], v[120:123], v[52:55]
    ds_read_b128 v[24:27], v8 offset:34816
    s_waitcnt lgkmcnt(7)
    v_mfma_f32_16x16x32_bf16 v[52:55], v[28:31], v[124:127], v[52:55]
    ds_read_b128 v[28:31], v8 offset:35840
    s_waitcnt lgkmcnt(7)
    v_mfma_f32_16x16x32_bf16 v[52:55], v[32:35], v[128:131], v[52:55]
    ds_read_b128 v[32:35], v8 offset:36864
    s_waitcnt lgkmcnt(7)
    v_mfma_f32_16x16x32_bf16 v[52:55], v[36:39], v[132:135], v[52:55]
    ds_read_b128 v[36:39], v8 offset:37888
    s_waitcnt lgkmcnt(7)
    v_mfma_f32_16x16x32_bf16 v[52:55], v[40:43], v[136:139], v[52:55]
    ds_read_b128 v[40:43], v8 offset:38912
    s_waitcnt lgkmcnt(7)
    v_mfma_f32_16x16x32_bf16 v[52:55], v[44:47], v[140:143], v[52:55]
    ds_read_b128 v[44:47], v8 offset:39936
    s_waitcnt lgkmcnt(7)
    v_mfma_f32_16x16x32_bf16 v[52:55], v[16:19], v[144:147], v[52:55]
    s_waitcnt lgkmcnt(6)
    v_mfma_f32_16x16x32_bf16 v[52:55], v[20:23], v[148:151], v[52:55]
    s_waitcnt lgkmcnt(5)
    v_mfma_f32_16x16x32_bf16 v[52:55], v[24:27], v[152:155], v[52:55]
    s_waitcnt lgkmcnt(4)
    v_mfma_f32_16x16x32_bf16 v[52:55], v[28:31], v[156:159], v[52:55]
    s_waitcnt lgkmcnt(3)
    v_mfma_f32_16x16x32_bf16 v[52:55], v[32:35], v[160:163], v[52:55]
    s_waitcnt lgkmcnt(2)
    v_mfma_f32_16x16x32_bf16 v[52:55], v[36:39], v[164:167], v[52:55]
    s_waitcnt lgkmcnt(1)
    v_mfma_f32_16x16x32_bf16 v[52:55], v[40:43], v[168:171], v[52:55]
    s_waitcnt lgkmcnt(0)
    v_mfma_f32_16x16x32_bf16 v[52:55], v[44:47], v[172:175], v[52:55]
    s_nop 7
    v_cvt_pk_bf16_f32 v64, v48, v49
    v_cvt_pk_bf16_f32 v65, v50, v51
    v_cvt_pk_bf16_f32 v66, v52, v53
    v_cvt_pk_bf16_f32 v67, v54, v55
    buffer_store_dwordx4 v[64:67], v9, s[44:47], s74 offen sc1
    s_mov_b32 s78, s73
    s_add_u32 s73, s73, 1
    s_cmp_ge_u32 s73, 64
    s_cbranch_scc1 xst_92
    s_cmp_lt_u32 s73, 6
    s_cbranch_scc1 xst_92
    s_waitcnt vmcnt(6)
    s_branch xb_93
L_q:
    s_mov_b32 s52, s16
    s_and_b32 s53, s17, 0xffff
    s_mov_b32 s54, 0x280000
    s_mov_b32 s55, 0x00020000
    s_sub_u32 s63, s2, 160
    s_lshl_b32 s63, s63, 3
    s_add_u32 s63, s63, s3
    s_lshl_b32 s63, s63, 2
    s_mul_i32 s64, s63, 1280
    v_lshrrev_b32 v3, 4, v1
    v_and_b32 v4, 15, v1
    v_mul_u32_u24 v2, 1280, v3
    v_lshlrev_b32 v5, 4, v4
    v_add_u32 v2, v2, v5
    buffer_load_dwordx4 v[16:19], v2, s[52:55], s64 offen offset:0
    buffer_load_dwordx4 v[20:23], v2, s[52:55], s64 offen offset:256
    buffer_load_dwordx4 v[24:27], v2, s[52:55], s64 offen offset:512
    buffer_load_dwordx4 v[28:31], v2, s[52:55], s64 offen offset:768
    buffer_load_dwordx4 v[32:35], v2, s[52:55], s64 offen offset:1024
    v_lshrrev_b32 v5, 2, v4
    v_lshlrev_b32 v5, 10, v5
    v_and_b32 v6, 3, v4
    v_lshlrev_b32 v6, 8, v6
    v_lshlrev_b32 v3, 4, v3
    v_add3_u32 v5, v5, v6, v3
    s_lshr_b32 s64, s63, 4
    s_mul_i32 s64, s64, 20480
    s_and_b32 s65, s63, 15
    s_lshl_b32 s65, s65, 4
    s_add_u32 s64, s64, s65
    s_waitcnt vmcnt(0)
    v_lshlrev_b32 v40, 16, v16
    v_and_b32 v41, 0xffff0000, v16
    v_lshlrev_b32 v42, 16, v17
    v_and_b32 v43, 0xffff0000, v17
    v_lshlrev_b32 v44, 16, v18
    v_and_b32 v45, 0xffff0000, v18
    v_lshlrev_b32 v46, 16, v19
    v_and_b32 v47, 0xffff0000, v19
    v_lshlrev_b32 v48, 16, v20
    v_and_b32 v49, 0xffff0000, v20
    v_lshlrev_b32 v50, 16, v21
    v_and_b32 v51, 0xffff0000, v21
    v_lshlrev_b32 v52, 16, v22
    v_and_b32 v53, 0xffff0000, v22
    v_lshlrev_b32 v54, 16, v23
    v_and_b32 v55, 0xffff0000, v23
    v_lshlrev_b32 v56, 16, v24
    v_and_b32 v57, 0xffff0000, v24
    v_lshlrev_b32 v58, 16, v25
    v_and_b32 v59, 0xffff0000, v25
    v_lshlrev_b32 v60, 16, v26
    v_and_b32 v61, 0xffff0000, v26
    v_lshlrev_b32 v62, 16, v27
    v_and_b32 v63, 0xffff0000, v27
    v_lshlrev_b32 v64, 16, v28
    v_and_b32 v65, 0xffff0000, v28
    v_lshlrev_b32 v66, 16, v29
    v_and_b32 v67, 0xffff0000, v29
    v_lshlrev_b32 v68, 16, v30
    v_and_b32 v69, 0xffff0000, v30
    v_lshlrev_b32 v70, 16, v31
    v_and_b32 v71, 0xffff0000, v31
    v_lshlrev_b32 v72, 16, v32
    v_and_b32 v73, 0xffff0000, v32
    v_lshlrev_b32 v74, 16, v33
    v_and_b32 v75, 0xffff0000, v33
    v_lshlrev_b32 v76, 16, v34
    v_and_b32 v77, 0xffff0000, v34
    v_lshlrev_b32 v78, 16, v35
    v_and_b32 v79, 0xffff0000, v35
    v_pk_add_f32 v[8:9], v[40:41], v[42:43]
    v_pk_add_f32 v[8:9], v[8:9], v[44:45]
    v_pk_add_f32 v[8:9], v[8:9], v[46:47]
    v_pk_add_f32 v[8:9], v[8:9], v[48:49]
    v_pk_add_f32 v[8:9], v[8:9], v[50:51]
    v_pk_add_f32 v[8:9], v[8:9], v[52:53]
    v_pk_add_f32 v[8:9], v[8:9], v[54:55]
    v_pk_add_f32 v[8:9], v[8:9], v[56:57]
    v_pk_add_f32 v[8:9], v[8:9], v[58:59]
    v_pk_add_f32 v[8:9], v[8:9], v[60:61]
    v_pk_add_f32 v[8:9], v[8:9], v[62:63]
    v_pk_add_f32 v[8:9], v[8:9], v[64:65]
    v_pk_add_f32 v[8:9], v[8:9], v[66:67]
    v_pk_add_f32 v[8:9], v[8:9], v[68:69]
    v_pk_add_f32 v[8:9], v[8:9], v[70:71]
    v_pk_add_f32 v[8:9], v[8:9], v[72:73]
    v_pk_add_f32 v[8:9], v[8:9], v[74:75]
    v_pk_add_f32 v[8:9], v[8:9], v[76:77]
    v_pk_add_f32 v[8:9], v[8:9], v[78:79]
    v_add_f32 v8, v8, v9
    s_nop 1
    v_add_f32_dpp v8, v8, v8 row_ror:1 row_mask:0xf bank_mask:0xf
    s_nop 1
    v_add_f32_dpp v8, v8, v8 row_ror:2 row_mask:0xf bank_mask:0xf
    s_nop 1
    v_add_f32_dpp v8, v8, v8 row_ror:4 row_mask:0xf bank_mask:0xf
    s_nop 1
    v_add_f32_dpp v8, v8, v8 row_ror:8 row_mask:0xf bank_mask:0xf
    v_mul_f32 v8, 0xbacccccd, v8
    v_mov_b32 v9, v8
    v_pk_add_f32 v[80:81], v[40:41], v[8:9]
    v_pk_add_f32 v[82:83], v[42:43], v[8:9]
    v_pk_add_f32 v[84:85], v[44:45], v[8:9]
    v_pk_add_f32 v[86:87], v[46:47], v[8:9]
    v_pk_add_f32 v[88:89], v[48:49], v[8:9]
    v_pk_add_f32 v[90:91], v[50:51], v[8:9]
    v_pk_add_f32 v[92:93], v[52:53], v[8:9]
    v_pk_add_f32 v[94:95], v[54:55], v[8:9]
    v_pk_add_f32 v[96:97], v[56:57], v[8:9]
    v_pk_add_f32 v[98:99], v[58:59], v[8:9]
    v_pk_add_f32 v[100:101], v[60:61], v[8:9]
    v_pk_add_f32 v[102:103], v[62:63], v[8:9]
    v_pk_add_f32 v[104:105], v[64:65], v[8:9]
    v_pk_add_f32 v[106:107], v[66:67], v[8:9]
    v_pk_add_f32 v[108:109], v[68:69], v[8:9]
    v_pk_add_f32 v[110:111], v[70:71], v[8:9]
    v_pk_add_f32 v[112:113], v[72:73], v[8:9]
    v_pk_add_f32 v[114:115], v[74:75], v[8:9]
    v_pk_add_f32 v[116:117], v[76:77], v[8:9]
    v_pk_add_f32 v[118:119], v[78:79], v[8:9]
    v_pk_mul_f32 v[10:11], v[80:81], v[80:81]
    v_pk_fma_f32 v[10:11], v[82:83], v[82:83], v[10:11]
    v_pk_fma_f32 v[10:11], v[84:85], v[84:85], v[10:11]
    v_pk_fma_f32 v[10:11], v[86:87], v[86:87], v[10:11]
    v_pk_fma_f32 v[10:11], v[88:89], v[88:89], v[10:11]
    v_pk_fma_f32 v[10:11], v[90:91], v[90:91], v[10:11]
    v_pk_fma_f32 v[10:11], v[92:93], v[92:93], v[10:11]
    v_pk_fma_f32 v[10:11], v[94:95], v[94:95], v[10:11]
    v_pk_fma_f32 v[10:11], v[96:97], v[96:97], v[10:11]
    v_pk_fma_f32 v[10:11], v[98:99], v[98:99], v[10:11]
    v_pk_fma_f32 v[10:11], v[100:101], v[100:101], v[10:11]
    v_pk_fma_f32 v[10:11], v[102:103], v[102:103], v[10:11]
    v_pk_fma_f32 v[10:11], v[104:105], v[104:105], v[10:11]
    v_pk_fma_f32 v[10:11], v[106:107], v[106:107], v[10:11]
    v_pk_fma_f32 v[10:11], v[108:109], v[108:109], v[10:11]
    v_pk_fma_f32 v[10:11], v[110:111], v[110:111], v[10:11]
    v_pk_fma_f32 v[10:11], v[112:113], v[112:113], v[10:11]
    v_pk_fma_f32 v[10:11], v[114:115], v[114:115], v[10:11]
    v_pk_fma_f32 v[10:11], v[116:117], v[116:117], v[10:11]
    v_pk_fma_f32 v[10:11], v[118:119], v[118:119], v[10:11]
    v_add_f32 v10, v10, v11
    s_nop 1
    v_add_f32_dpp v10, v10, v10 row_ror:1 row_mask:0xf bank_mask:0xf
    s_nop 1
    v_add_f32_dpp v10, v10, v10 row_ror:2 row_mask:0xf bank_mask:0xf
    s_nop 1
    v_add_f32_dpp v10, v10, v10 row_ror:4 row_mask:0xf bank_mask:0xf
    s_nop 1
    v_add_f32_dpp v10, v10, v10 row_ror:8 row_mask:0xf bank_mask:0xf
    v_mul_f32 v10, 0x3acccccd, v10
    v_cvt_pk_bf16_f32 v10, v10, v10
    v_and_b32 v10, 0xffff0000, v10
    v_add_f32 v10, 0x3727c5ac, v10
    v_cvt_pk_bf16_f32 v10, v10, v10
    v_and_b32 v10, 0xffff0000, v10
    v_sqrt_f32 v10, v10
    s_nop 0
    v_cvt_pk_bf16_f32 v10, v10, v10
    v_and_b32 v10, 0xffff0000, v10
    v_rcp_f32 v12, v10
    v_cvt_pk_bf16_f32 v8, v8, v8
    v_and_b32 v8, 0xffff0000, v8
    v_mov_b32 v9, v8
    v_mov_b32 v13, v12
    v_sub_f32 v10, 0, v10
    v_mov_b32 v11, v10
    v_pk_add_f32 v[80:81], v[40:41], v[8:9]
    v_pk_add_f32 v[82:83], v[42:43], v[8:9]
    v_pk_add_f32 v[84:85], v[44:45], v[8:9]
    v_pk_add_f32 v[86:87], v[46:47], v[8:9]
    v_pk_add_f32 v[88:89], v[48:49], v[8:9]
    v_pk_add_f32 v[90:91], v[50:51], v[8:9]
    v_pk_add_f32 v[92:93], v[52:53], v[8:9]
    v_pk_add_f32 v[94:95], v[54:55], v[8:9]
    v_pk_add_f32 v[96:97], v[56:57], v[8:9]
    v_pk_add_f32 v[98:99], v[58:59], v[8:9]
    v_pk_add_f32 v[100:101], v[60:61], v[8:9]
    v_pk_add_f32 v[102:103], v[62:63], v[8:9]
    v_pk_add_f32 v[104:105], v[64:65], v[8:9]
    v_pk_add_f32 v[106:107], v[66:67], v[8:9]
    v_pk_add_f32 v[108:109], v[68:69], v[8:9]
    v_pk_add_f32 v[110:111], v[70:71], v[8:9]
    v_pk_add_f32 v[112:113], v[72:73], v[8:9]
    v_pk_add_f32 v[114:115], v[74:75], v[8:9]
    v_pk_add_f32 v[116:117], v[76:77], v[8:9]
    v_pk_add_f32 v[118:119], v[78:79], v[8:9]
    v_cvt_pk_bf16_f32 v16, v80, v81
    v_cvt_pk_bf16_f32 v17, v82, v83
    v_cvt_pk_bf16_f32 v18, v84, v85
    v_cvt_pk_bf16_f32 v19, v86, v87
    v_cvt_pk_bf16_f32 v20, v88, v89
    v_cvt_pk_bf16_f32 v21, v90, v91
    v_cvt_pk_bf16_f32 v22, v92, v93
    v_cvt_pk_bf16_f32 v23, v94, v95
    v_cvt_pk_bf16_f32 v24, v96, v97
    v_cvt_pk_bf16_f32 v25, v98, v99
    v_cvt_pk_bf16_f32 v26, v100, v101
    v_cvt_pk_bf16_f32 v27, v102, v103
    v_cvt_pk_bf16_f32 v28, v104, v105
    v_cvt_pk_bf16_f32 v29, v106, v107
    v_cvt_pk_bf16_f32 v30, v108, v109
    v_cvt_pk_bf16_f32 v31, v110, v111
    v_cvt_pk_bf16_f32 v32, v112, v113
    v_cvt_pk_bf16_f32 v33, v114, v115
    v_cvt_pk_bf16_f32 v34, v116, v117
    v_cvt_pk_bf16_f32 v35, v118, v119
    v_lshlrev_b32 v40, 16, v16
    v_and_b32 v41, 0xffff0000, v16
    v_lshlrev_b32 v42, 16, v17
    v_and_b32 v43, 0xffff0000, v17
    v_lshlrev_b32 v44, 16, v18
    v_and_b32 v45, 0xffff0000, v18
    v_lshlrev_b32 v46, 16, v19
    v_and_b32 v47, 0xffff0000, v19
    v_lshlrev_b32 v48, 16, v20
    v_and_b32 v49, 0xffff0000, v20
    v_lshlrev_b32 v50, 16, v21
    v_and_b32 v51, 0xffff0000, v21
    v_lshlrev_b32 v52, 16, v22
    v_and_b32 v53, 0xffff0000, v22
    v_lshlrev_b32 v54, 16, v23
    v_and_b32 v55, 0xffff0000, v23
    v_lshlrev_b32 v56, 16, v24
    v_and_b32 v57, 0xffff0000, v24
    v_lshlrev_b32 v58, 16, v25
    v_and_b32 v59, 0xffff0000, v25
    v_lshlrev_b32 v60, 16, v26
    v_and_b32 v61, 0xffff0000, v26
    v_lshlrev_b32 v62, 16, v27
    v_and_b32 v63, 0xffff0000, v27
    v_lshlrev_b32 v64, 16, v28
    v_and_b32 v65, 0xffff0000, v28
    v_lshlrev_b32 v66, 16, v29
    v_and_b32 v67, 0xffff0000, v29
    v_lshlrev_b32 v68, 16, v30
    v_and_b32 v69, 0xffff0000, v30
    v_lshlrev_b32 v70, 16, v31
    v_and_b32 v71, 0xffff0000, v31
    v_lshlrev_b32 v72, 16, v32
    v_and_b32 v73, 0xffff0000, v32
    v_lshlrev_b32 v74, 16, v33
    v_and_b32 v75, 0xffff0000, v33
    v_lshlrev_b32 v76, 16, v34
    v_and_b32 v77, 0xffff0000, v34
    v_lshlrev_b32 v78, 16, v35
    v_and_b32 v79, 0xffff0000, v35
    v_pk_mul_f32 v[80:81], v[40:41], v[12:13]
    v_pk_fma_f32 v[40:41], v[80:81], v[10:11], v[40:41]
    v_pk_fma_f32 v[80:81], v[40:41], v[12:13], v[80:81]
    v_pk_mul_f32 v[82:83], v[42:43], v[12:13]
    v_pk_fma_f32 v[42:43], v[82:83], v[10:11], v[42:43]
    v_pk_fma_f32 v[82:83], v[42:43], v[12:13], v[82:83]
    v_pk_mul_f32 v[84:85], v[44:45], v[12:13]
    v_pk_fma_f32 v[44:45], v[84:85], v[10:11], v[44:45]
    v_pk_fma_f32 v[84:85], v[44:45], v[12:13], v[84:85]
    v_pk_mul_f32 v[86:87], v[46:47], v[12:13]
    v_pk_fma_f32 v[46:47], v[86:87], v[10:11], v[46:47]
    v_pk_fma_f32 v[86:87], v[46:47], v[12:13], v[86:87]
    v_pk_mul_f32 v[88:89], v[48:49], v[12:13]
    v_pk_fma_f32 v[48:49], v[88:89], v[10:11], v[48:49]
    v_pk_fma_f32 v[88:89], v[48:49], v[12:13], v[88:89]
    v_pk_mul_f32 v[90:91], v[50:51], v[12:13]
    v_pk_fma_f32 v[50:51], v[90:91], v[10:11], v[50:51]
    v_pk_fma_f32 v[90:91], v[50:51], v[12:13], v[90:91]
    v_pk_mul_f32 v[92:93], v[52:53], v[12:13]
    v_pk_fma_f32 v[52:53], v[92:93], v[10:11], v[52:53]
    v_pk_fma_f32 v[92:93], v[52:53], v[12:13], v[92:93]
    v_pk_mul_f32 v[94:95], v[54:55], v[12:13]
    v_pk_fma_f32 v[54:55], v[94:95], v[10:11], v[54:55]
    v_pk_fma_f32 v[94:95], v[54:55], v[12:13], v[94:95]
    v_pk_mul_f32 v[96:97], v[56:57], v[12:13]
    v_pk_fma_f32 v[56:57], v[96:97], v[10:11], v[56:57]
    v_pk_fma_f32 v[96:97], v[56:57], v[12:13], v[96:97]
    v_pk_mul_f32 v[98:99], v[58:59], v[12:13]
    v_pk_fma_f32 v[58:59], v[98:99], v[10:11], v[58:59]
    v_pk_fma_f32 v[98:99], v[58:59], v[12:13], v[98:99]
    v_pk_mul_f32 v[100:101], v[60:61], v[12:13]
    v_pk_fma_f32 v[60:61], v[100:101], v[10:11], v[60:61]
    v_pk_fma_f32 v[100:101], v[60:61], v[12:13], v[100:101]
    v_pk_mul_f32 v[102:103], v[62:63], v[12:13]
    v_pk_fma_f32 v[62:63], v[102:103], v[10:11], v[62:63]
    v_pk_fma_f32 v[102:103], v[62:63], v[12:13], v[102:103]
    v_pk_mul_f32 v[104:105], v[64:65], v[12:13]
    v_pk_fma_f32 v[64:65], v[104:105], v[10:11], v[64:65]
    v_pk_fma_f32 v[104:105], v[64:65], v[12:13], v[104:105]
    v_pk_mul_f32 v[106:107], v[66:67], v[12:13]
    v_pk_fma_f32 v[66:67], v[106:107], v[10:11], v[66:67]
    v_pk_fma_f32 v[106:107], v[66:67], v[12:13], v[106:107]
    v_pk_mul_f32 v[108:109], v[68:69], v[12:13]
    v_pk_fma_f32 v[68:69], v[108:109], v[10:11], v[68:69]
    v_pk_fma_f32 v[108:109], v[68:69], v[12:13], v[108:109]
    v_pk_mul_f32 v[110:111], v[70:71], v[12:13]
    v_pk_fma_f32 v[70:71], v[110:111], v[10:11], v[70:71]
    v_pk_fma_f32 v[110:111], v[70:71], v[12:13], v[110:111]
    v_pk_mul_f32 v[112:113], v[72:73], v[12:13]
    v_pk_fma_f32 v[72:73], v[112:113], v[10:11], v[72:73]
    v_pk_fma_f32 v[112:113], v[72:73], v[12:13], v[112:113]
    v_pk_mul_f32 v[114:115], v[74:75], v[12:13]
    v_pk_fma_f32 v[74:75], v[114:115], v[10:11], v[74:75]
    v_pk_fma_f32 v[114:115], v[74:75], v[12:13], v[114:115]
    v_pk_mul_f32 v[116:117], v[76:77], v[12:13]
    v_pk_fma_f32 v[76:77], v[116:117], v[10:11], v[76:77]
    v_pk_fma_f32 v[116:117], v[76:77], v[12:13], v[116:117]
    v_pk_mul_f32 v[118:119], v[78:79], v[12:13]
    v_pk_fma_f32 v[78:79], v[118:119], v[10:11], v[78:79]
    v_pk_fma_f32 v[118:119], v[78:79], v[12:13], v[118:119]
    v_cvt_pk_bf16_f32 v16, v80, v81
    v_cvt_pk_bf16_f32 v17, v82, v83
    v_cvt_pk_bf16_f32 v18, v84, v85
    v_cvt_pk_bf16_f32 v19, v86, v87
    buffer_store_dwordx4 v[16:19], v5, s[44:47], s64 offen sc1
    s_add_u32 s64, s64, 4096
    v_cvt_pk_bf16_f32 v20, v88, v89
    v_cvt_pk_bf16_f32 v21, v90, v91
    v_cvt_pk_bf16_f32 v22, v92, v93
    v_cvt_pk_bf16_f32 v23, v94, v95
    buffer_store_dwordx4 v[20:23], v5, s[44:47], s64 offen sc1
    s_add_u32 s64, s64, 4096
    v_cvt_pk_bf16_f32 v24, v96, v97
    v_cvt_pk_bf16_f32 v25, v98, v99
    v_cvt_pk_bf16_f32 v26, v100, v101
    v_cvt_pk_bf16_f32 v27, v102, v103
    buffer_store_dwordx4 v[24:27], v5, s[44:47], s64 offen sc1
    s_add_u32 s64, s64, 4096
    v_cvt_pk_bf16_f32 v28, v104, v105
    v_cvt_pk_bf16_f32 v29, v106, v107
    v_cvt_pk_bf16_f32 v30, v108, v109
    v_cvt_pk_bf16_f32 v31, v110, v111
    buffer_store_dwordx4 v[28:31], v5, s[44:47], s64 offen sc1
    s_add_u32 s64, s64, 4096
    v_cvt_pk_bf16_f32 v32, v112, v113
    v_cvt_pk_bf16_f32 v33, v114, v115
    v_cvt_pk_bf16_f32 v34, v116, v117
    v_cvt_pk_bf16_f32 v35, v118, v119
    buffer_store_dwordx4 v[32:35], v5, s[44:47], s64 offen sc1
    s_add_u32 s64, s64, 4096
    s_waitcnt vmcnt(0)
    s_barrier
    s_cmp_eq_u32 s3, 0
    s_cbranch_scc0 arr_96
    s_getreg_b32 s12, hwreg(HW_REG_XCC_ID)
    s_and_b32 s12, s12, 15
    s_cmp_gt_u32 s12, 7
    s_cselect_b32 s13, s14, 0
    s_lshr_b32 s13, s13, 3
    s_add_u32 s12, s12, s13
    s_sub_u32 s12, s12, s14
    s_and_b32 s12, s12, 7
    s_mul_i32 s13, s12, s12
    s_lshl_b32 s12, s12, 9
    s_or_b32 s12, s12, 1
    v_mov_b32 v12, s12
    v_mov_b32 v13, s13
    v_mov_b32 v14, 1073741824
    v_cmp_eq_u32 vcc, 0, v1
    s_nop 1
    v_cndmask_b32 v14, v14, v1, vcc
    buffer_atomic_add_x2 v[12:13], v14, s[56:59], s10 offen sc1
arr_96:
    s_sub_u32 s60, s5, 20
    s_lshl_b32 s61, s4, 2
    s_add_u32 s61, s61, s60
    s_mul_i32 s62, s61, 384
    s_cmp_lt_u32 s3, 4
    s_cbranch_scc0 pw_97
    v_lshrrev_b32 v11, 5, v1
    v_mul_u32_u24 v10, 3072, v11
    v_bfe_u32 v11, v1, 2, 2
    v_mul_u32_u24 v11, 384, v11
    v_add_u32 v10, v10, v11
    v_and_b32 v11, 1, v1
    v_lshlrev_b32 v11, 5, v11
    v_add_u32 v10, v10, v11
    v_and_b32 v11, 16, v1
    v_add_u32 v10, v10, v11
    v_and_b32 v11, 2, v1
    v_lshlrev_b32 v11, 2, v11
    v_add_u32 v10, v10, v11
    s_lshl_b32 s63, s3, 6
    s_branch pw_98
pw_97:
    v_lshrrev_b32 v11, 4, v1
    v_mul_u32_u24 v10, 3072, v11
    v_bfe_u32 v11, v1, 2, 2
    v_mul_u32_u24 v11, 384, v11
    v_add_u32 v10, v10, v11
    v_and_b32 v11, 3, v1
    v_mul_u32_u24 v11, 8, v11
    v_add_u32 v10, v10, v11
    s_lshl_b32 s63, s3, 5
    s_add_u32 s63, s63, 128
pw_98:
    v_add_u32 v10, s63, v10
    s_mov_b32 s48, s20
    s_and_b32 s49, s21, 0xffff
    s_mov_b32 s50, 0x780000
    s_mov_b32 s51, 0x00020000
    v_add_u32 v5, 0, v1
    v_mul_u32_u24 v6, 2731, v5
    v_lshrrev_b32 v6, 16, v6
    v_mul_u32_u24 v2, 11904, v6
    v_lshlrev_b32 v5, 4, v5
    v_add_u32 v2, v2, v5
    v_add_u32 v5, 64, v1
    v_mul_u32_u24 v6, 2731, v5
    v_lshrrev_b32 v6, 16, v6
    v_mul_u32_u24 v3, 11904, v6
    v_lshlrev_b32 v5, 4, v5
    v_add_u32 v3, v3, v5
    v_add_u32 v5, 128, v1
    v_mul_u32_u24 v6, 2731, v5
    v_lshrrev_b32 v6, 16, v6
    v_mul_u32_u24 v4, 11904, v6
    v_lshlrev_b32 v5, 4, v5
    v_add_u32 v4, v4, v5
    s_mul_i32 s63, s3, 3072
    s_add_u32 s63, s63, 0
    s_mul_i32 s64, s3, 98304
    s_add_u32 s64, s64, s62
    s_add_u32 s64, s64, 0
    s_mov_b32 m0, s63
    s_add_u32 s63, s63, 1024
    buffer_load_dwordx4 v2, s[48:51], s64 offen lds
    s_mov_b32 m0, s63
    s_add_u32 s63, s63, 1024
    buffer_load_dwordx4 v3, s[48:51], s64 offen lds
    s_mov_b32 m0, s63
    s_add_u32 s63, s63, 22528
    buffer_load_dwordx4 v4, s[48:51], s64 offen lds
    s_add_u32 s64, s64, 786432
    s_mov_b32 m0, s63
    s_add_u32 s63, s63, 1024
    buffer_load_dwordx4 v2, s[48:51], s64 offen lds
    s_mov_b32 m0, s63
    s_add_u32 s63, s63, 1024
    buffer_load_dwordx4 v3, s[48:51], s64 offen lds
    s_mov_b32 m0, s63
    s_add_u32 s63, s63, 22528
    buffer_load_dwordx4 v4, s[48:51], s64 offen lds
    s_add_u32 s64, s64, 786432
    s_mul_i32 s63, s3, 3072
    s_add_u32 s63, s63, 49152
    s_mul_i32 s64, s3, 98304
    s_add_u32 s64, s64, s62
    s_add_u32 s64, s64, 1572864
    s_mov_b32 m0, s63
    s_add_u32 s63, s63, 1024
    buffer_load_dwordx4 v2, s[48:51], s64 offen lds
    s_mov_b32 m0, s63
    s_add_u32 s63, s63, 1024
    buffer_load_dwordx4 v3, s[48:51], s64 offen lds
    s_mov_b32 m0, s63
    s_add_u32 s63, s63, 22528
    buffer_load_dwordx4 v4, s[48:51], s64 offen lds
    s_add_u32 s64, s64, 786432
    s_mov_b32 m0, s63
    s_add_u32 s63, s63, 1024
    buffer_load_dwordx4 v2, s[48:51], s64 offen lds
    s_mov_b32 m0, s63
    s_add_u32 s63, s63, 1024
    buffer_load_dwordx4 v3, s[48:51], s64 offen lds
    s_mov_b32 m0, s63
    s_add_u32 s63, s63, 22528
    buffer_load_dwordx4 v4, s[48:51], s64 offen lds
    s_add_u32 s64, s64, 786432
    s_mul_i32 s63, s3, 3072
    s_add_u32 s63, s63, 98304
    s_mul_i32 s64, s3, 98304
    s_add_u32 s64, s64, s62
    s_add_u32 s64, s64, 3145728
    s_mov_b32 m0, s63
    s_add_u32 s63, s63, 1024
    buffer_load_dwordx4 v2, s[48:51], s64 offen lds
    s_mov_b32 m0, s63
    s_add_u32 s63, s63, 1024
    buffer_load_dwordx4 v3, s[48:51], s64 offen lds
    s_mov_b32 m0, s63
    s_add_u32 s63, s63, 22528
    buffer_load_dwordx4 v4, s[48:51], s64 offen lds
    s_add_u32 s64, s64, 786432
    s_mov_b32 m0, s63
    s_add_u32 s63, s63, 1024
    buffer_load_dwordx4 v2, s[48:51], s64 offen lds
    s_mov_b32 m0, s63
    s_add_u32 s63, s63, 1024
    buffer_load_dwordx4 v3, s[48:51], s64 offen lds
    s_mov_b32 m0, s63
    s_add_u32 s63, s63, 22528
    buffer_load_dwordx4 v4, s[48:51], s64 offen lds
    s_add_u32 s64, s64, 786432
    s_waitcnt vmcnt(12)
    s_barrier
    s_cmp_lt_u32 s3, 4
    s_cbranch_scc0 rd_99
    v_add_u32 v11, 0, v10
    ds_read_b64_tr_b16 v[96:97], v11 offset:0
    ds_read_b64_tr_b16 v[98:99], v11 offset:1536
    ds_read_b64_tr_b16 v[176:177], v11 offset:6144
    ds_read_b64_tr_b16 v[178:179], v11 offset:7680
    ds_read_b64_tr_b16 v[100:101], v11 offset:12288
    ds_read_b64_tr_b16 v[102:103], v11 offset:13824
    ds_read_b64_tr_b16 v[180:181], v11 offset:18432
    ds_read_b64_tr_b16 v[182:183], v11 offset:19968
    s_waitcnt lgkmcnt(6)
    ds_read_b64_tr_b16 v[104:105], v11 offset:24576
    ds_read_b64_tr_b16 v[106:107], v11 offset:26112
    ds_read_b64_tr_b16 v[184:185], v11 offset:30720
    ds_read_b64_tr_b16 v[186:187], v11 offset:32256
    ds_read_b64_tr_b16 v[108:109], v11 offset:36864
    ds_read_b64_tr_b16 v[110:111], v11 offset:38400
    ds_read_b64_tr_b16 v[188:189], v11 offset:43008
    ds_read_b64_tr_b16 v[190:191], v11 offset:44544
    s_waitcnt lgkmcnt(6)
rd_99:
    s_cmp_lt_u32 s3, 4
    s_cbranch_scc1 rd_100
    v_add_u32 v11, 0, v10
    ds_read_b64_tr_b16 v[96:97], v11 offset:0
    ds_read_b64_tr_b16 v[98:99], v11 offset:1536
    ds_read_b64_tr_b16 v[100:101], v11 offset:12288
    ds_read_b64_tr_b16 v[102:103], v11 offset:13824
    ds_read_b64_tr_b16 v[104:105], v11 offset:24576
    ds_read_b64_tr_b16 v[106:107], v11 offset:26112
    ds_read_b64_tr_b16 v[108:109], v11 offset:36864
    ds_read_b64_tr_b16 v[110:111], v11 offset:38400
    s_waitcnt lgkmcnt(6)
rd_100:
    s_waitcnt lgkmcnt(0)
    s_barrier
    s_mul_i32 s63, s3, 3072
    s_add_u32 s63, s63, 0
    s_mul_i32 s64, s3, 98304
    s_add_u32 s64, s64, s62
    s_add_u32 s64, s64, 4718592
    s_mov_b32 m0, s63
    s_add_u32 s63, s63, 1024
    buffer_load_dwordx4 v2, s[48:51], s64 offen lds
    s_mov_b32 m0, s63
    s_add_u32 s63, s63, 1024
    buffer_load_dwordx4 v3, s[48:51], s64 offen lds
    s_mov_b32 m0, s63
    s_add_u32 s63, s63, 22528
    buffer_load_dwordx4 v4, s[48:51], s64 offen lds
    s_add_u32 s64, s64, 786432
    s_mov_b32 m0, s63
    s_add_u32 s63, s63, 1024
    buffer_load_dwordx4 v2, s[48:51], s64 offen lds
    s_mov_b32 m0, s63
    s_add_u32 s63, s63, 1024
    buffer_load_dwordx4 v3, s[48:51], s64 offen lds
    s_mov_b32 m0, s63
    s_add_u32 s63, s63, 22528
    buffer_load_dwordx4 v4, s[48:51], s64 offen lds
    s_add_u32 s64, s64, 786432
    s_waitcnt vmcnt(12)
    s_barrier
    s_cmp_lt_u32 s3, 4
    s_cbranch_scc0 rd_101
    v_add_u32 v11, 49152, v10
    ds_read_b64_tr_b16 v[112:113], v11 offset:0
    ds_read_b64_tr_b16 v[114:115], v11 offset:1536
    ds_read_b64_tr_b16 v[192:193], v11 offset:6144
    ds_read_b64_tr_b16 v[194:195], v11 offset:7680
    ds_read_b64_tr_b16 v[116:117], v11 offset:12288
    ds_read_b64_tr_b16 v[118:119], v11 offset:13824
    ds_read_b64_tr_b16 v[196:197], v11 offset:18432
    ds_read_b64_tr_b16 v[198:199], v11 offset:19968
    s_waitcnt lgkmcnt(6)
    ds_read_b64_tr_b16 v[120:121], v11 offset:24576
    ds_read_b64_tr_b16 v[122:123], v11 offset:26112
    ds_read_b64_tr_b16 v[200:201], v11 offset:30720
    ds_read_b64_tr_b16 v[202:203], v11 offset:32256
    ds_read_b64_tr_b16 v[124:125], v11 offset:36864
    ds_read_b64_tr_b16 v[126:127], v11 offset:38400
    ds_read_b64_tr_b16 v[204:205], v11 offset:43008
    ds_read_b64_tr_b16 v[206:207], v11 offset:44544
    s_waitcnt lgkmcnt(6)
rd_101:
    s_cmp_lt_u32 s3, 4
    s_cbranch_scc1 rd_102
    v_add_u32 v11, 49152, v10
    ds_read_b64_tr_b16 v[112:113], v11 offset:0
    ds_read_b64_tr_b16 v[114:115], v11 offset:1536
    ds_read_b64_tr_b16 v[116:117], v11 offset:12288
    ds_read_b64_tr_b16 v[118:119], v11 offset:13824
    ds_read_b64_tr_b16 v[120:121], v11 offset:24576
    ds_read_b64_tr_b16 v[122:123], v11 offset:26112
    ds_read_b64_tr_b16 v[124:125], v11 offset:36864
    ds_read_b64_tr_b16 v[126:127], v11 offset:38400
    s_waitcnt lgkmcnt(6)
rd_102:
    s_waitcnt lgkmcnt(0)
    s_barrier
    s_mul_i32 s63, s3, 3072
    s_add_u32 s63, s63, 49152
    s_mul_i32 s64, s3, 98304
    s_add_u32 s64, s64, s62
    s_add_u32 s64, s64, 6291456
    s_mov_b32 m0, s63
    s_add_u32 s63, s63, 1024
    buffer_load_dwordx4 v2, s[48:51], s64 offen lds
    s_mov_b32 m0, s63
    s_add_u32 s63, s63, 1024
    buffer_load_dwordx4 v3, s[48:51], s64 offen lds
    s_mov_b32 m0, s63
    s_add_u32 s63, s63, 22528
    buffer_load_dwordx4 v4, s[48:51], s64 offen lds
    s_add_u32 s64, s64, 786432
    s_mov_b32 m0, s63
    s_add_u32 s63, s63, 1024
    buffer_load_dwordx4 v2, s[48:51], s64 offen lds
    s_mov_b32 m0, s63
    s_add_u32 s63, s63, 1024
    buffer_load_dwordx4 v3, s[48:51], s64 offen lds
    s_mov_b32 m0, s63
    s_add_u32 s63, s63, 22528
    buffer_load_dwordx4 v4, s[48:51], s64 offen lds
    s_add_u32 s64, s64, 786432
    s_waitcnt vmcnt(12)
    s_barrier
    s_cmp_lt_u32 s3, 4
    s_cbranch_scc0 rd_103
    v_add_u32 v11, 98304, v10
    ds_read_b64_tr_b16 v[128:129], v11 offset:0
    ds_read_b64_tr_b16 v[130:131], v11 offset:1536
    ds_read_b64_tr_b16 v[208:209], v11 offset:6144
    ds_read_b64_tr_b16 v[210:211], v11 offset:7680
    ds_read_b64_tr_b16 v[132:133], v11 offset:12288
    ds_read_b64_tr_b16 v[134:135], v11 offset:13824
    ds_read_b64_tr_b16 v[212:213], v11 offset:18432
    ds_read_b64_tr_b16 v[214:215], v11 offset:19968
    s_waitcnt lgkmcnt(6)
    ds_read_b64_tr_b16 v[136:137], v11 offset:24576
    ds_read_b64_tr_b16 v[138:139], v11 offset:26112
    ds_read_b64_tr_b16 v[216:217], v11 offset:30720
    ds_read_b64_tr_b16 v[218:219], v11 offset:32256
    ds_read_b64_tr_b16 v[140:141], v11 offset:36864
    ds_read_b64_tr_b16 v[142:143], v11 offset:38400
    ds_read_b64_tr_b16 v[220:221], v11 offset:43008
    ds_read_b64_tr_b16 v[222:223], v11 offset:44544
    s_waitcnt lgkmcnt(6)
rd_103:
    s_cmp_lt_u32 s3, 4
    s_cbranch_scc1 rd_104
    v_add_u32 v11, 98304, v10
    ds_read_b64_tr_b16 v[128:129], v11 offset:0
    ds_read_b64_tr_b16 v[130:131], v11 offset:1536
    ds_read_b64_tr_b16 v[132:133], v11 offset:12288
    ds_read_b64_tr_b16 v[134:135], v11 offset:13824
    ds_read_b64_tr_b16 v[136:137], v11 offset:24576
    ds_read_b64_tr_b16 v[138:139], v11 offset:26112
    ds_read_b64_tr_b16 v[140:141], v11 offset:36864
    ds_read_b64_tr_b16 v[142:143], v11 offset:38400
    s_waitcnt lgkmcnt(6)
rd_104:
    s_waitcnt lgkmcnt(0)
    s_barrier
    s_waitcnt vmcnt(6)
    s_barrier
    s_cmp_lt_u32 s3, 4
    s_cbranch_scc0 rd_105
    v_add_u32 v11, 0, v10
    ds_read_b64_tr_b16 v[144:145], v11 offset:0
    ds_read_b64_tr_b16 v[146:147], v11 offset:1536
    ds_read_b64_tr_b16 v[224:225], v11 offset:6144
    ds_read_b64_tr_b16 v[226:227], v11 offset:7680
    ds_read_b64_tr_b16 v[148:149], v11 offset:12288
    ds_read_b64_tr_b16 v[150:151], v11 offset:13824
    ds_read_b64_tr_b16 v[228:229], v11 offset:18432
    ds_read_b64_tr_b16 v[230:231], v11 offset:19968
    s_waitcnt lgkmcnt(6)
    ds_read_b64_tr_b16 v[152:153], v11 offset:24576
    ds_read_b64_tr_b16 v[154:155], v11 offset:26112
    ds_read_b64_tr_b16 v[232:233], v11 offset:30720
    ds_read_b64_tr_b16 v[234:235], v11 offset:32256
    ds_read_b64_tr_b16 v[156:157], v11 offset:36864
    ds_read_b64_tr_b16 v[158:159], v11 offset:38400
    ds_read_b64_tr_b16 v[236:237], v11 offset:43008
    ds_read_b64_tr_b16 v[238:239], v11 offset:44544
    s_waitcnt lgkmcnt(6)
rd_105:
    s_cmp_lt_u32 s3, 4
    s_cbranch_scc1 rd_106
    v_add_u32 v11, 0, v10
    ds_read_b64_tr_b16 v[144:145], v11 offset:0
    ds_read_b64_tr_b16 v[146:147], v11 offset:1536
    ds_read_b64_tr_b16 v[148:149], v11 offset:12288
    ds_read_b64_tr_b16 v[150:151], v11 offset:13824
    ds_read_b64_tr_b16 v[152:153], v11 offset:24576
    ds_read_b64_tr_b16 v[154:155], v11 offset:26112
    ds_read_b64_tr_b16 v[156:157], v11 offset:36864
    ds_read_b64_tr_b16 v[158:159], v11 offset:38400
    s_waitcnt lgkmcnt(6)
rd_106:
    s_waitcnt lgkmcnt(0)
    s_barrier
    s_waitcnt vmcnt(0)
    s_barrier
    s_cmp_lt_u32 s3, 4
    s_cbranch_scc0 rd_107
    v_add_u32 v11, 49152, v10
    ds_read_b64_tr_b16 v[160:161], v11 offset:0
    ds_read_b64_tr_b16 v[162:163], v11 offset:1536
    ds_read_b64_tr_b16 v[240:241], v11 offset:6144
    ds_read_b64_tr_b16 v[242:243], v11 offset:7680
    ds_read_b64_tr_b16 v[164:165], v11 offset:12288
    ds_read_b64_tr_b16 v[166:167], v11 offset:13824
    ds_read_b64_tr_b16 v[244:245], v11 offset:18432
    ds_read_b64_tr_b16 v[246:247], v11 offset:19968
    s_waitcnt lgkmcnt(6)
    ds_read_b64_tr_b16 v[168:169], v11 offset:24576
    ds_read_b64_tr_b16 v[170:171], v11 offset:26112
    ds_read_b64_tr_b16 v[248:249], v11 offset:30720
    ds_read_b64_tr_b16 v[250:251], v11 offset:32256
    ds_read_b64_tr_b16 v[172:173], v11 offset:36864
    ds_read_b64_tr_b16 v[174:175], v11 offset:38400
    ds_read_b64_tr_b16 v[252:253], v11 offset:43008
    ds_read_b64_tr_b16 v[254:255], v11 offset:44544
    s_waitcnt lgkmcnt(6)
rd_107:
    s_cmp_lt_u32 s3, 4
    s_cbranch_scc1 rd_108
    v_add_u32 v11, 49152, v10
    ds_read_b64_tr_b16 v[160:161], v11 offset:0
    ds_read_b64_tr_b16 v[162:163], v11 offset:1536
    ds_read_b64_tr_b16 v[164:165], v11 offset:12288
    ds_read_b64_tr_b16 v[166:167], v11 offset:13824
    ds_read_b64_tr_b16 v[168:169], v11 offset:24576
    ds_read_b64_tr_b16 v[170:171], v11 offset:26112
    ds_read_b64_tr_b16 v[172:173], v11 offset:36864
    ds_read_b64_tr_b16 v[174:175], v11 offset:38400
    s_waitcnt lgkmcnt(6)
rd_108:
    s_waitcnt lgkmcnt(0)
    s_barrier
    v_mov_b32 v8, 0
    s_cmp_eq_u32 s3, 0
    s_cbranch_scc0 wao_111
    s_mov_b32 s76, 1000000
wa_109:
    buffer_load_dword v9, v8, s[56:59], s10 offen offset:128 sc1
    s_sub_u32 s76, s76, 1
    s_cbranch_scc1 wad_110
    s_waitcnt vmcnt(0)
    v_readfirstlane_b32 s63, v9
    s_cmp_lg_u32 s63, 0
    s_cbranch_scc1 wad_110
    s_sleep 8
    s_branch wa_109
wad_110:
    s_waitcnt vmcnt(0)
    ds_write_b32 v8, v9
    s_waitcnt lgkmcnt(0)
wao_111:
    s_barrier
    ds_read_b32 v9, v8
    s_waitcnt lgkmcnt(0)
    v_readfirstlane_b32 s63, v9
    s_cmp_lg_u32 s63, 1
    s_cselect_b32 s6, 1, 0
    s_waitcnt vmcnt(0)
    s_barrier
    s_cbranch_scc0 wak_112
    s_cmp_eq_u32 s10, 0
    s_mov_b32 s10, 16
    s_cbranch_scc1 L_restart
wak_112:
    v_lshlrev_b32 v7, 4, v1
    v_mov_b32 v9, v7
    s_cmp_lt_u32 s3, 4
    s_cbranch_scc0 q_113
    v_bfe_u32 v9, v1, 4, 1
    v_mul_u32_u24 v9, 6144, v9
    v_and_b32 v10, 15, v1
    v_lshlrev_b32 v10, 4, v10
    v_add_u32 v9, v9, v10
    v_lshrrev_b32 v10, 5, v1
    v_lshlrev_b32 v10, 9, v10
    v_add_u32 v9, v9, v10
    v_bfe_u32 v72, v1, 4, 1
    v_mul_u32_u24 v72, 20480, v72
    v_and_b32 v10, 15, v1
    v_lshlrev_b32 v10, 4, v10
    v_add_u32 v72, v72, v10
    v_lshrrev_b32 v10, 5, v1
    v_lshlrev_b32 v10, 8, v10
    v_add_u32 v72, v72, v10
    v_sub_u32 v72, v72, v7
    s_lshl_b32 s64, s3, 10
    s_branch q_114
q_113:
    s_lshl_b32 s64, s3, 9
    s_add_u32 s64, s64, 2048
    v_lshrrev_b32 v9, 5, v1
    v_lshlrev_b32 v9, 8, v9
    v_and_b32 v10, 15, v1
    v_lshlrev_b32 v10, 4, v10
    v_add_u32 v9, v9, v10
    v_bfe_u32 v10, v1, 4, 1
    v_lshlrev_b32 v10, 3, v10
    v_add_u32 v9, v9, v10
q_114:
    s_add_u32 s64, s64, 81920
    v_add_u32 v9, s64, v9
    s_lshl_b32 s63, s60, 3
    s_add_u32 s63, s63, s4
    s_lshl_b32 s63, s63, 7
    s_add_u32 s63, s63, 156807168
    v_min_u32 v10, 1, v1
    v_lshlrev_b32 v10, 12, v10
    v_add_u32 v10, s63, v10
    s_lshl_b32 s63, s61, 7
    s_add_u32 s63, s63, 156835840
    v_min_u32 v11, 2, v1
    v_lshlrev_b32 v11, 2, v11
    v_add_u32 v11, s63, v11
    s_mov_b32 s77, 0
    s_mov_b32 s78, 0
    s_and_b32 s79, s3, 1
    s_bfe_u32 s80, s3, 0x10001
    v_lshrrev_b32 v12, 4, v1
    v_lshlrev_b32 v12, 2, v12
    v_and_b32 v13, 15, v1
    v_add_u32 v14, 0, v12
    v_cmp_gt_u32 s[82:83], v14, v13
    v_add_u32 v14, 1, v12
    v_cmp_gt_u32 s[84:85], v14, v13
    v_add_u32 v14, 2, v12
    v_cmp_gt_u32 s[86:87], v14, v13
    v_add_u32 v14, 3, v12
    v_cmp_gt_u32 s[88:89], v14, v13
    s_mul_i32 s63, s79, 6144
    s_add_u32 s63, s63, 81920
    v_add_u32 v12, s63, v7
    s_mul_i32 s63, s80, 6144
    s_add_u32 s63, s63, 118784
    v_add_u32 v13, s63, v7
    s_mul_i32 s63, s61, 3072
    s_mul_i32 s64, s80, 1536
    s_add_u32 s63, s63, s64
    s_add_u32 s63, s63, 180355072
    v_lshlrev_b32 v14, 2, v1
    v_add_u32 v14, s63, v14
    s_lshl_b32 s63, s79, 5
    s_add_u32 s63, s63, s61
    s_mul_i32 s63, s63, 6144
    s_mul_i32 s64, s80, 3072
    s_add_u32 s63, s63, s64
    s_add_u32 s63, s63, 54525952
    v_add_u32 v15, s63, v7
    v_add_u32 v6, 106496, v7
    s_mul_i32 s63, s61, 6144
    s_add_u32 s63, s63, 167772160
    v_lshrrev_b32 v5, 2, v1
    v_lshlrev_b32 v5, 5, v5
    v_and_b32 v4, 1, v1
    v_lshlrev_b32 v4, 4, v4
    v_add_u32 v5, v5, v4
    v_and_b32 v4, 2, v1
    v_lshlrev_b32 v4, 29, v4
    v_add_u32 v5, v5, v4
    v_add_u32 v5, s63, v5
    s_mov_b32 s81, 0x3dd53b95
    s_mov_b32 s90, s81
    s_mov_b32 s91, s81
    s_cmp_lt_u32 s3, 4
    s_cbranch_scc1 qp_115
    s_setprio 2
qp_115:
    s_lshl_b32 s63, s4, 7
    s_add_u32 s63, s63, 156819456
    v_min_u32 v0, 3, v1
    v_lshlrev_b32 v0, 10, v0
    v_add_u32 v0, s63, v0
    s_mov_b32 s66, 0
    s_mov_b32 s73, 0
    s_mov_b32 s70, 0
    s_mov_b32 s71, 0
    s_lshl_b32 s63, s3, 10
    s_add_u32 s64, s63, s70
    s_add_u32 s63, s63, s71
    s_mov_b32 m0, s63
    s_add_u32 s63, s63, 8192
    buffer_load_dwordx4 v7, s[44:47], s64 offen sc1 lds
    s_add_u32 s64, s64, 8192
    s_mov_b32 m0, s63
    s_add_u32 s63, s63, 8192
    buffer_load_dwordx4 v7, s[44:47], s64 offen sc1 lds
    s_add_u32 s64, s64, 8192
    s_mov_b32 m0, s63
    s_add_u32 s63, s63, 8192
    buffer_load_dwordx4 v7, s[44:47], s64 offen sc1 lds
    s_add_u32 s64, s64, 8192
    s_mov_b32 m0, s63
    s_add_u32 s63, s63, 8192
    buffer_load_dwordx4 v7, s[44:47], s64 offen sc1 lds
    s_add_u32 s64, s64, 8192
    s_mov_b32 m0, s63
    s_add_u32 s63, s63, 8192
    buffer_load_dwordx4 v7, s[44:47], s64 offen sc1 lds
    s_add_u32 s64, s64, 8192
    .p2align 6
ql_116:
    s_add_u32 s75, s73, 1
    s_min_u32 s75, s75, 64
    s_cmp_eq_u32 s3, 0
    s_cbranch_scc0 w0_121
    s_cmp_ge_u32 s77, s75
    s_cbranch_scc1 fwd_123
    s_mov_b32 s76, 4000000
fw_122:
    buffer_load_dword v2, v10, s[44:47], 0 offen sc1
    s_sub_u32 s76, s76, 1
    s_cbranch_scc1 fwd_123
    s_waitcnt vmcnt(0)
    v_cmp_gt_u32 vcc, s75, v2
    s_cbranch_vccz fwo_124
    s_sleep 2
    s_branch fw_122
fwo_124:
    s_add_u32 s76, s75, 3
    v_cmp_gt_u32 vcc, s76, v2
    s_cmp_eq_u64 vcc, 0
    s_cselect_b32 s77, s76, s75
fwd_123:
w0_121:
    s_max_u32 s75, s73, 8
    s_sub_u32 s75, s75, 8
    s_cmp_eq_u32 s3, 0
    s_cbranch_scc0 w0_125
    s_cmp_ge_u32 s66, s75
    s_cbranch_scc1 fwd_127
    s_mov_b32 s76, 4000000
fw_126:
    buffer_load_dword v2, v0, s[44:47], 0 offen sc1
    s_sub_u32 s76, s76, 1
    s_cbranch_scc1 fwd_127
    s_waitcnt vmcnt(0)
    v_cmp_gt_u32 vcc, s75, v2
    s_cbranch_vccz fwo_128
    s_sleep 2
    s_branch fw_126
fwo_128:
    s_add_u32 s76, s75, 4
    v_cmp_gt_u32 vcc, s76, v2
    s_cmp_eq_u64 vcc, 0
    s_cselect_b32 s66, s76, s75
fwd_127:
w0_125:
    s_waitcnt vmcnt(0) lgkmcnt(0)
    s_barrier
    s_max_u32 s75, s73, 1
    s_sub_u32 s75, s75, 1
    s_cmp_eq_u32 s3, 0
    s_cbranch_scc0 fs_129
    v_mov_b32 v2, 0
    v_mov_b32 v3, s75
    s_cmp_lg_u32 s6, 0
    s_cbranch_scc1 sf_130
    buffer_store_dword v3, v2, s[44:47], s8 offen
    s_branch sd_131
sf_130:
    buffer_store_dword v3, v2, s[44:47], s8 offen sc1
sd_131:
fs_129:
    s_cmp_eq_u32 s73, 65
    s_cbranch_scc1 qf_120
    s_and_b32 s72, s73, 1
    s_mov_b32 s69, 0
    s_mov_b32 s67, 0
    s_cmp_eq_u32 s73, 64
    s_cbranch_scc1 qnp_132
    s_add_u32 s74, s73, 1
    s_min_u32 s74, s74, 63
    s_mul_i32 s70, s74, 40960
    s_lshl_b32 s63, s3, 10
    s_add_u32 s70, s70, s63
    s_mul_i32 s64, s72, 40960
    v_add_u32 v8, s64, v7
    s_xor_b32 s71, s64, 40960
    s_add_u32 s71, s71, s63
    s_mul_i32 s64, s72, 12288
    v_add_u32 v3, s64, v9
    s_cmp_lt_u32 s3, 4
    s_cbranch_scc0 qs_117
    s_lshl_b32 s74, s73, 5
    s_add_u32 s74, s74, s61
    s_mul_i32 s74, s74, 12288
    s_add_u32 s74, s74, s63
    s_add_u32 s64, s74, 29360128
    s_add_u32 s74, s74, 4194304
    s_mul_i32 s65, s72, 24576
    s_add_u32 s65, s65, s63
    s_add_u32 s65, s65, 106496
    v_add_u32 v8, v8, v72
    ds_read_b128 v[16:19], v8 offset:0
    ds_read_b128 v[20:23], v8 offset:512
    ds_read_b128 v[24:27], v8 offset:1024
    ds_read_b128 v[28:31], v8 offset:1536
    ds_read_b128 v[32:35], v8 offset:2048
    ds_read_b128 v[36:39], v8 offset:2560
    ds_read_b128 v[40:43], v8 offset:3072
    ds_read_b128 v[44:47], v8 offset:3584
    s_waitcnt lgkmcnt(7)
    v_mfma_f32_32x32x16_bf16 v[48:63], v[96:99], v[16:19], 0
    ds_read_b128 v[16:19], v8 offset:4096
    s_mov_b32 m0, s65
    s_add_u32 s65, s65, 4096
    buffer_load_dwordx4 v7, s[44:47], s74 offen sc1 lds
    s_add_u32 s74, s74, 4096
    s_waitcnt lgkmcnt(7)
    v_mfma_f32_32x32x16_bf16 v[48:63], v[176:179], v[20:23], v[48:63]
    ds_read_b128 v[20:23], v8 offset:4608
    s_mov_b32 m0, s65
    s_add_u32 s65, s65, 4096
    buffer_load_dwordx4 v7, s[44:47], s74 offen sc1 lds
    s_add_u32 s74, s74, 4096
    s_waitcnt lgkmcnt(7)
    v_mfma_f32_32x32x16_bf16 v[48:63], v[100:103], v[24:27], v[48:63]
    ds_read_b128 v[24:27], v8 offset:5120
    s_mov_b32 m0, s65
    s_add_u32 s65, s65, 4096
    buffer_load_dwordx4 v7, s[44:47], s74 offen sc1 lds
    s_add_u32 s74, s74, 4096
    s_waitcnt lgkmcnt(7)
    v_mfma_f32_32x32x16_bf16 v[48:63], v[180:183], v[28:31], v[48:63]
    ds_read_b128 v[28:31], v8 offset:5632
    s_mov_b32 m0, s65
    s_add_u32 s65, s65, 4096
    buffer_load_dwordx4 v7, s[44:47], s64 offen sc1 lds
    s_add_u32 s64, s64, 4096
    s_waitcnt lgkmcnt(7)
    v_mfma_f32_32x32x16_bf16 v[48:63], v[104:107], v[32:35], v[48:63]
    ds_read_b128 v[32:35], v8 offset:6144
    s_mov_b32 m0, s65
    s_add_u32 s65, s65, 4096
    buffer_load_dwordx4 v7, s[44:47], s64 offen sc1 lds
    s_add_u32 s64, s64, 4096
    s_waitcnt lgkmcnt(7)
    v_mfma_f32_32x32x16_bf16 v[48:63], v[184:187], v[36:39], v[48:63]
    ds_read_b128 v[36:39], v8 offset:6656
    s_mov_b32 m0, s65
    s_add_u32 s65, s65, 4096
    buffer_load_dwordx4 v7, s[44:47], s64 offen sc1 lds
    s_add_u32 s64, s64, 4096
    s_waitcnt lgkmcnt(7)
    v_mfma_f32_32x32x16_bf16 v[48:63], v[108:111], v[40:43], v[48:63]
    ds_read_b128 v[40:43], v8 offset:7168
    s_mov_b32 m0, s71
    s_add_u32 s71, s71, 4096
    buffer_load_dwordx4 v7, s[44:47], s70 offen sc1 lds
    s_add_u32 s70, s70, 4096
    s_waitcnt lgkmcnt(7)
    v_mfma_f32_32x32x16_bf16 v[48:63], v[188:191], v[44:47], v[48:63]
    ds_read_b128 v[44:47], v8 offset:7680
    s_mov_b32 m0, s71
    s_add_u32 s71, s71, 4096
    buffer_load_dwordx4 v7, s[44:47], s70 offen sc1 lds
    s_add_u32 s70, s70, 4096
    s_waitcnt lgkmcnt(7)
    v_mfma_f32_32x32x16_bf16 v[48:63], v[112:115], v[16:19], v[48:63]
    ds_read_b128 v[16:19], v8 offset:8192
    s_mov_b32 m0, s71
    s_add_u32 s71, s71, 4096
    buffer_load_dwordx4 v7, s[44:47], s70 offen sc1 lds
    s_add_u32 s70, s70, 4096
    s_waitcnt lgkmcnt(7)
    v_mfma_f32_32x32x16_bf16 v[48:63], v[192:195], v[20:23], v[48:63]
    ds_read_b128 v[20:23], v8 offset:8704
    s_mov_b32 m0, s71
    s_add_u32 s71, s71, 4096
    buffer_load_dwordx4 v7, s[44:47], s70 offen sc1 lds
    s_add_u32 s70, s70, 4096
    s_waitcnt lgkmcnt(7)
    v_mfma_f32_32x32x16_bf16 v[48:63], v[116:119], v[24:27], v[48:63]
    ds_read_b128 v[24:27], v8 offset:9216
    s_mov_b32 m0, s71
    s_add_u32 s71, s71, 4096
    buffer_load_dwordx4 v7, s[44:47], s70 offen sc1 lds
    s_add_u32 s70, s70, 4096
    s_waitcnt lgkmcnt(7)
    v_mfma_f32_32x32x16_bf16 v[48:63], v[196:199], v[28:31], v[48:63]
    ds_read_b128 v[28:31], v8 offset:9728
    s_mov_b32 m0, s71
    s_add_u32 s71, s71, 4096
    buffer_load_dwordx4 v7, s[44:47], s70 offen sc1 lds
    s_add_u32 s70, s70, 4096
    s_waitcnt lgkmcnt(7)
    v_mfma_f32_32x32x16_bf16 v[48:63], v[120:123], v[32:35], v[48:63]
    ds_read_b128 v[32:35], v8 offset:10240
    s_mov_b32 m0, s71
    s_add_u32 s71, s71, 4096
    buffer_load_dwordx4 v7, s[44:47], s70 offen sc1 lds
    s_add_u32 s70, s70, 4096
    s_waitcnt lgkmcnt(7)
    v_mfma_f32_32x32x16_bf16 v[48:63], v[200:203], v[36:39], v[48:63]
    ds_read_b128 v[36:39], v8 offset:10752
    s_mov_b32 m0, s71
    s_add_u32 s71, s71, 4096
    buffer_load_dwordx4 v7, s[44:47], s70 offen sc1 lds
    s_add_u32 s70, s70, 4096
    s_waitcnt lgkmcnt(7)
    v_mfma_f32_32x32x16_bf16 v[48:63], v[124:127], v[40:43], v[48:63]
    ds_read_b128 v[40:43], v8 offset:11264
    s_mov_b32 m0, s71
    s_add_u32 s71, s71, 4096
    buffer_load_dwordx4 v7, s[44:47], s70 offen sc1 lds
    s_add_u32 s70, s70, 4096
    s_waitcnt lgkmcnt(7)
    v_mfma_f32_32x32x16_bf16 v[48:63], v[204:207], v[44:47], v[48:63]
    ds_read_b128 v[44:47], v8 offset:11776
    s_mov_b32 m0, s71
    s_add_u32 s71, s71, 4096
    buffer_load_dwordx4 v7, s[44:47], s70 offen sc1 lds
    s_add_u32 s70, s70, 4096
    s_waitcnt lgkmcnt(7)
    v_mfma_f32_32x32x16_bf16 v[48:63], v[128:131], v[16:19], v[48:63]
    ds_read_b128 v[16:19], v8 offset:12288
    s_waitcnt lgkmcnt(7)
    v_mfma_f32_32x32x16_bf16 v[48:63], v[208:211], v[20:23], v[48:63]
    ds_read_b128 v[20:23], v8 offset:12800
    s_waitcnt lgkmcnt(7)
    v_mfma_f32_32x32x16_bf16 v[48:63], v[132:135], v[24:27], v[48:63]
    ds_read_b128 v[24:27], v8 offset:13312
    s_waitcnt lgkmcnt(7)
    v_mfma_f32_32x32x16_bf16 v[48:63], v[212:215], v[28:31], v[48:63]
    ds_read_b128 v[28:31], v8 offset:13824
    s_waitcnt lgkmcnt(7)
    v_mfma_f32_32x32x16_bf16 v[48:63], v[136:139], v[32:35], v[48:63]
    ds_read_b128 v[32:35], v8 offset:14336
    s_waitcnt lgkmcnt(7)
    v_mfma_f32_32x32x16_bf16 v[48:63], v[216:219], v[36:39], v[48:63]
    ds_read_b128 v[36:39], v8 offset:14848
    s_waitcnt lgkmcnt(7)
    v_mfma_f32_32x32x16_bf16 v[48:63], v[140:143], v[40:43], v[48:63]
    ds_read_b128 v[40:43], v8 offset:15360
    s_waitcnt lgkmcnt(7)
    v_mfma_f32_32x32x16_bf16 v[48:63], v[220:223], v[44:47], v[48:63]
    ds_read_b128 v[44:47], v8 offset:15872
    s_waitcnt lgkmcnt(7)
    v_mfma_f32_32x32x16_bf16 v[48:63], v[144:147], v[16:19], v[48:63]
    ds_read_b128 v[16:19], v8 offset:16384
    s_waitcnt lgkmcnt(7)
    v_mfma_f32_32x32x16_bf16 v[48:63], v[224:227], v[20:23], v[48:63]
    ds_read_b128 v[20:23], v8 offset:16896
    s_waitcnt lgkmcnt(7)
    v_mfma_f32_32x32x16_bf16 v[48:63], v[148:151], v[24:27], v[48:63]
    ds_read_b128 v[24:27], v8 offset:17408
    s_waitcnt lgkmcnt(7)
    v_mfma_f32_32x32x16_bf16 v[48:63], v[228:231], v[28:31], v[48:63]
    ds_read_b128 v[28:31], v8 offset:17920
    s_waitcnt lgkmcnt(7)
    v_mfma_f32_32x32x16_bf16 v[48:63], v[152:155], v[32:35], v[48:63]
    ds_read_b128 v[32:35], v8 offset:18432
    s_waitcnt lgkmcnt(7)
    v_mfma_f32_32x32x16_bf16 v[48:63], v[232:235], v[36:39], v[48:63]
    ds_read_b128 v[36:39], v8 offset:18944
    s_waitcnt lgkmcnt(7)
    v_mfma_f32_32x32x16_bf16 v[48:63], v[156:159], v[40:43], v[48:63]
    ds_read_b128 v[40:43], v8 offset:19456
    s_waitcnt lgkmcnt(7)
    v_mfma_f32_32x32x16_bf16 v[48:63], v[236:239], v[44:47], v[48:63]
    ds_read_b128 v[44:47], v8 offset:19968
    s_waitcnt lgkmcnt(7)
    v_mfma_f32_32x32x16_bf16 v[48:63], v[160:163], v[16:19], v[48:63]
    s_waitcnt lgkmcnt(6)
    v_mfma_f32_32x32x16_bf16 v[48:63], v[240:243], v[20:23], v[48:63]
    s_waitcnt lgkmcnt(5)
    v_mfma_f32_32x32x16_bf16 v[48:63], v[164:167], v[24:27], v[48:63]
    s_waitcnt lgkmcnt(4)
    v_mfma_f32_32x32x16_bf16 v[48:63], v[244:247], v[28:31], v[48:63]
    s_waitcnt lgkmcnt(3)
    v_mfma_f32_32x32x16_bf16 v[48:63], v[168:171], v[32:35], v[48:63]
    s_waitcnt lgkmcnt(2)
    v_mfma_f32_32x32x16_bf16 v[48:63], v[248:251], v[36:39], v[48:63]
    s_waitcnt lgkmcnt(1)
    v_mfma_f32_32x32x16_bf16 v[48:63], v[172:175], v[40:43], v[48:63]
    s_waitcnt lgkmcnt(0)
    v_mfma_f32_32x32x16_bf16 v[48:63], v[252:255], v[44:47], v[48:63]
    s_nop 11
    v_cvt_pk_bf16_f32 v64, v48, v49
    v_cvt_pk_bf16_f32 v65, v50, v51
    v_cvt_pk_bf16_f32 v66, v52, v53
    v_cvt_pk_bf16_f32 v67, v54, v55
    v_cvt_pk_bf16_f32 v68, v56, v57
    v_cvt_pk_bf16_f32 v69, v58, v59
    v_cvt_pk_bf16_f32 v70, v60, v61
    v_cvt_pk_bf16_f32 v71, v62, v63
    ds_write_b128 v3, v[64:67]
    ds_write_b128 v3, v[68:71] offset:256
    s_branch qj_118
    .p2align 6
qs_117:
    s_cmp_eq_u32 s73, 0
    s_cbranch_scc1 qne_133
    s_cmp_ge_u32 s78, s73
    s_cbranch_scc0 qne_133
    s_sub_u32 s75, s73, 1
    s_mul_i32 s68, s75, 196608
    buffer_load_dwordx4 v[212:215], v5, s[44:47], s68 offen offset:0 sc1
    buffer_load_dwordx4 v[216:219], v5, s[44:47], s68 offen offset:512 sc1
    buffer_load_dwordx4 v[220:223], v5, s[44:47], s68 offen offset:1024 sc1
    buffer_load_dwordx4 v[224:227], v5, s[44:47], s68 offen offset:1536 sc1
    buffer_load_dwordx4 v[228:231], v5, s[44:47], s68 offen offset:2048 sc1
    buffer_load_dwordx4 v[232:235], v5, s[44:47], s68 offen offset:2560 sc1
    s_lshr_b32 s75, s68, 1
    buffer_load_dword v200, v14, s[44:47], s75 offen offset:0 sc1
    buffer_load_dword v202, v14, s[44:47], s75 offen offset:256 sc1
    buffer_load_dword v204, v14, s[44:47], s75 offen offset:512 sc1
    buffer_load_dword v206, v14, s[44:47], s75 offen offset:768 sc1
    buffer_load_dword v208, v14, s[44:47], s75 offen offset:1024 sc1
    buffer_load_dword v210, v14, s[44:47], s75 offen offset:1280 sc1
    s_mov_b32 s69, 1
qne_133:
    ds_read_b128 v[16:19], v8 offset:0
    ds_read_b128 v[20:23], v8 offset:1024
    ds_read_b128 v[24:27], v8 offset:2048
    ds_read_b128 v[28:31], v8 offset:3072
    ds_read_b128 v[32:35], v8 offset:4096
    ds_read_b128 v[36:39], v8 offset:5120
    ds_read_b128 v[40:43], v8 offset:6144
    ds_read_b128 v[44:47], v8 offset:7168
    s_waitcnt lgkmcnt(7)
    v_mfma_f32_16x16x32_bf16 v[48:51], v[96:99], v[16:19], 0
    ds_read_b128 v[16:19], v8 offset:8192
    s_waitcnt lgkmcnt(7)
    v_mfma_f32_16x16x32_bf16 v[48:51], v[100:103], v[20:23], v[48:51]
    ds_read_b128 v[20:23], v8 offset:9216
    s_waitcnt lgkmcnt(7)
    v_mfma_f32_16x16x32_bf16 v[48:51], v[104:107], v[24:27], v[48:51]
    ds_read_b128 v[24:27], v8 offset:10240
    s_waitcnt lgkmcnt(7)
    v_mfma_f32_16x16x32_bf16 v[48:51], v[108:111], v[28:31], v[48:51]
    ds_read_b128 v[28:31], v8 offset:11264
    s_waitcnt lgkmcnt(7)
    v_mfma_f32_16x16x32_bf16 v[48:51], v[112:115], v[32:35], v[48:51]
    ds_read_b128 v[32:35], v8 offset:12288
    buffer_load_dword v62, v11, s[44:47], 0 offen sc1
    s_waitcnt lgkmcnt(7)
    v_mfma_f32_16x16x32_bf16 v[48:51], v[116:119], v[36:39], v[48:51]
    ds_read_b128 v[36:39], v8 offset:13312
    s_waitcnt lgkmcnt(7)
    v_mfma_f32_16x16x32_bf16 v[48:51], v[120:123], v[40:43], v[48:51]
    ds_read_b128 v[40:43], v8 offset:14336
    s_waitcnt lgkmcnt(7)
    v_mfma_f32_16x16x32_bf16 v[48:51], v[124:127], v[44:47], v[48:51]
    ds_read_b128 v[44:47], v8 offset:15360
    s_waitcnt lgkmcnt(7)
    v_mfma_f32_16x16x32_bf16 v[48:51], v[128:131], v[16:19], v[48:51]
    ds_read_b128 v[16:19], v8 offset:16384
    s_waitcnt lgkmcnt(7)
    v_mfma_f32_16x16x32_bf16 v[48:51], v[132:135], v[20:23], v[48:51]
    ds_read_b128 v[20:23], v8 offset:17408
    s_waitcnt lgkmcnt(7)
    v_mfma_f32_16x16x32_bf16 v[48:51], v[136:139], v[24:27], v[48:51]
    ds_read_b128 v[24:27], v8 offset:18432
    s_waitcnt lgkmcnt(7)
    v_mfma_f32_16x16x32_bf16 v[48:51], v[140:143], v[28:31], v[48:51]
    ds_read_b128 v[28:31], v8 offset:19456
    s_waitcnt lgkmcnt(7)
    v_mfma_f32_16x16x32_bf16 v[48:51], v[144:147], v[32:35], v[48:51]
    ds_read_b128 v[32:35], v8 offset:20480
    s_waitcnt lgkmcnt(7)
    v_mfma_f32_16x16x32_bf16 v[48:51], v[148:151], v[36:39], v[48:51]
    ds_read_b128 v[36:39], v8 offset:21504
    s_waitcnt lgkmcnt(7)
    v_mfma_f32_16x16x32_bf16 v[48:51], v[152:155], v[40:43], v[48:51]
    ds_read_b128 v[40:43], v8 offset:22528
    s_waitcnt lgkmcnt(7)
    v_mfma_f32_16x16x32_bf16 v[48:51], v[156:159], v[44:47], v[48:51]
    ds_read_b128 v[44:47], v8 offset:23552
    s_waitcnt lgkmcnt(7)
    v_mfma_f32_16x16x32_bf16 v[48:51], v[160:163], v[16:19], v[48:51]
    ds_read_b128 v[16:19], v8 offset:24576
    s_waitcnt lgkmcnt(7)
    v_mfma_f32_16x16x32_bf16 v[48:51], v[164:167], v[20:23], v[48:51]
    ds_read_b128 v[20:23], v8 offset:25600
    s_waitcnt lgkmcnt(7)
    v_mfma_f32_16x16x32_bf16 v[48:51], v[168:171], v[24:27], v[48:51]
    ds_read_b128 v[24:27], v8 offset:26624
    s_waitcnt lgkmcnt(7)
    v_mfma_f32_16x16x32_bf16 v[48:51], v[172:175], v[28:31], v[48:51]
    ds_read_b128 v[28:31], v8 offset:27648
    s_waitcnt lgkmcnt(7)
    v_mfma_f32_16x16x32_bf16 v[52:55], v[96:99], v[32:35], 0
    ds_read_b128 v[32:35], v8 offset:28672
    s_waitcnt lgkmcnt(7)
    v_mfma_f32_16x16x32_bf16 v[52:55], v[100:103], v[36:39], v[52:55]
    ds_read_b128 v[36:39], v8 offset:29696
    s_waitcnt lgkmcnt(7)
    v_mfma_f32_16x16x32_bf16 v[52:55], v[104:107], v[40:43], v[52:55]
    ds_read_b128 v[40:43], v8 offset:30720
    s_waitcnt lgkmcnt(7)
    v_mfma_f32_16x16x32_bf16 v[52:55], v[108:111], v[44:47], v[52:55]
    ds_read_b128 v[44:47], v8 offset:31744
    s_waitcnt lgkmcnt(7)
    v_mfma_f32_16x16x32_bf16 v[52:55], v[112:115], v[16:19], v[52:55]
    ds_read_b128 v[16:19], v8 offset:32768
    s_waitcnt lgkmcnt(7)
    v_mfma_f32_16x16x32_bf16 v[52:55], v[116:119], v[20:23], v[52:55]
    ds_read_b128 v[20:23], v8 offset:33792
    s_waitcnt lgkmcnt(7)
    v_mfma_f32_16x16x32_bf16 v[52:55], v[120:123], v[24:27], v[52:55]
    ds_read_b128 v[24:27], v8 offset:34816
    s_waitcnt lgkmcnt(7)
    v_mfma_f32_16x16x32_bf16 v[52:55], v[124:127], v[28:31], v[52:55]
    ds_read_b128 v[28:31], v8 offset:35840
    s_waitcnt lgkmcnt(7)
    v_mfma_f32_16x16x32_bf16 v[52:55], v[128:131], v[32:35], v[52:55]
    ds_read_b128 v[32:35], v8 offset:36864
    s_waitcnt lgkmcnt(7)
    v_mfma_f32_16x16x32_bf16 v[52:55], v[132:135], v[36:39], v[52:55]
    ds_read_b128 v[36:39], v8 offset:37888
    s_waitcnt lgkmcnt(7)
    v_mfma_f32_16x16x32_bf16 v[52:55], v[136:139], v[40:43], v[52:55]
    ds_read_b128 v[40:43], v8 offset:38912
    s_waitcnt lgkmcnt(7)
    v_mfma_f32_16x16x32_bf16 v[52:55], v[140:143], v[44:47], v[52:55]
    ds_read_b128 v[44:47], v8 offset:39936
    s_waitcnt lgkmcnt(7)
    v_mfma_f32_16x16x32_bf16 v[52:55], v[144:147], v[16:19], v[52:55]
    s_waitcnt lgkmcnt(6)
    v_mfma_f32_16x16x32_bf16 v[52:55], v[148:151], v[20:23], v[52:55]
    s_waitcnt lgkmcnt(5)
    v_mfma_f32_16x16x32_bf16 v[52:55], v[152:155], v[24:27], v[52:55]
    s_waitcnt lgkmcnt(4)
    v_mfma_f32_16x16x32_bf16 v[52:55], v[156:159], v[28:31], v[52:55]
    s_waitcnt lgkmcnt(3)
    v_mfma_f32_16x16x32_bf16 v[52:55], v[160:163], v[32:35], v[52:55]
    s_waitcnt lgkmcnt(2)
    v_mfma_f32_16x16x32_bf16 v[52:55], v[164:167], v[36:39], v[52:55]
    s_waitcnt lgkmcnt(1)
    v_mfma_f32_16x16x32_bf16 v[52:55], v[168:171], v[40:43], v[52:55]
    s_waitcnt lgkmcnt(0)
    v_mfma_f32_16x16x32_bf16 v[52:55], v[172:175], v[44:47], v[52:55]
    s_nop 7
    v_cvt_pk_bf16_f32 v64, v48, v49
    v_cvt_pk_bf16_f32 v65, v50, v51
    v_cvt_pk_bf16_f32 v66, v52, v53
    v_cvt_pk_bf16_f32 v67, v54, v55
    ds_write_b64 v3, v[64:65]
    ds_write_b64 v3, v[66:67] offset:6144
    s_waitcnt vmcnt(0)
    v_readlane_b32 s78, v62, 0
    v_readlane_b32 s76, v62, 1
    s_min_u32 s78, s78, s76
    v_readlane_b32 s76, v62, 2
    s_min_u32 s78, s78, s76
    s_cmp_eq_u32 s69, 1
    s_cbranch_scc1 qr2_135
    s_cmp_eq_u32 s73, 0
    s_cbranch_scc1 qr2_135
    s_cmp_ge_u32 s78, s73
    s_cbranch_scc0 qr2_135
    s_sub_u32 s75, s73, 1
    s_mul_i32 s68, s75, 196608
    buffer_load_dwordx4 v[212:215], v5, s[44:47], s68 offen offset:0 sc1
    buffer_load_dwordx4 v[216:219], v5, s[44:47], s68 offen offset:512 sc1
    buffer_load_dwordx4 v[220:223], v5, s[44:47], s68 offen offset:1024 sc1
    buffer_load_dwordx4 v[224:227], v5, s[44:47], s68 offen offset:1536 sc1
    buffer_load_dwordx4 v[228:231], v5, s[44:47], s68 offen offset:2048 sc1
    buffer_load_dwordx4 v[232:235], v5, s[44:47], s68 offen offset:2560 sc1
    s_lshr_b32 s75, s68, 1
    buffer_load_dword v200, v14, s[44:47], s75 offen offset:0 sc1
    buffer_load_dword v202, v14, s[44:47], s75 offen offset:256 sc1
    buffer_load_dword v204, v14, s[44:47], s75 offen offset:512 sc1
    buffer_load_dword v206, v14, s[44:47], s75 offen offset:768 sc1
    buffer_load_dword v208, v14, s[44:47], s75 offen offset:1024 sc1
    buffer_load_dword v210, v14, s[44:47], s75 offen offset:1280 sc1
    s_mov_b32 s69, 1
qr2_135:
qnp_132:
    s_cmp_lt_u32 s3, 4
    s_cbranch_scc1 qj_118
    s_cmp_eq_u32 s73, 0
    s_cbranch_scc1 qj_118
qat_134:
    s_xor_b32 s72, s72, 1
    s_mul_i32 s64, s72, 12288
    v_add_u32 v44, s64, v12
    s_lshl_b32 s64, s64, 1
    v_add_u32 v45, s64, v6
    v_add_u32 v46, s64, v13
    ds_read_b128 v[64:67], v44 offset:0
    ds_read_b128 v[68:71], v44 offset:1024
    ds_read_b128 v[72:75], v44 offset:2048
    ds_read_b128 v[76:79], v44 offset:3072
    ds_read_b128 v[80:83], v44 offset:4096
    ds_read_b128 v[84:87], v44 offset:5120
    ds_read_b128 v[16:19], v45 offset:0
    ds_read_b128 v[20:23], v45 offset:1024
    ds_read_b128 v[24:27], v45 offset:2048
    ds_read_b128 v[28:31], v45 offset:3072
    ds_read_b128 v[32:35], v45 offset:4096
    ds_read_b128 v[36:39], v45 offset:5120
    s_waitcnt lgkmcnt(5)
    v_mfma_f32_16x16x32_bf16 v[48:51], v[16:19], v[64:67], 0
    s_waitcnt lgkmcnt(4)
    v_mfma_f32_16x16x32_bf16 v[48:51], v[20:23], v[68:71], v[48:51]
    s_waitcnt lgkmcnt(3)
    v_mfma_f32_16x16x32_bf16 v[48:51], v[24:27], v[72:75], v[48:51]
    s_waitcnt lgkmcnt(2)
    v_mfma_f32_16x16x32_bf16 v[48:51], v[28:31], v[76:79], v[48:51]
    s_waitcnt lgkmcnt(1)
    v_mfma_f32_16x16x32_bf16 v[48:51], v[32:35], v[80:83], v[48:51]
    s_waitcnt lgkmcnt(0)
    v_mfma_f32_16x16x32_bf16 v[48:51], v[36:39], v[84:87], v[48:51]
    v_mov_b32 v61, 0xd04e1d32
    s_cmp_eq_u32 s79, 0
    s_cbranch_scc1 q0_136
    ds_read_b128 v[16:19], v45 offset:6144
    ds_read_b128 v[20:23], v45 offset:7168
    ds_read_b128 v[24:27], v45 offset:8192
    ds_read_b128 v[28:31], v45 offset:9216
    ds_read_b128 v[32:35], v45 offset:10240
    ds_read_b128 v[36:39], v45 offset:11264
    s_waitcnt lgkmcnt(5)
    v_mfma_f32_16x16x32_bf16 v[52:55], v[16:19], v[64:67], 0
    s_waitcnt lgkmcnt(4)
    v_mfma_f32_16x16x32_bf16 v[52:55], v[20:23], v[68:71], v[52:55]
    s_waitcnt lgkmcnt(3)
    v_mfma_f32_16x16x32_bf16 v[52:55], v[24:27], v[72:75], v[52:55]
    s_waitcnt lgkmcnt(2)
    v_mfma_f32_16x16x32_bf16 v[52:55], v[28:31], v[76:79], v[52:55]
    s_waitcnt lgkmcnt(1)
    v_mfma_f32_16x16x32_bf16 v[52:55], v[32:35], v[80:83], v[52:55]
    s_waitcnt lgkmcnt(0)
    v_mfma_f32_16x16x32_bf16 v[52:55], v[36:39], v[84:87], v[52:55]
    s_nop 7
    v_cndmask_b32 v52, v52, v61, s[82:83]
    v_cndmask_b32 v53, v53, v61, s[84:85]
    v_cndmask_b32 v54, v54, v61, s[86:87]
    v_cndmask_b32 v55, v55, v61, s[88:89]
    s_branch q1_137
q0_136:
    s_nop 7
    v_cndmask_b32 v48, v48, v61, s[82:83]
    v_cndmask_b32 v49, v49, v61, s[84:85]
    v_cndmask_b32 v50, v50, v61, s[86:87]
    v_cndmask_b32 v51, v51, v61, s[88:89]
    v_mov_b32 v52, v61
    v_mov_b32 v53, v61
    v_mov_b32 v54, v61
    v_mov_b32 v55, v61
q1_137:
    ds_read_b128 v[176:179], v46 offset:0
    ds_read_b128 v[180:183], v46 offset:1024
    ds_read_b128 v[184:187], v46 offset:2048
    ds_read_b128 v[188:191], v46 offset:3072
    ds_read_b128 v[192:195], v46 offset:4096
    ds_read_b128 v[196:199], v46 offset:5120
    v_mov_b32 v201, 0
    v_mov_b32 v203, 0
    v_mov_b32 v205, 0
    v_mov_b32 v207, 0
    v_mov_b32 v209, 0
    v_mov_b32 v211, 0
    v_mov_b32 v40, 0x3f803f80
    v_mov_b32 v41, 0x3f803f80
    v_mov_b32 v42, 0x3f803f80
    v_mov_b32 v43, 0x3f803f80
    v_mov_b32 v93, 0
    v_max3_f32 v60, v48, v49, v50
    v_max3_f32 v60, v60, v51, v52
    v_max3_f32 v60, v60, v53, v54
    v_max_f32 v60, v60, v55
    s_cmp_eq_u32 s69, 1
    s_cbranch_scc1 qhv_138
    s_cmp_eq_u32 s73, 64
    s_cbranch_scc0 ql_139
    s_mov_b32 s76, 4000000
qr_140:
    s_sub_u32 s75, s73, 1
    s_mul_i32 s68, s75, 196608
    buffer_load_dwordx4 v[212:215], v5, s[44:47], s68 offen offset:0 sc1
    buffer_load_dwordx4 v[216:219], v5, s[44:47], s68 offen offset:512 sc1
    buffer_load_dwordx4 v[220:223], v5, s[44:47], s68 offen offset:1024 sc1
    buffer_load_dwordx4 v[224:227], v5, s[44:47], s68 offen offset:1536 sc1
    buffer_load_dwordx4 v[228:231], v5, s[44:47], s68 offen offset:2048 sc1
    buffer_load_dwordx4 v[232:235], v5, s[44:47], s68 offen offset:2560 sc1
    s_lshr_b32 s75, s68, 1
    buffer_load_dword v200, v14, s[44:47], s75 offen offset:0 sc1
    buffer_load_dword v202, v14, s[44:47], s75 offen offset:256 sc1
    buffer_load_dword v204, v14, s[44:47], s75 offen offset:512 sc1
    buffer_load_dword v206, v14, s[44:47], s75 offen offset:768 sc1
    buffer_load_dword v208, v14, s[44:47], s75 offen offset:1024 sc1
    buffer_load_dword v210, v14, s[44:47], s75 offen offset:1280 sc1
    s_sub_u32 s76, s76, 1
    s_cbranch_scc1 qhv_138
    s_waitcnt vmcnt(0)
    v_max3_u32 v2, v212, v213, v214
    v_max3_u32 v2, v2, v215, v216
    v_max3_u32 v2, v2, v217, v218
    v_max3_u32 v2, v2, v219, v220
    v_max3_u32 v2, v2, v221, v222
    v_max3_u32 v2, v2, v223, v224
    v_max3_u32 v2, v2, v225, v226
    v_max3_u32 v2, v2, v227, v228
    v_max3_u32 v2, v2, v229, v230
    v_max3_u32 v2, v2, v231, v232
    v_max3_u32 v2, v2, v233, v234
    v_max3_u32 v2, v2, v235, v200
    v_max3_u32 v2, v2, v202, v204
    v_max3_u32 v2, v2, v206, v208
    v_max_u32 v2, v2, v210
    v_cmp_eq_u32 vcc, -1, v2
    s_cbranch_vccnz qr_140
    s_branch qhv_138
    .p2align 6
ql_139:
    s_cmp_ge_u32 s78, s73
    s_cbranch_scc1 fwd_142
    s_mov_b32 s76, 4000000
fw_141:
    buffer_load_dword v2, v11, s[44:47], 0 offen sc1
    s_sub_u32 s76, s76, 1
    s_cbranch_scc1 fwd_142
    s_waitcnt vmcnt(0)
    v_cmp_gt_u32 vcc, s73, v2
    s_cbranch_vccz fwo_143
    s_sleep 1
    s_branch fw_141
fwo_143:
    v_readlane_b32 s78, v2, 0
    v_readlane_b32 s76, v2, 1
    s_min_u32 s78, s78, s76
    v_readlane_b32 s76, v2, 2
    s_min_u32 s78, s78, s76
fwd_142:
    s_sub_u32 s75, s73, 1
    s_mul_i32 s68, s75, 196608
    buffer_load_dwordx4 v[212:215], v5, s[44:47], s68 offen offset:0 sc1
    buffer_load_dwordx4 v[216:219], v5, s[44:47], s68 offen offset:512 sc1
    buffer_load_dwordx4 v[220:223], v5, s[44:47], s68 offen offset:1024 sc1
    buffer_load_dwordx4 v[224:227], v5, s[44:47], s68 offen offset:1536 sc1
    buffer_load_dwordx4 v[228:231], v5, s[44:47], s68 offen offset:2048 sc1
    buffer_load_dwordx4 v[232:235], v5, s[44:47], s68 offen offset:2560 sc1
    s_lshr_b32 s75, s68, 1
    buffer_load_dword v200, v14, s[44:47], s75 offen offset:0 sc1
    buffer_load_dword v202, v14, s[44:47], s75 offen offset:256 sc1
    buffer_load_dword v204, v14, s[44:47], s75 offen offset:512 sc1
    buffer_load_dword v206, v14, s[44:47], s75 offen offset:768 sc1
    buffer_load_dword v208, v14, s[44:47], s75 offen offset:1024 sc1
    buffer_load_dword v210, v14, s[44:47], s75 offen offset:1280 sc1
qhv_138:
    s_waitcnt vmcnt(6)
    v_mfma_f32_16x16x32_bf16 v[56:59], v[212:215], v[64:67], 0
    v_mfma_f32_16x16x32_bf16 v[56:59], v[216:219], v[68:71], v[56:59]
    v_mfma_f32_16x16x32_bf16 v[56:59], v[220:223], v[72:75], v[56:59]
    v_mfma_f32_16x16x32_bf16 v[56:59], v[224:227], v[76:79], v[56:59]
    v_mfma_f32_16x16x32_bf16 v[56:59], v[228:231], v[80:83], v[56:59]
    v_mfma_f32_16x16x32_bf16 v[56:59], v[232:235], v[84:87], v[56:59]
    s_sub_u32 s74, s73, 1
    s_and_b32 s74, s74, 7
    s_mul_i32 s74, s74, 393216
    s_nop 6
    v_max3_f32 v60, v60, v56, v57
    v_mov_b32 v61, v60
    s_nop 1
    v_permlane16_swap_b32 v60, v61
    v_max_f32 v60, v60, v61
    v_mov_b32 v61, v60
    s_nop 1
    v_permlane32_swap_b32 v60, v61
    v_max_f32 v60, v60, v61
    v_sub_f32 v56, v56, v60
    v_sub_f32 v57, v57, v60
    v_sub_f32 v48, v48, v60
    v_sub_f32 v49, v49, v60
    v_sub_f32 v50, v50, v60
    v_sub_f32 v51, v51, v60
    v_sub_f32 v52, v52, v60
    v_sub_f32 v53, v53, v60
    v_sub_f32 v54, v54, v60
    v_sub_f32 v55, v55, v60
    v_mul_f32 v56, s81, v56
    v_mul_f32 v57, s81, v57
    v_mul_f32 v48, s81, v48
    v_mul_f32 v49, s81, v49
    v_mul_f32 v50, s81, v50
    v_mul_f32 v51, s81, v51
    v_mul_f32 v52, s81, v52
    v_mul_f32 v53, s81, v53
    v_mul_f32 v54, s81, v54
    v_mul_f32 v55, s81, v55
    v_exp_f32 v56, v56
    v_exp_f32 v57, v57
    v_exp_f32 v48, v48
    v_exp_f32 v49, v49
    v_exp_f32 v50, v50
    v_exp_f32 v51, v51
    v_exp_f32 v52, v52
    v_exp_f32 v53, v53
    v_exp_f32 v54, v54
    v_exp_f32 v55, v55
    v_cvt_pk_bf16_f32 v92, v56, v57
    v_cvt_pk_bf16_f32 v88, v48, v49
    v_cvt_pk_bf16_f32 v89, v50, v51
    v_cvt_pk_bf16_f32 v90, v52, v53
    v_cvt_pk_bf16_f32 v91, v54, v55
    s_waitcnt vmcnt(0) lgkmcnt(0)
    v_mfma_f32_16x16x16_bf16 v[236:239], v[40:41], v[92:93], 0
    v_mfma_f32_16x16x16_bf16 v[212:215], v[200:201], v[92:93], 0
    v_mfma_f32_16x16x16_bf16 v[216:219], v[202:203], v[92:93], 0
    v_mfma_f32_16x16x16_bf16 v[220:223], v[204:205], v[92:93], 0
    v_mfma_f32_16x16x16_bf16 v[224:227], v[206:207], v[92:93], 0
    v_mfma_f32_16x16x16_bf16 v[228:231], v[208:209], v[92:93], 0
    v_mfma_f32_16x16x16_bf16 v[232:235], v[210:211], v[92:93], 0
    v_mfma_f32_16x16x32_bf16 v[236:239], v[40:43], v[88:91], v[236:239]
    v_mfma_f32_16x16x32_bf16 v[212:215], v[176:179], v[88:91], v[212:215]
    v_mfma_f32_16x16x32_bf16 v[216:219], v[180:183], v[88:91], v[216:219]
    v_mfma_f32_16x16x32_bf16 v[220:223], v[184:187], v[88:91], v[220:223]
    v_mfma_f32_16x16x32_bf16 v[224:227], v[188:191], v[88:91], v[224:227]
    v_mfma_f32_16x16x32_bf16 v[228:231], v[192:195], v[88:91], v[228:231]
    v_mfma_f32_16x16x32_bf16 v[232:235], v[196:199], v[88:91], v[232:235]
    s_nop 1
    v_rcp_f32 v61, v236
    s_nop 0
    v_mul_f32 v212, v212, v61
    v_mul_f32 v213, v213, v61
    v_mul_f32 v214, v214, v61
    v_mul_f32 v215, v215, v61
    v_mul_f32 v216, v216, v61
    v_mul_f32 v217, v217, v61
    v_mul_f32 v218, v218, v61
    v_mul_f32 v219, v219, v61
    v_mul_f32 v220, v220, v61
    v_mul_f32 v221, v221, v61
    v_mul_f32 v222, v222, v61
    v_mul_f32 v223, v223, v61
    v_mul_f32 v224, v224, v61
    v_mul_f32 v225, v225, v61
    v_mul_f32 v226, v226, v61
    v_mul_f32 v227, v227, v61
    v_mul_f32 v228, v228, v61
    v_mul_f32 v229, v229, v61
    v_mul_f32 v230, v230, v61
    v_mul_f32 v231, v231, v61
    v_mul_f32 v232, v232, v61
    v_mul_f32 v233, v233, v61
    v_mul_f32 v234, v234, v61
    v_mul_f32 v235, v235, v61
    v_cvt_pk_bf16_f32 v240, v212, v213
    v_cvt_pk_bf16_f32 v241, v214, v215
    v_cvt_pk_bf16_f32 v242, v216, v217
    v_cvt_pk_bf16_f32 v243, v218, v219
    v_cvt_pk_bf16_f32 v244, v220, v221
    v_cvt_pk_bf16_f32 v245, v222, v223
    v_cvt_pk_bf16_f32 v246, v224, v225
    v_cvt_pk_bf16_f32 v247, v226, v227
    v_cvt_pk_bf16_f32 v248, v228, v229
    v_cvt_pk_bf16_f32 v249, v230, v231
    v_cvt_pk_bf16_f32 v250, v232, v233
    v_cvt_pk_bf16_f32 v251, v234, v235
    s_cmp_lg_u32 s6, 0
    s_cbranch_scc1 sf_144
    buffer_store_dwordx4 v[240:243], v15, s[44:47], s74 offen offset:0
    buffer_store_dwordx4 v[244:247], v15, s[44:47], s74 offen offset:1024
    buffer_store_dwordx4 v[248:251], v15, s[44:47], s74 offen offset:2048
    s_branch sd_145
sf_144:
    buffer_store_dwordx4 v[240:243], v15, s[44:47], s74 offen offset:0 sc1
    buffer_store_dwordx4 v[244:247], v15, s[44:47], s74 offen offset:1024 sc1
    buffer_store_dwordx4 v[248:251], v15, s[44:47], s74 offen offset:2048 sc1
sd_145:
qj_118:
    s_add_u32 s73, s73, 1
    s_branch ql_116
qf_120:
    s_endpgm
L_o:
    s_mov_b32 s52, s16
    s_and_b32 s53, s17, 0xffff
    s_mov_b32 s54, 0x280000
    s_mov_b32 s55, 0x00020000
    s_sub_u32 s63, s2, 160
    s_lshl_b32 s63, s63, 3
    s_add_u32 s63, s63, s3
    s_lshl_b32 s63, s63, 2
    s_mul_i32 s64, s63, 1280
    v_lshrrev_b32 v3, 4, v1
    v_and_b32 v4, 15, v1
    v_mul_u32_u24 v2, 1280, v3
    v_lshlrev_b32 v5, 4, v4
    v_add_u32 v2, v2, v5
    buffer_load_dwordx4 v[16:19], v2, s[52:55], s64 offen offset:0
    buffer_load_dwordx4 v[20:23], v2, s[52:55], s64 offen offset:256
    buffer_load_dwordx4 v[24:27], v2, s[52:55], s64 offen offset:512
    buffer_load_dwordx4 v[28:31], v2, s[52:55], s64 offen offset:768
    buffer_load_dwordx4 v[32:35], v2, s[52:55], s64 offen offset:1024
    v_lshrrev_b32 v5, 2, v4
    v_lshlrev_b32 v5, 10, v5
    v_and_b32 v6, 3, v4
    v_lshlrev_b32 v6, 8, v6
    v_lshlrev_b32 v3, 4, v3
    v_add3_u32 v5, v5, v6, v3
    s_lshr_b32 s64, s63, 4
    s_mul_i32 s64, s64, 20480
    s_and_b32 s65, s63, 15
    s_lshl_b32 s65, s65, 4
    s_add_u32 s64, s64, s65
    s_waitcnt vmcnt(0)
    v_lshlrev_b32 v40, 16, v16
    v_and_b32 v41, 0xffff0000, v16
    v_lshlrev_b32 v42, 16, v17
    v_and_b32 v43, 0xffff0000, v17
    v_lshlrev_b32 v44, 16, v18
    v_and_b32 v45, 0xffff0000, v18
    v_lshlrev_b32 v46, 16, v19
    v_and_b32 v47, 0xffff0000, v19
    v_lshlrev_b32 v48, 16, v20
    v_and_b32 v49, 0xffff0000, v20
    v_lshlrev_b32 v50, 16, v21
    v_and_b32 v51, 0xffff0000, v21
    v_lshlrev_b32 v52, 16, v22
    v_and_b32 v53, 0xffff0000, v22
    v_lshlrev_b32 v54, 16, v23
    v_and_b32 v55, 0xffff0000, v23
    v_lshlrev_b32 v56, 16, v24
    v_and_b32 v57, 0xffff0000, v24
    v_lshlrev_b32 v58, 16, v25
    v_and_b32 v59, 0xffff0000, v25
    v_lshlrev_b32 v60, 16, v26
    v_and_b32 v61, 0xffff0000, v26
    v_lshlrev_b32 v62, 16, v27
    v_and_b32 v63, 0xffff0000, v27
    v_lshlrev_b32 v64, 16, v28
    v_and_b32 v65, 0xffff0000, v28
    v_lshlrev_b32 v66, 16, v29
    v_and_b32 v67, 0xffff0000, v29
    v_lshlrev_b32 v68, 16, v30
    v_and_b32 v69, 0xffff0000, v30
    v_lshlrev_b32 v70, 16, v31
    v_and_b32 v71, 0xffff0000, v31
    v_lshlrev_b32 v72, 16, v32
    v_and_b32 v73, 0xffff0000, v32
    v_lshlrev_b32 v74, 16, v33
    v_and_b32 v75, 0xffff0000, v33
    v_lshlrev_b32 v76, 16, v34
    v_and_b32 v77, 0xffff0000, v34
    v_lshlrev_b32 v78, 16, v35
    v_and_b32 v79, 0xffff0000, v35
    v_pk_add_f32 v[8:9], v[40:41], v[42:43]
    v_pk_add_f32 v[8:9], v[8:9], v[44:45]
    v_pk_add_f32 v[8:9], v[8:9], v[46:47]
    v_pk_add_f32 v[8:9], v[8:9], v[48:49]
    v_pk_add_f32 v[8:9], v[8:9], v[50:51]
    v_pk_add_f32 v[8:9], v[8:9], v[52:53]
    v_pk_add_f32 v[8:9], v[8:9], v[54:55]
    v_pk_add_f32 v[8:9], v[8:9], v[56:57]
    v_pk_add_f32 v[8:9], v[8:9], v[58:59]
    v_pk_add_f32 v[8:9], v[8:9], v[60:61]
    v_pk_add_f32 v[8:9], v[8:9], v[62:63]
    v_pk_add_f32 v[8:9], v[8:9], v[64:65]
    v_pk_add_f32 v[8:9], v[8:9], v[66:67]
    v_pk_add_f32 v[8:9], v[8:9], v[68:69]
    v_pk_add_f32 v[8:9], v[8:9], v[70:71]
    v_pk_add_f32 v[8:9], v[8:9], v[72:73]
    v_pk_add_f32 v[8:9], v[8:9], v[74:75]
    v_pk_add_f32 v[8:9], v[8:9], v[76:77]
    v_pk_add_f32 v[8:9], v[8:9], v[78:79]
    v_add_f32 v8, v8, v9
    s_nop 1
    v_add_f32_dpp v8, v8, v8 row_ror:1 row_mask:0xf bank_mask:0xf
    s_nop 1
    v_add_f32_dpp v8, v8, v8 row_ror:2 row_mask:0xf bank_mask:0xf
    s_nop 1
    v_add_f32_dpp v8, v8, v8 row_ror:4 row_mask:0xf bank_mask:0xf
    s_nop 1
    v_add_f32_dpp v8, v8, v8 row_ror:8 row_mask:0xf bank_mask:0xf
    v_mul_f32 v8, 0xbacccccd, v8
    v_mov_b32 v9, v8
    v_pk_add_f32 v[80:81], v[40:41], v[8:9]
    v_pk_add_f32 v[82:83], v[42:43], v[8:9]
    v_pk_add_f32 v[84:85], v[44:45], v[8:9]
    v_pk_add_f32 v[86:87], v[46:47], v[8:9]
    v_pk_add_f32 v[88:89], v[48:49], v[8:9]
    v_pk_add_f32 v[90:91], v[50:51], v[8:9]
    v_pk_add_f32 v[92:93], v[52:53], v[8:9]
    v_pk_add_f32 v[94:95], v[54:55], v[8:9]
    v_pk_add_f32 v[96:97], v[56:57], v[8:9]
    v_pk_add_f32 v[98:99], v[58:59], v[8:9]
    v_pk_add_f32 v[100:101], v[60:61], v[8:9]
    v_pk_add_f32 v[102:103], v[62:63], v[8:9]
    v_pk_add_f32 v[104:105], v[64:65], v[8:9]
    v_pk_add_f32 v[106:107], v[66:67], v[8:9]
    v_pk_add_f32 v[108:109], v[68:69], v[8:9]
    v_pk_add_f32 v[110:111], v[70:71], v[8:9]
    v_pk_add_f32 v[112:113], v[72:73], v[8:9]
    v_pk_add_f32 v[114:115], v[74:75], v[8:9]
    v_pk_add_f32 v[116:117], v[76:77], v[8:9]
    v_pk_add_f32 v[118:119], v[78:79], v[8:9]
    v_pk_mul_f32 v[10:11], v[80:81], v[80:81]
    v_pk_fma_f32 v[10:11], v[82:83], v[82:83], v[10:11]
    v_pk_fma_f32 v[10:11], v[84:85], v[84:85], v[10:11]
    v_pk_fma_f32 v[10:11], v[86:87], v[86:87], v[10:11]
    v_pk_fma_f32 v[10:11], v[88:89], v[88:89], v[10:11]
    v_pk_fma_f32 v[10:11], v[90:91], v[90:91], v[10:11]
    v_pk_fma_f32 v[10:11], v[92:93], v[92:93], v[10:11]
    v_pk_fma_f32 v[10:11], v[94:95], v[94:95], v[10:11]
    v_pk_fma_f32 v[10:11], v[96:97], v[96:97], v[10:11]
    v_pk_fma_f32 v[10:11], v[98:99], v[98:99], v[10:11]
    v_pk_fma_f32 v[10:11], v[100:101], v[100:101], v[10:11]
    v_pk_fma_f32 v[10:11], v[102:103], v[102:103], v[10:11]
    v_pk_fma_f32 v[10:11], v[104:105], v[104:105], v[10:11]
    v_pk_fma_f32 v[10:11], v[106:107], v[106:107], v[10:11]
    v_pk_fma_f32 v[10:11], v[108:109], v[108:109], v[10:11]
    v_pk_fma_f32 v[10:11], v[110:111], v[110:111], v[10:11]
    v_pk_fma_f32 v[10:11], v[112:113], v[112:113], v[10:11]
    v_pk_fma_f32 v[10:11], v[114:115], v[114:115], v[10:11]
    v_pk_fma_f32 v[10:11], v[116:117], v[116:117], v[10:11]
    v_pk_fma_f32 v[10:11], v[118:119], v[118:119], v[10:11]
    v_add_f32 v10, v10, v11
    s_nop 1
    v_add_f32_dpp v10, v10, v10 row_ror:1 row_mask:0xf bank_mask:0xf
    s_nop 1
    v_add_f32_dpp v10, v10, v10 row_ror:2 row_mask:0xf bank_mask:0xf
    s_nop 1
    v_add_f32_dpp v10, v10, v10 row_ror:4 row_mask:0xf bank_mask:0xf
    s_nop 1
    v_add_f32_dpp v10, v10, v10 row_ror:8 row_mask:0xf bank_mask:0xf
    v_mul_f32 v10, 0x3acccccd, v10
    v_cvt_pk_bf16_f32 v10, v10, v10
    v_and_b32 v10, 0xffff0000, v10
    v_add_f32 v10, 0x3727c5ac, v10
    v_cvt_pk_bf16_f32 v10, v10, v10
    v_and_b32 v10, 0xffff0000, v10
    v_sqrt_f32 v10, v10
    s_nop 0
    v_cvt_pk_bf16_f32 v10, v10, v10
    v_and_b32 v10, 0xffff0000, v10
    v_rcp_f32 v12, v10
    v_cvt_pk_bf16_f32 v8, v8, v8
    v_and_b32 v8, 0xffff0000, v8
    v_mov_b32 v9, v8
    v_mov_b32 v13, v12
    v_sub_f32 v10, 0, v10
    v_mov_b32 v11, v10
    v_pk_add_f32 v[80:81], v[40:41], v[8:9]
    v_pk_add_f32 v[82:83], v[42:43], v[8:9]
    v_pk_add_f32 v[84:85], v[44:45], v[8:9]
    v_pk_add_f32 v[86:87], v[46:47], v[8:9]
    v_pk_add_f32 v[88:89], v[48:49], v[8:9]
    v_pk_add_f32 v[90:91], v[50:51], v[8:9]
    v_pk_add_f32 v[92:93], v[52:53], v[8:9]
    v_pk_add_f32 v[94:95], v[54:55], v[8:9]
    v_pk_add_f32 v[96:97], v[56:57], v[8:9]
    v_pk_add_f32 v[98:99], v[58:59], v[8:9]
    v_pk_add_f32 v[100:101], v[60:61], v[8:9]
    v_pk_add_f32 v[102:103], v[62:63], v[8:9]
    v_pk_add_f32 v[104:105], v[64:65], v[8:9]
    v_pk_add_f32 v[106:107], v[66:67], v[8:9]
    v_pk_add_f32 v[108:109], v[68:69], v[8:9]
    v_pk_add_f32 v[110:111], v[70:71], v[8:9]
    v_pk_add_f32 v[112:113], v[72:73], v[8:9]
    v_pk_add_f32 v[114:115], v[74:75], v[8:9]
    v_pk_add_f32 v[116:117], v[76:77], v[8:9]
    v_pk_add_f32 v[118:119], v[78:79], v[8:9]
    v_cvt_pk_bf16_f32 v16, v80, v81
    v_cvt_pk_bf16_f32 v17, v82, v83
    v_cvt_pk_bf16_f32 v18, v84, v85
    v_cvt_pk_bf16_f32 v19, v86, v87
    v_cvt_pk_bf16_f32 v20, v88, v89
    v_cvt_pk_bf16_f32 v21, v90, v91
    v_cvt_pk_bf16_f32 v22, v92, v93
    v_cvt_pk_bf16_f32 v23, v94, v95
    v_cvt_pk_bf16_f32 v24, v96, v97
    v_cvt_pk_bf16_f32 v25, v98, v99
    v_cvt_pk_bf16_f32 v26, v100, v101
    v_cvt_pk_bf16_f32 v27, v102, v103
    v_cvt_pk_bf16_f32 v28, v104, v105
    v_cvt_pk_bf16_f32 v29, v106, v107
    v_cvt_pk_bf16_f32 v30, v108, v109
    v_cvt_pk_bf16_f32 v31, v110, v111
    v_cvt_pk_bf16_f32 v32, v112, v113
    v_cvt_pk_bf16_f32 v33, v114, v115
    v_cvt_pk_bf16_f32 v34, v116, v117
    v_cvt_pk_bf16_f32 v35, v118, v119
    v_lshlrev_b32 v40, 16, v16
    v_and_b32 v41, 0xffff0000, v16
    v_lshlrev_b32 v42, 16, v17
    v_and_b32 v43, 0xffff0000, v17
    v_lshlrev_b32 v44, 16, v18
    v_and_b32 v45, 0xffff0000, v18
    v_lshlrev_b32 v46, 16, v19
    v_and_b32 v47, 0xffff0000, v19
    v_lshlrev_b32 v48, 16, v20
    v_and_b32 v49, 0xffff0000, v20
    v_lshlrev_b32 v50, 16, v21
    v_and_b32 v51, 0xffff0000, v21
    v_lshlrev_b32 v52, 16, v22
    v_and_b32 v53, 0xffff0000, v22
    v_lshlrev_b32 v54, 16, v23
    v_and_b32 v55, 0xffff0000, v23
    v_lshlrev_b32 v56, 16, v24
    v_and_b32 v57, 0xffff0000, v24
    v_lshlrev_b32 v58, 16, v25
    v_and_b32 v59, 0xffff0000, v25
    v_lshlrev_b32 v60, 16, v26
    v_and_b32 v61, 0xffff0000, v26
    v_lshlrev_b32 v62, 16, v27
    v_and_b32 v63, 0xffff0000, v27
    v_lshlrev_b32 v64, 16, v28
    v_and_b32 v65, 0xffff0000, v28
    v_lshlrev_b32 v66, 16, v29
    v_and_b32 v67, 0xffff0000, v29
    v_lshlrev_b32 v68, 16, v30
    v_and_b32 v69, 0xffff0000, v30
    v_lshlrev_b32 v70, 16, v31
    v_and_b32 v71, 0xffff0000, v31
    v_lshlrev_b32 v72, 16, v32
    v_and_b32 v73, 0xffff0000, v32
    v_lshlrev_b32 v74, 16, v33
    v_and_b32 v75, 0xffff0000, v33
    v_lshlrev_b32 v76, 16, v34
    v_and_b32 v77, 0xffff0000, v34
    v_lshlrev_b32 v78, 16, v35
    v_and_b32 v79, 0xffff0000, v35
    v_pk_mul_f32 v[80:81], v[40:41], v[12:13]
    v_pk_fma_f32 v[40:41], v[80:81], v[10:11], v[40:41]
    v_pk_fma_f32 v[80:81], v[40:41], v[12:13], v[80:81]
    v_pk_mul_f32 v[82:83], v[42:43], v[12:13]
    v_pk_fma_f32 v[42:43], v[82:83], v[10:11], v[42:43]
    v_pk_fma_f32 v[82:83], v[42:43], v[12:13], v[82:83]
    v_pk_mul_f32 v[84:85], v[44:45], v[12:13]
    v_pk_fma_f32 v[44:45], v[84:85], v[10:11], v[44:45]
    v_pk_fma_f32 v[84:85], v[44:45], v[12:13], v[84:85]
    v_pk_mul_f32 v[86:87], v[46:47], v[12:13]
    v_pk_fma_f32 v[46:47], v[86:87], v[10:11], v[46:47]
    v_pk_fma_f32 v[86:87], v[46:47], v[12:13], v[86:87]
    v_pk_mul_f32 v[88:89], v[48:49], v[12:13]
    v_pk_fma_f32 v[48:49], v[88:89], v[10:11], v[48:49]
    v_pk_fma_f32 v[88:89], v[48:49], v[12:13], v[88:89]
    v_pk_mul_f32 v[90:91], v[50:51], v[12:13]
    v_pk_fma_f32 v[50:51], v[90:91], v[10:11], v[50:51]
    v_pk_fma_f32 v[90:91], v[50:51], v[12:13], v[90:91]
    v_pk_mul_f32 v[92:93], v[52:53], v[12:13]
    v_pk_fma_f32 v[52:53], v[92:93], v[10:11], v[52:53]
    v_pk_fma_f32 v[92:93], v[52:53], v[12:13], v[92:93]
    v_pk_mul_f32 v[94:95], v[54:55], v[12:13]
    v_pk_fma_f32 v[54:55], v[94:95], v[10:11], v[54:55]
    v_pk_fma_f32 v[94:95], v[54:55], v[12:13], v[94:95]
    v_pk_mul_f32 v[96:97], v[56:57], v[12:13]
    v_pk_fma_f32 v[56:57], v[96:97], v[10:11], v[56:57]
    v_pk_fma_f32 v[96:97], v[56:57], v[12:13], v[96:97]
    v_pk_mul_f32 v[98:99], v[58:59], v[12:13]
    v_pk_fma_f32 v[58:59], v[98:99], v[10:11], v[58:59]
    v_pk_fma_f32 v[98:99], v[58:59], v[12:13], v[98:99]
    v_pk_mul_f32 v[100:101], v[60:61], v[12:13]
    v_pk_fma_f32 v[60:61], v[100:101], v[10:11], v[60:61]
    v_pk_fma_f32 v[100:101], v[60:61], v[12:13], v[100:101]
    v_pk_mul_f32 v[102:103], v[62:63], v[12:13]
    v_pk_fma_f32 v[62:63], v[102:103], v[10:11], v[62:63]
    v_pk_fma_f32 v[102:103], v[62:63], v[12:13], v[102:103]
    v_pk_mul_f32 v[104:105], v[64:65], v[12:13]
    v_pk_fma_f32 v[64:65], v[104:105], v[10:11], v[64:65]
    v_pk_fma_f32 v[104:105], v[64:65], v[12:13], v[104:105]
    v_pk_mul_f32 v[106:107], v[66:67], v[12:13]
    v_pk_fma_f32 v[66:67], v[106:107], v[10:11], v[66:67]
    v_pk_fma_f32 v[106:107], v[66:67], v[12:13], v[106:107]
    v_pk_mul_f32 v[108:109], v[68:69], v[12:13]
    v_pk_fma_f32 v[68:69], v[108:109], v[10:11], v[68:69]
    v_pk_fma_f32 v[108:109], v[68:69], v[12:13], v[108:109]
    v_pk_mul_f32 v[110:111], v[70:71], v[12:13]
    v_pk_fma_f32 v[70:71], v[110:111], v[10:11], v[70:71]
    v_pk_fma_f32 v[110:111], v[70:71], v[12:13], v[110:111]
    v_pk_mul_f32 v[112:113], v[72:73], v[12:13]
    v_pk_fma_f32 v[72:73], v[112:113], v[10:11], v[72:73]
    v_pk_fma_f32 v[112:113], v[72:73], v[12:13], v[112:113]
    v_pk_mul_f32 v[114:115], v[74:75], v[12:13]
    v_pk_fma_f32 v[74:75], v[114:115], v[10:11], v[74:75]
    v_pk_fma_f32 v[114:115], v[74:75], v[12:13], v[114:115]
    v_pk_mul_f32 v[116:117], v[76:77], v[12:13]
    v_pk_fma_f32 v[76:77], v[116:117], v[10:11], v[76:77]
    v_pk_fma_f32 v[116:117], v[76:77], v[12:13], v[116:117]
    v_pk_mul_f32 v[118:119], v[78:79], v[12:13]
    v_pk_fma_f32 v[78:79], v[118:119], v[10:11], v[78:79]
    v_pk_fma_f32 v[118:119], v[78:79], v[12:13], v[118:119]
    v_cvt_pk_bf16_f32 v16, v80, v81
    v_cvt_pk_bf16_f32 v17, v82, v83
    v_cvt_pk_bf16_f32 v18, v84, v85
    v_cvt_pk_bf16_f32 v19, v86, v87
    buffer_store_dwordx4 v[16:19], v5, s[44:47], s64 offen sc1
    s_add_u32 s64, s64, 4096
    v_cvt_pk_bf16_f32 v20, v88, v89
    v_cvt_pk_bf16_f32 v21, v90, v91
    v_cvt_pk_bf16_f32 v22, v92, v93
    v_cvt_pk_bf16_f32 v23, v94, v95
    buffer_store_dwordx4 v[20:23], v5, s[44:47], s64 offen sc1
    s_add_u32 s64, s64, 4096
    v_cvt_pk_bf16_f32 v24, v96, v97
    v_cvt_pk_bf16_f32 v25, v98, v99
    v_cvt_pk_bf16_f32 v26, v100, v101
    v_cvt_pk_bf16_f32 v27, v102, v103
    buffer_store_dwordx4 v[24:27], v5, s[44:47], s64 offen sc1
    s_add_u32 s64, s64, 4096
    v_cvt_pk_bf16_f32 v28, v104, v105
    v_cvt_pk_bf16_f32 v29, v106, v107
    v_cvt_pk_bf16_f32 v30, v108, v109
    v_cvt_pk_bf16_f32 v31, v110, v111
    buffer_store_dwordx4 v[28:31], v5, s[44:47], s64 offen sc1
    s_add_u32 s64, s64, 4096
    v_cvt_pk_bf16_f32 v32, v112, v113
    v_cvt_pk_bf16_f32 v33, v114, v115
    v_cvt_pk_bf16_f32 v34, v116, v117
    v_cvt_pk_bf16_f32 v35, v118, v119
    buffer_store_dwordx4 v[32:35], v5, s[44:47], s64 offen sc1
    s_add_u32 s64, s64, 4096
    s_waitcnt vmcnt(0)
    s_barrier
    s_cmp_eq_u32 s3, 0
    s_cbranch_scc0 arr_146
    s_getreg_b32 s12, hwreg(HW_REG_XCC_ID)
    s_and_b32 s12, s12, 15
    s_cmp_gt_u32 s12, 7
    s_cselect_b32 s13, s14, 0
    s_lshr_b32 s13, s13, 3
    s_add_u32 s12, s12, s13
    s_sub_u32 s12, s12, s14
    s_and_b32 s12, s12, 7
    s_mul_i32 s13, s12, s12
    s_lshl_b32 s12, s12, 9
    s_or_b32 s12, s12, 1
    v_mov_b32 v12, s12
    v_mov_b32 v13, s13
    v_mov_b32 v14, 1073741824
    v_cmp_eq_u32 vcc, 0, v1
    s_nop 1
    v_cndmask_b32 v14, v14, v1, vcc
    buffer_atomic_add_x2 v[12:13], v14, s[56:59], s10 offen sc1
arr_146:
    s_cmp_eq_u32 s14, 255
    s_cbranch_scc0 mso_152
    s_cmp_eq_u32 s3, 0
    s_cbranch_scc0 mso_152
    v_mov_b32 v2, 0
    buffer_load_dword v4, v2, s[56:59], s10 offen offset:128 sc1
    s_waitcnt vmcnt(0)
    v_readfirstlane_b32 s63, v4
    s_cmp_lg_u32 s63, 0
    s_cbranch_scc1 mso_152
    s_mov_b32 s76, 1000000
ms_150:
    buffer_load_dwordx2 v[4:5], v2, s[56:59], s10 offen sc1
    s_sub_u32 s76, s76, 1
    s_cbranch_scc1 msd_151
    s_waitcnt vmcnt(0)
    v_readfirstlane_b32 s63, v4
    v_readfirstlane_b32 s64, v5
    s_and_b32 s65, s63, 511
    s_cmp_eq_u32 s65, 256
    s_cbranch_scc1 msd_151
    s_sleep 4
    s_branch ms_150
msd_151:
    s_lshr_b32 s63, s63, 9
    s_mul_i32 s63, s63, s63
    s_lshl_b32 s64, s64, 8
    s_cmp_eq_u32 s63, s64
    s_cselect_b32 s63, 1, 2
    v_mov_b32 v4, s63
    buffer_store_dword v4, v2, s[56:59], s10 offen offset:128 sc1
mso_152:
    v_mov_b32 v8, 0
    s_cmp_eq_u32 s3, 0
    s_cbranch_scc0 wao_149
    s_mov_b32 s76, 1000000
wa_147:
    buffer_load_dword v9, v8, s[56:59], s10 offen offset:128 sc1
    s_sub_u32 s76, s76, 1
    s_cbranch_scc1 wad_148
    s_waitcnt vmcnt(0)
    v_readfirstlane_b32 s63, v9
    s_cmp_lg_u32 s63, 0
    s_cbranch_scc1 wad_148
    s_sleep 8
    s_branch wa_147
wad_148:
    s_waitcnt vmcnt(0)
    ds_write_b32 v8, v9
    s_waitcnt lgkmcnt(0)
wao_149:
    s_barrier
    ds_read_b32 v9, v8
    s_waitcnt lgkmcnt(0)
    v_readfirstlane_b32 s63, v9
    s_cmp_lg_u32 s63, 1
    s_cselect_b32 s6, 1, 0
    s_waitcnt vmcnt(0)
    s_barrier
    s_cbranch_scc0 wak_153
    s_cmp_eq_u32 s10, 0
    s_mov_b32 s10, 16
    s_cbranch_scc1 L_restart
wak_153:
    s_and_b32 s60, s5, 3
    s_lshl_b32 s63, s60, 3
    s_add_u32 s63, s63, s4
    s_lshl_b32 s63, s63, 7
    s_add_u32 s63, s63, 156807168
    v_min_u32 v10, 1, v1
    v_lshlrev_b32 v10, 12, v10
    v_add_u32 v10, s63, v10
    s_mov_b32 s77, 0
    s_mov_b32 s75, 0
    s_cmp_eq_u32 s3, 0
    s_cbranch_scc0 w0_154
    s_cmp_ge_u32 s77, s75
    s_cbranch_scc1 fwd_156
    s_mov_b32 s76, 4000000
fw_155:
    buffer_load_dword v2, v10, s[44:47], 0 offen sc1
    s_sub_u32 s76, s76, 1
    s_cbranch_scc1 fwd_156
    s_waitcnt vmcnt(0)
    v_cmp_gt_u32 vcc, s75, v2
    s_cbranch_vccz fwo_157
    s_sleep 8
    s_branch fw_155
fwo_157:
    s_mov_b32 s77, s75
fwd_156:
w0_154:
    s_barrier
    s_sub_u32 s60, s5, 24
    s_mul_i32 s62, s4, 983040
    s_mul_i32 s63, s60, 320
    s_add_u32 s62, s62, s63
    v_lshrrev_b32 v11, 4, v1
    v_mul_u32_u24 v10, 1280, v11
    v_bfe_u32 v11, v1, 2, 2
    v_mul_u32_u24 v11, 320, v11
    v_add_u32 v10, v10, v11
    v_and_b32 v11, 3, v1
    v_mul_u32_u24 v11, 8, v11
    v_add_u32 v10, v10, v11
    s_lshl_b32 s63, s3, 1
    s_add_u32 s64, s3, 2
    s_min_u32 s9, s63, s64
    s_lshl_b32 s63, s9, 5
    v_add_u32 v10, s63, v10
    s_mov_b32 s48, s26
    s_and_b32 s49, s27, 0xffff
    s_mov_b32 s50, 0x780000
    s_mov_b32 s51, 0x00020000
    v_add_u32 v7, 0, v1
    v_mul_u32_u24 v8, 3277, v7
    v_lshrrev_b32 v8, 16, v8
    v_mul_u32_u24 v2, 960, v8
    v_lshlrev_b32 v7, 4, v7
    v_add_u32 v2, v2, v7
    v_add_u32 v7, 64, v1
    v_mul_u32_u24 v8, 3277, v7
    v_lshrrev_b32 v8, 16, v8
    v_mul_u32_u24 v3, 960, v8
    v_lshlrev_b32 v7, 4, v7
    v_add_u32 v3, v3, v7
    v_add_u32 v7, 128, v1
    v_mul_u32_u24 v8, 3277, v7
    v_lshrrev_b32 v8, 16, v8
    v_mul_u32_u24 v4, 960, v8
    v_lshlrev_b32 v7, 4, v7
    v_add_u32 v4, v4, v7
    v_add_u32 v7, 192, v1
    v_mul_u32_u24 v8, 3277, v7
    v_lshrrev_b32 v8, 16, v8
    v_mul_u32_u24 v5, 960, v8
    v_lshlrev_b32 v7, 4, v7
    v_add_u32 v5, v5, v7
    v_add_u32 v7, 256, v1
    v_mul_u32_u24 v8, 3277, v7
    v_lshrrev_b32 v8, 16, v8
    v_mul_u32_u24 v6, 960, v8
    v_lshlrev_b32 v7, 4, v7
    v_add_u32 v6, v6, v7
    s_mul_i32 s63, s3, 5120
    s_add_u32 s63, s63, 0
    s_mul_i32 s64, s3, 20480
    s_add_u32 s64, s64, s62
    s_add_u32 s64, s64, 0
    s_mov_b32 m0, s63
    s_add_u32 s63, s63, 1024
    buffer_load_dwordx4 v2, s[48:51], s64 offen lds
    s_mov_b32 m0, s63
    s_add_u32 s63, s63, 1024
    buffer_load_dwordx4 v3, s[48:51], s64 offen lds
    s_mov_b32 m0, s63
    s_add_u32 s63, s63, 1024
    buffer_load_dwordx4 v4, s[48:51], s64 offen lds
    s_mov_b32 m0, s63
    s_add_u32 s63, s63, 1024
    buffer_load_dwordx4 v5, s[48:51], s64 offen lds
    s_mov_b32 m0, s63
    s_add_u32 s63, s63, 36864
    buffer_load_dwordx4 v6, s[48:51], s64 offen lds
    s_add_u32 s64, s64, 163840
    s_mul_i32 s63, s3, 5120
    s_add_u32 s63, s63, 40960
    s_mul_i32 s64, s3, 20480
    s_add_u32 s64, s64, s62
    s_add_u32 s64, s64, 163840
    s_mov_b32 m0, s63
    s_add_u32 s63, s63, 1024
    buffer_load_dwordx4 v2, s[48:51], s64 offen lds
    s_mov_b32 m0, s63
    s_add_u32 s63, s63, 1024
    buffer_load_dwordx4 v3, s[48:51], s64 offen lds
    s_mov_b32 m0, s63
    s_add_u32 s63, s63, 1024
    buffer_load_dwordx4 v4, s[48:51], s64 offen lds
    s_mov_b32 m0, s63
    s_add_u32 s63, s63, 1024
    buffer_load_dwordx4 v5, s[48:51], s64 offen lds
    s_mov_b32 m0, s63
    s_add_u32 s63, s63, 36864
    buffer_load_dwordx4 v6, s[48:51], s64 offen lds
    s_add_u32 s64, s64, 163840
    s_mul_i32 s63, s3, 5120
    s_add_u32 s63, s63, 81920
    s_mul_i32 s64, s3, 20480
    s_add_u32 s64, s64, s62
    s_add_u32 s64, s64, 327680
    s_mov_b32 m0, s63
    s_add_u32 s63, s63, 1024
    buffer_load_dwordx4 v2, s[48:51], s64 offen lds
    s_mov_b32 m0, s63
    s_add_u32 s63, s63, 1024
    buffer_load_dwordx4 v3, s[48:51], s64 offen lds
    s_mov_b32 m0, s63
    s_add_u32 s63, s63, 1024
    buffer_load_dwordx4 v4, s[48:51], s64 offen lds
    s_mov_b32 m0, s63
    s_add_u32 s63, s63, 1024
    buffer_load_dwordx4 v5, s[48:51], s64 offen lds
    s_mov_b32 m0, s63
    s_add_u32 s63, s63, 36864
    buffer_load_dwordx4 v6, s[48:51], s64 offen lds
    s_add_u32 s64, s64, 163840
    s_mul_i32 s63, s3, 5120
    s_add_u32 s63, s63, 122880
    s_mul_i32 s64, s3, 20480
    s_add_u32 s64, s64, s62
    s_add_u32 s64, s64, 491520
    s_mov_b32 m0, s63
    s_add_u32 s63, s63, 1024
    buffer_load_dwordx4 v2, s[48:51], s64 offen lds
    s_mov_b32 m0, s63
    s_add_u32 s63, s63, 1024
    buffer_load_dwordx4 v3, s[48:51], s64 offen lds
    s_mov_b32 m0, s63
    s_add_u32 s63, s63, 1024
    buffer_load_dwordx4 v4, s[48:51], s64 offen lds
    s_mov_b32 m0, s63
    s_add_u32 s63, s63, 1024
    buffer_load_dwordx4 v5, s[48:51], s64 offen lds
    s_mov_b32 m0, s63
    s_add_u32 s63, s63, 36864
    buffer_load_dwordx4 v6, s[48:51], s64 offen lds
    s_add_u32 s64, s64, 163840
    s_waitcnt vmcnt(15)
    s_barrier
    s_cmp_lt_u32 s3, 2
    s_cbranch_scc0 rd_158
    v_add_u32 v11, 0, v10
    ds_read_b64_tr_b16 v[64:65], v11 offset:0
    ds_read_b64_tr_b16 v[66:67], v11 offset:5120
    ds_read_b64_tr_b16 v[160:161], v11 offset:32
    ds_read_b64_tr_b16 v[162:163], v11 offset:5152
    ds_read_b64_tr_b16 v[68:69], v11 offset:10240
    ds_read_b64_tr_b16 v[70:71], v11 offset:15360
    ds_read_b64_tr_b16 v[164:165], v11 offset:10272
    ds_read_b64_tr_b16 v[166:167], v11 offset:15392
    s_waitcnt lgkmcnt(6)
    ds_read_b64_tr_b16 v[72:73], v11 offset:20480
    ds_read_b64_tr_b16 v[74:75], v11 offset:25600
    ds_read_b64_tr_b16 v[168:169], v11 offset:20512
    ds_read_b64_tr_b16 v[170:171], v11 offset:25632
    ds_read_b64_tr_b16 v[76:77], v11 offset:30720
    ds_read_b64_tr_b16 v[78:79], v11 offset:35840
    ds_read_b64_tr_b16 v[172:173], v11 offset:30752
    ds_read_b64_tr_b16 v[174:175], v11 offset:35872
    s_waitcnt lgkmcnt(6)
rd_158:
    s_cmp_lt_u32 s3, 2
    s_cbranch_scc1 rd_159
    v_add_u32 v11, 0, v10
    ds_read_b64_tr_b16 v[64:65], v11 offset:0
    ds_read_b64_tr_b16 v[66:67], v11 offset:5120
    ds_read_b64_tr_b16 v[68:69], v11 offset:10240
    ds_read_b64_tr_b16 v[70:71], v11 offset:15360
    ds_read_b64_tr_b16 v[72:73], v11 offset:20480
    ds_read_b64_tr_b16 v[74:75], v11 offset:25600
    ds_read_b64_tr_b16 v[76:77], v11 offset:30720
    ds_read_b64_tr_b16 v[78:79], v11 offset:35840
    s_waitcnt lgkmcnt(6)
rd_159:
    s_waitcnt lgkmcnt(0)
    s_barrier
    s_mul_i32 s63, s3, 5120
    s_add_u32 s63, s63, 0
    s_mul_i32 s64, s3, 20480
    s_add_u32 s64, s64, s62
    s_add_u32 s64, s64, 655360
    s_mov_b32 m0, s63
    s_add_u32 s63, s63, 1024
    buffer_load_dwordx4 v2, s[48:51], s64 offen lds
    s_mov_b32 m0, s63
    s_add_u32 s63, s63, 1024
    buffer_load_dwordx4 v3, s[48:51], s64 offen lds
    s_mov_b32 m0, s63
    s_add_u32 s63, s63, 1024
    buffer_load_dwordx4 v4, s[48:51], s64 offen lds
    s_mov_b32 m0, s63
    s_add_u32 s63, s63, 1024
    buffer_load_dwordx4 v5, s[48:51], s64 offen lds
    s_mov_b32 m0, s63
    s_add_u32 s63, s63, 36864
    buffer_load_dwordx4 v6, s[48:51], s64 offen lds
    s_add_u32 s64, s64, 163840
    s_waitcnt vmcnt(15)
    s_barrier
    s_cmp_lt_u32 s3, 2
    s_cbranch_scc0 rd_160
    v_add_u32 v11, 40960, v10
    ds_read_b64_tr_b16 v[80:81], v11 offset:0
    ds_read_b64_tr_b16 v[82:83], v11 offset:5120
    ds_read_b64_tr_b16 v[176:177], v11 offset:32
    ds_read_b64_tr_b16 v[178:179], v11 offset:5152
    ds_read_b64_tr_b16 v[84:85], v11 offset:10240
    ds_read_b64_tr_b16 v[86:87], v11 offset:15360
    ds_read_b64_tr_b16 v[180:181], v11 offset:10272
    ds_read_b64_tr_b16 v[182:183], v11 offset:15392
    s_waitcnt lgkmcnt(6)
    ds_read_b64_tr_b16 v[88:89], v11 offset:20480
    ds_read_b64_tr_b16 v[90:91], v11 offset:25600
    ds_read_b64_tr_b16 v[184:185], v11 offset:20512
    ds_read_b64_tr_b16 v[186:187], v11 offset:25632
    ds_read_b64_tr_b16 v[92:93], v11 offset:30720
    ds_read_b64_tr_b16 v[94:95], v11 offset:35840
    ds_read_b64_tr_b16 v[188:189], v11 offset:30752
    ds_read_b64_tr_b16 v[190:191], v11 offset:35872
    s_waitcnt lgkmcnt(6)
rd_160:
    s_cmp_lt_u32 s3, 2
    s_cbranch_scc1 rd_161
    v_add_u32 v11, 40960, v10
    ds_read_b64_tr_b16 v[80:81], v11 offset:0
    ds_read_b64_tr_b16 v[82:83], v11 offset:5120
    ds_read_b64_tr_b16 v[84:85], v11 offset:10240
    ds_read_b64_tr_b16 v[86:87], v11 offset:15360
    ds_read_b64_tr_b16 v[88:89], v11 offset:20480
    ds_read_b64_tr_b16 v[90:91], v11 offset:25600
    ds_read_b64_tr_b16 v[92:93], v11 offset:30720
    ds_read_b64_tr_b16 v[94:95], v11 offset:35840
    s_waitcnt lgkmcnt(6)
rd_161:
    s_waitcnt lgkmcnt(0)
    s_barrier
    s_mul_i32 s63, s3, 5120
    s_add_u32 s63, s63, 40960
    s_mul_i32 s64, s3, 20480
    s_add_u32 s64, s64, s62
    s_add_u32 s64, s64, 819200
    s_mov_b32 m0, s63
    s_add_u32 s63, s63, 1024
    buffer_load_dwordx4 v2, s[48:51], s64 offen lds
    s_mov_b32 m0, s63
    s_add_u32 s63, s63, 1024
    buffer_load_dwordx4 v3, s[48:51], s64 offen lds
    s_mov_b32 m0, s63
    s_add_u32 s63, s63, 1024
    buffer_load_dwordx4 v4, s[48:51], s64 offen lds
    s_mov_b32 m0, s63
    s_add_u32 s63, s63, 1024
    buffer_load_dwordx4 v5, s[48:51], s64 offen lds
    s_mov_b32 m0, s63
    s_add_u32 s63, s63, 36864
    buffer_load_dwordx4 v6, s[48:51], s64 offen lds
    s_add_u32 s64, s64, 163840
    s_waitcnt vmcnt(15)
    s_barrier
    s_cmp_lt_u32 s3, 2
    s_cbranch_scc0 rd_162
    v_add_u32 v11, 81920, v10
    ds_read_b64_tr_b16 v[96:97], v11 offset:0
    ds_read_b64_tr_b16 v[98:99], v11 offset:5120
    ds_read_b64_tr_b16 v[192:193], v11 offset:32
    ds_read_b64_tr_b16 v[194:195], v11 offset:5152
    ds_read_b64_tr_b16 v[100:101], v11 offset:10240
    ds_read_b64_tr_b16 v[102:103], v11 offset:15360
    ds_read_b64_tr_b16 v[196:197], v11 offset:10272
    ds_read_b64_tr_b16 v[198:199], v11 offset:15392
    s_waitcnt lgkmcnt(6)
    ds_read_b64_tr_b16 v[104:105], v11 offset:20480
    ds_read_b64_tr_b16 v[106:107], v11 offset:25600
    ds_read_b64_tr_b16 v[200:201], v11 offset:20512
    ds_read_b64_tr_b16 v[202:203], v11 offset:25632
    ds_read_b64_tr_b16 v[108:109], v11 offset:30720
    ds_read_b64_tr_b16 v[110:111], v11 offset:35840
    ds_read_b64_tr_b16 v[204:205], v11 offset:30752
    ds_read_b64_tr_b16 v[206:207], v11 offset:35872
    s_waitcnt lgkmcnt(6)
rd_162:
    s_cmp_lt_u32 s3, 2
    s_cbranch_scc1 rd_163
    v_add_u32 v11, 81920, v10
    ds_read_b64_tr_b16 v[96:97], v11 offset:0
    ds_read_b64_tr_b16 v[98:99], v11 offset:5120
    ds_read_b64_tr_b16 v[100:101], v11 offset:10240
    ds_read_b64_tr_b16 v[102:103], v11 offset:15360
    ds_read_b64_tr_b16 v[104:105], v11 offset:20480
    ds_read_b64_tr_b16 v[106:107], v11 offset:25600
    ds_read_b64_tr_b16 v[108:109], v11 offset:30720
    ds_read_b64_tr_b16 v[110:111], v11 offset:35840
    s_waitcnt lgkmcnt(6)
rd_163:
    s_waitcnt lgkmcnt(0)
    s_barrier
    s_waitcnt vmcnt(10)
    s_barrier
    s_cmp_lt_u32 s3, 2
    s_cbranch_scc0 rd_164
    v_add_u32 v11, 122880, v10
    ds_read_b64_tr_b16 v[112:113], v11 offset:0
    ds_read_b64_tr_b16 v[114:115], v11 offset:5120
    ds_read_b64_tr_b16 v[208:209], v11 offset:32
    ds_read_b64_tr_b16 v[210:211], v11 offset:5152
    ds_read_b64_tr_b16 v[116:117], v11 offset:10240
    ds_read_b64_tr_b16 v[118:119], v11 offset:15360
    ds_read_b64_tr_b16 v[212:213], v11 offset:10272
    ds_read_b64_tr_b16 v[214:215], v11 offset:15392
    s_waitcnt lgkmcnt(6)
    ds_read_b64_tr_b16 v[120:121], v11 offset:20480
    ds_read_b64_tr_b16 v[122:123], v11 offset:25600
    ds_read_b64_tr_b16 v[216:217], v11 offset:20512
    ds_read_b64_tr_b16 v[218:219], v11 offset:25632
    ds_read_b64_tr_b16 v[124:125], v11 offset:30720
    ds_read_b64_tr_b16 v[126:127], v11 offset:35840
    ds_read_b64_tr_b16 v[220:221], v11 offset:30752
    ds_read_b64_tr_b16 v[222:223], v11 offset:35872
    s_waitcnt lgkmcnt(6)
rd_164:
    s_cmp_lt_u32 s3, 2
    s_cbranch_scc1 rd_165
    v_add_u32 v11, 122880, v10
    ds_read_b64_tr_b16 v[112:113], v11 offset:0
    ds_read_b64_tr_b16 v[114:115], v11 offset:5120
    ds_read_b64_tr_b16 v[116:117], v11 offset:10240
    ds_read_b64_tr_b16 v[118:119], v11 offset:15360
    ds_read_b64_tr_b16 v[120:121], v11 offset:20480
    ds_read_b64_tr_b16 v[122:123], v11 offset:25600
    ds_read_b64_tr_b16 v[124:125], v11 offset:30720
    ds_read_b64_tr_b16 v[126:127], v11 offset:35840
    s_waitcnt lgkmcnt(6)
rd_165:
    s_waitcnt lgkmcnt(0)
    s_barrier
    s_waitcnt vmcnt(5)
    s_barrier
    s_cmp_lt_u32 s3, 2
    s_cbranch_scc0 rd_166
    v_add_u32 v11, 0, v10
    ds_read_b64_tr_b16 v[128:129], v11 offset:0
    ds_read_b64_tr_b16 v[130:131], v11 offset:5120
    ds_read_b64_tr_b16 v[224:225], v11 offset:32
    ds_read_b64_tr_b16 v[226:227], v11 offset:5152
    ds_read_b64_tr_b16 v[132:133], v11 offset:10240
    ds_read_b64_tr_b16 v[134:135], v11 offset:15360
    ds_read_b64_tr_b16 v[228:229], v11 offset:10272
    ds_read_b64_tr_b16 v[230:231], v11 offset:15392
    s_waitcnt lgkmcnt(6)
    ds_read_b64_tr_b16 v[136:137], v11 offset:20480
    ds_read_b64_tr_b16 v[138:139], v11 offset:25600
    ds_read_b64_tr_b16 v[232:233], v11 offset:20512
    ds_read_b64_tr_b16 v[234:235], v11 offset:25632
    ds_read_b64_tr_b16 v[140:141], v11 offset:30720
    ds_read_b64_tr_b16 v[142:143], v11 offset:35840
    ds_read_b64_tr_b16 v[236:237], v11 offset:30752
    ds_read_b64_tr_b16 v[238:239], v11 offset:35872
    s_waitcnt lgkmcnt(6)
rd_166:
    s_cmp_lt_u32 s3, 2
    s_cbranch_scc1 rd_167
    v_add_u32 v11, 0, v10
    ds_read_b64_tr_b16 v[128:129], v11 offset:0
    ds_read_b64_tr_b16 v[130:131], v11 offset:5120
    ds_read_b64_tr_b16 v[132:133], v11 offset:10240
    ds_read_b64_tr_b16 v[134:135], v11 offset:15360
    ds_read_b64_tr_b16 v[136:137], v11 offset:20480
    ds_read_b64_tr_b16 v[138:139], v11 offset:25600
    ds_read_b64_tr_b16 v[140:141], v11 offset:30720
    ds_read_b64_tr_b16 v[142:143], v11 offset:35840
    s_waitcnt lgkmcnt(6)
rd_167:
    s_waitcnt lgkmcnt(0)
    s_barrier
    s_waitcnt vmcnt(0)
    s_barrier
    s_cmp_lt_u32 s3, 2
    s_cbranch_scc0 rd_168
    v_add_u32 v11, 40960, v10
    ds_read_b64_tr_b16 v[144:145], v11 offset:0
    ds_read_b64_tr_b16 v[146:147], v11 offset:5120
    ds_read_b64_tr_b16 v[240:241], v11 offset:32
    ds_read_b64_tr_b16 v[242:243], v11 offset:5152
    ds_read_b64_tr_b16 v[148:149], v11 offset:10240
    ds_read_b64_tr_b16 v[150:151], v11 offset:15360
    ds_read_b64_tr_b16 v[244:245], v11 offset:10272
    ds_read_b64_tr_b16 v[246:247], v11 offset:15392
    s_waitcnt lgkmcnt(6)
    ds_read_b64_tr_b16 v[152:153], v11 offset:20480
    ds_read_b64_tr_b16 v[154:155], v11 offset:25600
    ds_read_b64_tr_b16 v[248:249], v11 offset:20512
    ds_read_b64_tr_b16 v[250:251], v11 offset:25632
    ds_read_b64_tr_b16 v[156:157], v11 offset:30720
    ds_read_b64_tr_b16 v[158:159], v11 offset:35840
    ds_read_b64_tr_b16 v[252:253], v11 offset:30752
    ds_read_b64_tr_b16 v[254:255], v11 offset:35872
    s_waitcnt lgkmcnt(6)
rd_168:
    s_cmp_lt_u32 s3, 2
    s_cbranch_scc1 rd_169
    v_add_u32 v11, 40960, v10
    ds_read_b64_tr_b16 v[144:145], v11 offset:0
    ds_read_b64_tr_b16 v[146:147], v11 offset:5120
    ds_read_b64_tr_b16 v[148:149], v11 offset:10240
    ds_read_b64_tr_b16 v[150:151], v11 offset:15360
    ds_read_b64_tr_b16 v[152:153], v11 offset:20480
    ds_read_b64_tr_b16 v[154:155], v11 offset:25600
    ds_read_b64_tr_b16 v[156:157], v11 offset:30720
    ds_read_b64_tr_b16 v[158:159], v11 offset:35840
    s_waitcnt lgkmcnt(6)
rd_169:
    s_waitcnt lgkmcnt(0)
    s_barrier
    v_lshlrev_b32 v7, 4, v1
    s_mul_i32 s63, s4, 5120
    s_mul_i32 s64, s60, 10
    s_add_u32 s63, s63, s64
    s_add_u32 s63, s63, s9
    s_lshl_b32 s63, s63, 9
    s_add_u32 s63, s63, 111149056
    v_lshlrev_b32 v9, 3, v1
    v_add_u32 v9, s63, v9
    s_lshl_b32 s63, s4, 7
    s_add_u32 s63, s63, 156766208
    v_min_u32 v11, 3, v1
    v_lshlrev_b32 v11, 2, v11
    v_add_u32 v11, s63, v11
    v_mov_b32 v10, 98304
    s_mov_b32 s77, 0
    s_mov_b32 s73, 0
    s_mov_b32 s78, 0
    s_mov_b32 s79, 0
    s_and_b32 s66, s3, 1
    s_lshr_b32 s63, s3, 2
    s_lshl_b32 s63, s63, 1
    s_add_u32 s66, s66, s63
    s_lshl_b32 s66, s66, 10
    s_lshl_b32 s63, s4, 2
    s_add_u32 s63, s63, s60
    s_mul_i32 s63, s63, 12288
    v_min_u32 v14, 47, v1
    v_lshlrev_b32 v14, 7, v14
    v_add_u32 v14, s63, v14
    s_lshr_b32 s63, s3, 2
    s_mul_i32 s69, s63, 25165824
    s_and_b32 s63, s3, 1
    s_mul_i32 s63, s63, 6144
    s_add_u32 s69, s69, s63
    s_add_u32 s69, s69, 4194304
    s_lshl_b32 s67, s3, 10
    s_cmp_lt_u32 s3, 2
    s_cbranch_scc0 o1_170
    s_setprio 1
    .p2align 6
o_172:
    s_cmp_gt_u32 s78, s73
    s_cbranch_scc1 oh_173
    s_waitcnt vmcnt(0) lgkmcnt(0)
    s_barrier
    ds_read_b32 v13, v10
    s_waitcnt lgkmcnt(0)
    v_readfirstlane_b32 s63, v13
    s_cmp_lt_u32 s73, 64
    s_cselect_b32 s63, s63, 0
    s_cmp_eq_u32 s63, 1
    s_cbranch_scc1 or_178
    s_cmp_eq_u32 s79, s73
    s_cbranch_scc1 opb_179
    s_mov_b32 s79, s73
    s_cmp_eq_u32 s3, 0
    s_cbranch_scc0 fs_180
    v_mov_b32 v2, 0
    v_mov_b32 v3, s73
    buffer_store_dword v3, v2, s[44:47], s8 offen sc1
fs_180:
opb_179:
    s_cmp_eq_u32 s73, 64
    s_cbranch_scc1 of_176
    s_add_u32 s75, s73, 1
    s_cmp_eq_u32 s3, 7
    s_cbranch_scc0 w0_181
    s_cmp_ge_u32 s77, s75
    s_cbranch_scc1 fwd_183
    s_mov_b32 s76, 4000000
fw_182:
    buffer_load_dword v12, v11, s[44:47], 0 offen sc1
    s_sub_u32 s76, s76, 1
    s_cbranch_scc1 fwd_183
    s_waitcnt vmcnt(0)
    v_cmp_gt_u32 vcc, s75, v12
    s_cbranch_vccz fwo_184
    s_sleep 1
    s_branch fw_182
fwo_184:
    s_mov_b32 s77, s75
fwd_183:
w0_181:
    s_barrier
or_178:
    s_and_b32 s70, s73, 7
    s_lshl_b32 s70, s70, 4
    s_add_u32 s70, s70, s4
    s_mul_i32 s70, s70, 24576
    s_add_u32 s70, s70, s67
    s_add_u32 s70, s70, 54525952
    s_add_u32 s80, s70, 196608
    s_and_b32 s71, s73, 1
    s_mul_i32 s71, s71, 49152
    s_add_u32 s71, s71, s67
    s_add_u32 s81, s71, 24576
    s_mov_b32 m0, s71
    s_add_u32 s71, s71, 8192
    buffer_load_dwordx4 v7, s[44:47], s70 offen sc1 lds
    s_add_u32 s70, s70, 8192
    s_mov_b32 m0, s71
    s_add_u32 s71, s71, 8192
    buffer_load_dwordx4 v7, s[44:47], s70 offen sc1 lds
    s_add_u32 s70, s70, 8192
    s_mov_b32 m0, s71
    s_add_u32 s71, s71, 8192
    buffer_load_dwordx4 v7, s[44:47], s70 offen sc1 lds
    s_add_u32 s70, s70, 8192
    s_mov_b32 m0, s81
    s_add_u32 s81, s81, 8192
    buffer_load_dwordx4 v7, s[44:47], s80 offen sc1 lds
    s_add_u32 s80, s80, 8192
    s_mov_b32 m0, s81
    s_add_u32 s81, s81, 8192
    buffer_load_dwordx4 v7, s[44:47], s80 offen sc1 lds
    s_add_u32 s80, s80, 8192
    s_mov_b32 m0, s81
    s_add_u32 s81, s81, 8192
    buffer_load_dwordx4 v7, s[44:47], s80 offen sc1 lds
    s_add_u32 s80, s80, 8192
    s_add_u32 s78, s73, 1
    s_waitcnt vmcnt(3)
    s_barrier
    s_cmp_eq_u32 s79, s73
    s_cbranch_scc1 opb_185
    s_mov_b32 s79, s73
    s_cmp_eq_u32 s3, 0
    s_cbranch_scc0 fs_186
    v_mov_b32 v2, 0
    v_mov_b32 v3, s73
    buffer_store_dword v3, v2, s[44:47], s8 offen sc1
fs_186:
opb_185:
    s_branch og_177
oh_173:
    s_waitcnt vmcnt(4)
    s_barrier
og_177:
    s_and_b32 s63, s73, 1
    s_mul_i32 s63, s63, 49152
    v_add_u32 v8, s63, v7
    s_mul_i32 s74, s73, 40960
    ds_read_b128 v[16:19], v8 offset:0
    ds_read_b128 v[20:23], v8 offset:1024
    ds_read_b128 v[24:27], v8 offset:2048
    ds_read_b128 v[28:31], v8 offset:3072
    ds_read_b128 v[32:35], v8 offset:4096
    ds_read_b128 v[36:39], v8 offset:5120
    ds_read_b128 v[40:43], v8 offset:6144
    ds_read_b128 v[44:47], v8 offset:7168
    s_waitcnt lgkmcnt(7)
    v_mfma_f32_16x16x32_bf16 v[48:51], v[64:67], v[16:19], 0
    v_mfma_f32_16x16x32_bf16 v[52:55], v[160:163], v[16:19], 0
    ds_read_b128 v[16:19], v8 offset:8192
    s_waitcnt lgkmcnt(7)
    v_mfma_f32_16x16x32_bf16 v[48:51], v[68:71], v[20:23], v[48:51]
    v_mfma_f32_16x16x32_bf16 v[52:55], v[164:167], v[20:23], v[52:55]
    ds_read_b128 v[20:23], v8 offset:9216
    s_waitcnt lgkmcnt(7)
    v_mfma_f32_16x16x32_bf16 v[48:51], v[72:75], v[24:27], v[48:51]
    v_mfma_f32_16x16x32_bf16 v[52:55], v[168:171], v[24:27], v[52:55]
    ds_read_b128 v[24:27], v8 offset:10240
    s_waitcnt lgkmcnt(7)
    v_mfma_f32_16x16x32_bf16 v[48:51], v[76:79], v[28:31], v[48:51]
    v_mfma_f32_16x16x32_bf16 v[52:55], v[172:175], v[28:31], v[52:55]
    ds_read_b128 v[28:31], v8 offset:11264
    s_waitcnt lgkmcnt(7)
    v_mfma_f32_16x16x32_bf16 v[48:51], v[80:83], v[32:35], v[48:51]
    v_mfma_f32_16x16x32_bf16 v[52:55], v[176:179], v[32:35], v[52:55]
    ds_read_b128 v[32:35], v8 offset:12288
    s_waitcnt lgkmcnt(7)
    v_mfma_f32_16x16x32_bf16 v[48:51], v[84:87], v[36:39], v[48:51]
    v_mfma_f32_16x16x32_bf16 v[52:55], v[180:183], v[36:39], v[52:55]
    ds_read_b128 v[36:39], v8 offset:13312
    s_waitcnt lgkmcnt(7)
    v_mfma_f32_16x16x32_bf16 v[48:51], v[88:91], v[40:43], v[48:51]
    v_mfma_f32_16x16x32_bf16 v[52:55], v[184:187], v[40:43], v[52:55]
    ds_read_b128 v[40:43], v8 offset:14336
    s_waitcnt lgkmcnt(7)
    v_mfma_f32_16x16x32_bf16 v[48:51], v[92:95], v[44:47], v[48:51]
    v_mfma_f32_16x16x32_bf16 v[52:55], v[188:191], v[44:47], v[52:55]
    ds_read_b128 v[44:47], v8 offset:15360
    s_waitcnt lgkmcnt(7)
    v_mfma_f32_16x16x32_bf16 v[48:51], v[96:99], v[16:19], v[48:51]
    v_mfma_f32_16x16x32_bf16 v[52:55], v[192:195], v[16:19], v[52:55]
    ds_read_b128 v[16:19], v8 offset:16384
    s_waitcnt lgkmcnt(7)
    v_mfma_f32_16x16x32_bf16 v[48:51], v[100:103], v[20:23], v[48:51]
    v_mfma_f32_16x16x32_bf16 v[52:55], v[196:199], v[20:23], v[52:55]
    ds_read_b128 v[20:23], v8 offset:17408
    s_waitcnt lgkmcnt(7)
    v_mfma_f32_16x16x32_bf16 v[48:51], v[104:107], v[24:27], v[48:51]
    v_mfma_f32_16x16x32_bf16 v[52:55], v[200:203], v[24:27], v[52:55]
    ds_read_b128 v[24:27], v8 offset:18432
    s_waitcnt lgkmcnt(7)
    v_mfma_f32_16x16x32_bf16 v[48:51], v[108:111], v[28:31], v[48:51]
    v_mfma_f32_16x16x32_bf16 v[52:55], v[204:207], v[28:31], v[52:55]
    ds_read_b128 v[28:31], v8 offset:19456
    s_waitcnt lgkmcnt(7)
    v_mfma_f32_16x16x32_bf16 v[48:51], v[112:115], v[32:35], v[48:51]
    v_mfma_f32_16x16x32_bf16 v[52:55], v[208:211], v[32:35], v[52:55]
    ds_read_b128 v[32:35], v8 offset:20480
    s_waitcnt lgkmcnt(7)
    v_mfma_f32_16x16x32_bf16 v[48:51], v[116:119], v[36:39], v[48:51]
    v_mfma_f32_16x16x32_bf16 v[52:55], v[212:215], v[36:39], v[52:55]
    ds_read_b128 v[36:39], v8 offset:21504
    s_waitcnt lgkmcnt(7)
    v_mfma_f32_16x16x32_bf16 v[48:51], v[120:123], v[40:43], v[48:51]
    v_mfma_f32_16x16x32_bf16 v[52:55], v[216:219], v[40:43], v[52:55]
    ds_read_b128 v[40:43], v8 offset:22528
    s_waitcnt lgkmcnt(7)
    v_mfma_f32_16x16x32_bf16 v[48:51], v[124:127], v[44:47], v[48:51]
    v_mfma_f32_16x16x32_bf16 v[52:55], v[220:223], v[44:47], v[52:55]
    ds_read_b128 v[44:47], v8 offset:23552
    s_waitcnt lgkmcnt(7)
    v_mfma_f32_16x16x32_bf16 v[48:51], v[128:131], v[16:19], v[48:51]
    v_mfma_f32_16x16x32_bf16 v[52:55], v[224:227], v[16:19], v[52:55]
    s_waitcnt lgkmcnt(6)
    v_mfma_f32_16x16x32_bf16 v[48:51], v[132:135], v[20:23], v[48:51]
    v_mfma_f32_16x16x32_bf16 v[52:55], v[228:231], v[20:23], v[52:55]
    s_waitcnt lgkmcnt(5)
    v_mfma_f32_16x16x32_bf16 v[48:51], v[136:139], v[24:27], v[48:51]
    v_mfma_f32_16x16x32_bf16 v[52:55], v[232:235], v[24:27], v[52:55]
    s_waitcnt lgkmcnt(4)
    v_mfma_f32_16x16x32_bf16 v[48:51], v[140:143], v[28:31], v[48:51]
    v_mfma_f32_16x16x32_bf16 v[52:55], v[236:239], v[28:31], v[52:55]
    s_waitcnt lgkmcnt(3)
    v_mfma_f32_16x16x32_bf16 v[48:51], v[144:147], v[32:35], v[48:51]
    v_mfma_f32_16x16x32_bf16 v[52:55], v[240:243], v[32:35], v[52:55]
    s_waitcnt lgkmcnt(2)
    v_mfma_f32_16x16x32_bf16 v[48:51], v[148:151], v[36:39], v[48:51]
    v_mfma_f32_16x16x32_bf16 v[52:55], v[244:247], v[36:39], v[52:55]
    s_waitcnt lgkmcnt(1)
    v_mfma_f32_16x16x32_bf16 v[48:51], v[152:155], v[40:43], v[48:51]
    v_mfma_f32_16x16x32_bf16 v[52:55], v[248:251], v[40:43], v[52:55]
    s_waitcnt lgkmcnt(0)
    v_mfma_f32_16x16x32_bf16 v[48:51], v[156:159], v[44:47], v[48:51]
    v_mfma_f32_16x16x32_bf16 v[52:55], v[252:255], v[44:47], v[52:55]
    s_waitcnt vmcnt(0) lgkmcnt(0)
    s_barrier
    ds_read_b32 v13, v10
    s_add_u32 s75, s73, 1
    s_waitcnt lgkmcnt(0)
    v_readfirstlane_b32 s63, v13
    s_cmp_lt_u32 s75, 64
    s_cselect_b32 s63, s63, 0
    s_cmp_eq_u32 s63, 0
    s_cbranch_scc1 ob_187
    s_add_u32 s78, s75, 1
    ds_read_b128 v[16:19], v8 offset:24576
    ds_read_b128 v[20:23], v8 offset:25600
    ds_read_b128 v[24:27], v8 offset:26624
    ds_read_b128 v[28:31], v8 offset:27648
    ds_read_b128 v[32:35], v8 offset:28672
    ds_read_b128 v[36:39], v8 offset:29696
    ds_read_b128 v[40:43], v8 offset:30720
    ds_read_b128 v[44:47], v8 offset:31744
    s_waitcnt lgkmcnt(7)
    v_mfma_f32_16x16x32_bf16 v[56:59], v[64:67], v[16:19], 0
    v_mfma_f32_16x16x32_bf16 v[60:63], v[160:163], v[16:19], 0
    ds_read_b128 v[16:19], v8 offset:32768
    s_waitcnt lgkmcnt(7)
    v_mfma_f32_16x16x32_bf16 v[56:59], v[68:71], v[20:23], v[56:59]
    v_mfma_f32_16x16x32_bf16 v[60:63], v[164:167], v[20:23], v[60:63]
    ds_read_b128 v[20:23], v8 offset:33792
    s_waitcnt lgkmcnt(7)
    v_mfma_f32_16x16x32_bf16 v[56:59], v[72:75], v[24:27], v[56:59]
    v_mfma_f32_16x16x32_bf16 v[60:63], v[168:171], v[24:27], v[60:63]
    ds_read_b128 v[24:27], v8 offset:34816
    s_waitcnt lgkmcnt(7)
    v_mfma_f32_16x16x32_bf16 v[56:59], v[76:79], v[28:31], v[56:59]
    v_mfma_f32_16x16x32_bf16 v[60:63], v[172:175], v[28:31], v[60:63]
    ds_read_b128 v[28:31], v8 offset:35840
    s_waitcnt lgkmcnt(7)
    v_mfma_f32_16x16x32_bf16 v[56:59], v[80:83], v[32:35], v[56:59]
    v_mfma_f32_16x16x32_bf16 v[60:63], v[176:179], v[32:35], v[60:63]
    ds_read_b128 v[32:35], v8 offset:36864
    s_waitcnt lgkmcnt(7)
    v_mfma_f32_16x16x32_bf16 v[56:59], v[84:87], v[36:39], v[56:59]
    v_mfma_f32_16x16x32_bf16 v[60:63], v[180:183], v[36:39], v[60:63]
    ds_read_b128 v[36:39], v8 offset:37888
    s_waitcnt lgkmcnt(7)
    v_mfma_f32_16x16x32_bf16 v[56:59], v[88:91], v[40:43], v[56:59]
    v_mfma_f32_16x16x32_bf16 v[60:63], v[184:187], v[40:43], v[60:63]
    ds_read_b128 v[40:43], v8 offset:38912
    s_waitcnt lgkmcnt(7)
    v_mfma_f32_16x16x32_bf16 v[56:59], v[92:95], v[44:47], v[56:59]
    v_mfma_f32_16x16x32_bf16 v[60:63], v[188:191], v[44:47], v[60:63]
    ds_read_b128 v[44:47], v8 offset:39936
    s_waitcnt lgkmcnt(7)
    v_mfma_f32_16x16x32_bf16 v[56:59], v[96:99], v[16:19], v[56:59]
    v_mfma_f32_16x16x32_bf16 v[60:63], v[192:195], v[16:19], v[60:63]
    ds_read_b128 v[16:19], v8 offset:40960
    s_waitcnt lgkmcnt(7)
    v_mfma_f32_16x16x32_bf16 v[56:59], v[100:103], v[20:23], v[56:59]
    v_mfma_f32_16x16x32_bf16 v[60:63], v[196:199], v[20:23], v[60:63]
    ds_read_b128 v[20:23], v8 offset:41984
    s_waitcnt lgkmcnt(7)
    v_mfma_f32_16x16x32_bf16 v[56:59], v[104:107], v[24:27], v[56:59]
    v_mfma_f32_16x16x32_bf16 v[60:63], v[200:203], v[24:27], v[60:63]
    ds_read_b128 v[24:27], v8 offset:43008
    s_cmp_eq_u32 s79, s73
    s_cbranch_scc1 opb_188
    s_mov_b32 s79, s73
    s_cmp_eq_u32 s3, 0
    s_cbranch_scc0 fs_189
    v_mov_b32 v2, 0
    v_mov_b32 v3, s73
    buffer_store_dword v3, v2, s[44:47], s8 offen sc1
fs_189:
opb_188:
    s_waitcnt lgkmcnt(7)
    v_mfma_f32_16x16x32_bf16 v[56:59], v[108:111], v[28:31], v[56:59]
    v_mfma_f32_16x16x32_bf16 v[60:63], v[204:207], v[28:31], v[60:63]
    ds_read_b128 v[28:31], v8 offset:44032
    s_waitcnt lgkmcnt(7)
    v_mfma_f32_16x16x32_bf16 v[56:59], v[112:115], v[32:35], v[56:59]
    v_mfma_f32_16x16x32_bf16 v[60:63], v[208:211], v[32:35], v[60:63]
    ds_read_b128 v[32:35], v8 offset:45056
    s_waitcnt lgkmcnt(7)
    v_mfma_f32_16x16x32_bf16 v[56:59], v[116:119], v[36:39], v[56:59]
    v_mfma_f32_16x16x32_bf16 v[60:63], v[212:215], v[36:39], v[60:63]
    ds_read_b128 v[36:39], v8 offset:46080
    v_cvt_pk_bf16_f32 v48, v48, v49
    v_cvt_pk_bf16_f32 v49, v50, v51
    v_min_u32 v48, -2, v48
    v_min_u32 v49, -2, v49
    buffer_store_dwordx2 v[48:49], v9, s[44:47], s74 offen offset:0 sc1
    v_cvt_pk_bf16_f32 v52, v52, v53
    v_cvt_pk_bf16_f32 v53, v54, v55
    v_min_u32 v52, -2, v52
    v_min_u32 v53, -2, v53
    buffer_store_dwordx2 v[52:53], v9, s[44:47], s74 offen offset:512 sc1
    s_add_u32 s74, s74, 20480
    s_waitcnt lgkmcnt(7)
    v_mfma_f32_16x16x32_bf16 v[56:59], v[120:123], v[40:43], v[56:59]
    v_mfma_f32_16x16x32_bf16 v[60:63], v[216:219], v[40:43], v[60:63]
    ds_read_b128 v[40:43], v8 offset:47104
    s_waitcnt lgkmcnt(7)
    v_mfma_f32_16x16x32_bf16 v[56:59], v[124:127], v[44:47], v[56:59]
    v_mfma_f32_16x16x32_bf16 v[60:63], v[220:223], v[44:47], v[60:63]
    ds_read_b128 v[44:47], v8 offset:48128
    s_waitcnt lgkmcnt(7)
    v_mfma_f32_16x16x32_bf16 v[56:59], v[128:131], v[16:19], v[56:59]
    v_mfma_f32_16x16x32_bf16 v[60:63], v[224:227], v[16:19], v[60:63]
    s_waitcnt lgkmcnt(6)
    v_mfma_f32_16x16x32_bf16 v[56:59], v[132:135], v[20:23], v[56:59]
    v_mfma_f32_16x16x32_bf16 v[60:63], v[228:231], v[20:23], v[60:63]
    s_waitcnt lgkmcnt(5)
    v_mfma_f32_16x16x32_bf16 v[56:59], v[136:139], v[24:27], v[56:59]
    v_mfma_f32_16x16x32_bf16 v[60:63], v[232:235], v[24:27], v[60:63]
    s_waitcnt lgkmcnt(4)
    v_mfma_f32_16x16x32_bf16 v[56:59], v[140:143], v[28:31], v[56:59]
    v_mfma_f32_16x16x32_bf16 v[60:63], v[236:239], v[28:31], v[60:63]
    s_waitcnt lgkmcnt(3)
    v_mfma_f32_16x16x32_bf16 v[56:59], v[144:147], v[32:35], v[56:59]
    v_mfma_f32_16x16x32_bf16 v[60:63], v[240:243], v[32:35], v[60:63]
    s_waitcnt lgkmcnt(2)
    v_mfma_f32_16x16x32_bf16 v[56:59], v[148:151], v[36:39], v[56:59]
    v_mfma_f32_16x16x32_bf16 v[60:63], v[244:247], v[36:39], v[60:63]
    s_waitcnt lgkmcnt(1)
    v_mfma_f32_16x16x32_bf16 v[56:59], v[152:155], v[40:43], v[56:59]
    v_mfma_f32_16x16x32_bf16 v[60:63], v[248:251], v[40:43], v[60:63]
    s_waitcnt lgkmcnt(0)
    v_mfma_f32_16x16x32_bf16 v[56:59], v[156:159], v[44:47], v[56:59]
    v_mfma_f32_16x16x32_bf16 v[60:63], v[252:255], v[44:47], v[60:63]
    s_branch oj_175
ob_187:
    s_cmp_eq_u32 s79, s73
    s_cbranch_scc1 opb_190
    s_mov_b32 s79, s73
    s_cmp_eq_u32 s3, 0
    s_cbranch_scc0 fs_191
    v_mov_b32 v2, 0
    v_mov_b32 v3, s73
    buffer_store_dword v3, v2, s[44:47], s8 offen sc1
fs_191:
opb_190:
    v_cvt_pk_bf16_f32 v48, v48, v49
    v_cvt_pk_bf16_f32 v49, v50, v51
    v_min_u32 v48, -2, v48
    v_min_u32 v49, -2, v49
    buffer_store_dwordx2 v[48:49], v9, s[44:47], s74 offen offset:0 sc1
    v_cvt_pk_bf16_f32 v52, v52, v53
    v_cvt_pk_bf16_f32 v53, v54, v55
    v_min_u32 v52, -2, v52
    v_min_u32 v53, -2, v53
    buffer_store_dwordx2 v[52:53], v9, s[44:47], s74 offen offset:512 sc1
    s_add_u32 s74, s74, 20480
    ds_read_b128 v[16:19], v8 offset:24576
    ds_read_b128 v[20:23], v8 offset:25600
    ds_read_b128 v[24:27], v8 offset:26624
    ds_read_b128 v[28:31], v8 offset:27648
    ds_read_b128 v[32:35], v8 offset:28672
    ds_read_b128 v[36:39], v8 offset:29696
    ds_read_b128 v[40:43], v8 offset:30720
    ds_read_b128 v[44:47], v8 offset:31744
    s_waitcnt lgkmcnt(7)
    v_mfma_f32_16x16x32_bf16 v[56:59], v[64:67], v[16:19], 0
    v_mfma_f32_16x16x32_bf16 v[60:63], v[160:163], v[16:19], 0
    ds_read_b128 v[16:19], v8 offset:32768
    s_waitcnt lgkmcnt(7)
    v_mfma_f32_16x16x32_bf16 v[56:59], v[68:71], v[20:23], v[56:59]
    v_mfma_f32_16x16x32_bf16 v[60:63], v[164:167], v[20:23], v[60:63]
    ds_read_b128 v[20:23], v8 offset:33792
    s_waitcnt lgkmcnt(7)
    v_mfma_f32_16x16x32_bf16 v[56:59], v[72:75], v[24:27], v[56:59]
    v_mfma_f32_16x16x32_bf16 v[60:63], v[168:171], v[24:27], v[60:63]
    ds_read_b128 v[24:27], v8 offset:34816
    s_waitcnt lgkmcnt(7)
    v_mfma_f32_16x16x32_bf16 v[56:59], v[76:79], v[28:31], v[56:59]
    v_mfma_f32_16x16x32_bf16 v[60:63], v[172:175], v[28:31], v[60:63]
    ds_read_b128 v[28:31], v8 offset:35840
    s_waitcnt lgkmcnt(7)
    v_mfma_f32_16x16x32_bf16 v[56:59], v[80:83], v[32:35], v[56:59]
    v_mfma_f32_16x16x32_bf16 v[60:63], v[176:179], v[32:35], v[60:63]
    ds_read_b128 v[32:35], v8 offset:36864
    s_waitcnt lgkmcnt(7)
    v_mfma_f32_16x16x32_bf16 v[56:59], v[84:87], v[36:39], v[56:59]
    v_mfma_f32_16x16x32_bf16 v[60:63], v[180:183], v[36:39], v[60:63]
    ds_read_b128 v[36:39], v8 offset:37888
    s_waitcnt lgkmcnt(7)
    v_mfma_f32_16x16x32_bf16 v[56:59], v[88:91], v[40:43], v[56:59]
    v_mfma_f32_16x16x32_bf16 v[60:63], v[184:187], v[40:43], v[60:63]
    ds_read_b128 v[40:43], v8 offset:38912
    s_waitcnt lgkmcnt(7)
    v_mfma_f32_16x16x32_bf16 v[56:59], v[92:95], v[44:47], v[56:59]
    v_mfma_f32_16x16x32_bf16 v[60:63], v[188:191], v[44:47], v[60:63]
    ds_read_b128 v[44:47], v8 offset:39936
    s_waitcnt lgkmcnt(7)
    v_mfma_f32_16x16x32_bf16 v[56:59], v[96:99], v[16:19], v[56:59]
    v_mfma_f32_16x16x32_bf16 v[60:63], v[192:195], v[16:19], v[60:63]
    ds_read_b128 v[16:19], v8 offset:40960
    s_waitcnt lgkmcnt(7)
    v_mfma_f32_16x16x32_bf16 v[56:59], v[100:103], v[20:23], v[56:59]
    v_mfma_f32_16x16x32_bf16 v[60:63], v[196:199], v[20:23], v[60:63]
    ds_read_b128 v[20:23], v8 offset:41984
    s_waitcnt lgkmcnt(7)
    v_mfma_f32_16x16x32_bf16 v[56:59], v[104:107], v[24:27], v[56:59]
    v_mfma_f32_16x16x32_bf16 v[60:63], v[200:203], v[24:27], v[60:63]
    ds_read_b128 v[24:27], v8 offset:43008
    s_waitcnt lgkmcnt(7)
    v_mfma_f32_16x16x32_bf16 v[56:59], v[108:111], v[28:31], v[56:59]
    v_mfma_f32_16x16x32_bf16 v[60:63], v[204:207], v[28:31], v[60:63]
    ds_read_b128 v[28:31], v8 offset:44032
    s_waitcnt lgkmcnt(7)
    v_mfma_f32_16x16x32_bf16 v[56:59], v[112:115], v[32:35], v[56:59]
    v_mfma_f32_16x16x32_bf16 v[60:63], v[208:211], v[32:35], v[60:63]
    ds_read_b128 v[32:35], v8 offset:45056
    s_waitcnt lgkmcnt(7)
    v_mfma_f32_16x16x32_bf16 v[56:59], v[116:119], v[36:39], v[56:59]
    v_mfma_f32_16x16x32_bf16 v[60:63], v[212:215], v[36:39], v[60:63]
    ds_read_b128 v[36:39], v8 offset:46080
    s_waitcnt lgkmcnt(7)
    v_mfma_f32_16x16x32_bf16 v[56:59], v[120:123], v[40:43], v[56:59]
    v_mfma_f32_16x16x32_bf16 v[60:63], v[216:219], v[40:43], v[60:63]
    ds_read_b128 v[40:43], v8 offset:47104
    s_waitcnt lgkmcnt(7)
    v_mfma_f32_16x16x32_bf16 v[56:59], v[124:127], v[44:47], v[56:59]
    v_mfma_f32_16x16x32_bf16 v[60:63], v[220:223], v[44:47], v[60:63]
    ds_read_b128 v[44:47], v8 offset:48128
    s_waitcnt lgkmcnt(7)
    v_mfma_f32_16x16x32_bf16 v[56:59], v[128:131], v[16:19], v[56:59]
    v_mfma_f32_16x16x32_bf16 v[60:63], v[224:227], v[16:19], v[60:63]
    s_waitcnt lgkmcnt(6)
    v_mfma_f32_16x16x32_bf16 v[56:59], v[132:135], v[20:23], v[56:59]
    v_mfma_f32_16x16x32_bf16 v[60:63], v[228:231], v[20:23], v[60:63]
    s_waitcnt lgkmcnt(5)
    v_mfma_f32_16x16x32_bf16 v[56:59], v[136:139], v[24:27], v[56:59]
    v_mfma_f32_16x16x32_bf16 v[60:63], v[232:235], v[24:27], v[60:63]
    s_waitcnt lgkmcnt(4)
    v_mfma_f32_16x16x32_bf16 v[56:59], v[140:143], v[28:31], v[56:59]
    v_mfma_f32_16x16x32_bf16 v[60:63], v[236:239], v[28:31], v[60:63]
    s_waitcnt lgkmcnt(3)
    v_mfma_f32_16x16x32_bf16 v[56:59], v[144:147], v[32:35], v[56:59]
    v_mfma_f32_16x16x32_bf16 v[60:63], v[240:243], v[32:35], v[60:63]
    s_waitcnt lgkmcnt(2)
    v_mfma_f32_16x16x32_bf16 v[56:59], v[148:151], v[36:39], v[56:59]
    v_mfma_f32_16x16x32_bf16 v[60:63], v[244:247], v[36:39], v[60:63]
    s_waitcnt lgkmcnt(1)
    v_mfma_f32_16x16x32_bf16 v[56:59], v[152:155], v[40:43], v[56:59]
    v_mfma_f32_16x16x32_bf16 v[60:63], v[248:251], v[40:43], v[60:63]
    s_waitcnt lgkmcnt(0)
    v_mfma_f32_16x16x32_bf16 v[56:59], v[156:159], v[44:47], v[56:59]
    v_mfma_f32_16x16x32_bf16 v[60:63], v[252:255], v[44:47], v[60:63]
oj_175:
    s_nop 7
    v_cvt_pk_bf16_f32 v56, v56, v57
    v_cvt_pk_bf16_f32 v57, v58, v59
    v_min_u32 v56, -2, v56
    v_min_u32 v57, -2, v57
    buffer_store_dwordx2 v[56:57], v9, s[44:47], s74 offen offset:0 sc1
    v_cvt_pk_bf16_f32 v60, v60, v61
    v_cvt_pk_bf16_f32 v61, v62, v63
    v_min_u32 v60, -2, v60
    v_min_u32 v61, -2, v61
    buffer_store_dwordx2 v[60:61], v9, s[44:47], s74 offen offset:512 sc1
    s_add_u32 s73, s73, 1
    s_branch o_172
of_176:
    s_endpgm
o1_170:
    s_bitcmp1_b32 s3, 1
    s_cbranch_scc1 o2_171
    .p2align 6
o_192:
    s_cmp_gt_u32 s78, s73
    s_cbranch_scc1 oh_193
    s_waitcnt vmcnt(0) lgkmcnt(0)
    s_barrier
    ds_read_b32 v13, v10
    s_waitcnt lgkmcnt(0)
    v_readfirstlane_b32 s63, v13
    s_cmp_lt_u32 s73, 64
    s_cselect_b32 s63, s63, 0
    s_cmp_eq_u32 s63, 1
    s_cbranch_scc1 or_198
    s_cmp_eq_u32 s73, 64
    s_cbranch_scc1 of_196
    s_add_u32 s75, s73, 1
    s_cmp_eq_u32 s3, 7
    s_cbranch_scc0 w0_199
    s_cmp_ge_u32 s77, s75
    s_cbranch_scc1 fwd_201
    s_mov_b32 s76, 4000000
fw_200:
    buffer_load_dword v12, v11, s[44:47], 0 offen sc1
    s_sub_u32 s76, s76, 1
    s_cbranch_scc1 fwd_201
    s_waitcnt vmcnt(0)
    v_cmp_gt_u32 vcc, s75, v12
    s_cbranch_vccz fwo_202
    s_sleep 1
    s_branch fw_200
fwo_202:
    s_mov_b32 s77, s75
fwd_201:
w0_199:
    s_barrier
or_198:
    s_and_b32 s70, s73, 7
    s_lshl_b32 s70, s70, 4
    s_add_u32 s70, s70, s4
    s_mul_i32 s70, s70, 24576
    s_add_u32 s70, s70, s67
    s_add_u32 s70, s70, 54525952
    s_add_u32 s80, s70, 196608
    s_and_b32 s71, s73, 1
    s_mul_i32 s71, s71, 49152
    s_add_u32 s71, s71, s67
    s_add_u32 s81, s71, 24576
    s_mov_b32 m0, s71
    s_add_u32 s71, s71, 8192
    buffer_load_dwordx4 v7, s[44:47], s70 offen sc1 lds
    s_add_u32 s70, s70, 8192
    s_mov_b32 m0, s71
    s_add_u32 s71, s71, 8192
    buffer_load_dwordx4 v7, s[44:47], s70 offen sc1 lds
    s_add_u32 s70, s70, 8192
    s_mov_b32 m0, s71
    s_add_u32 s71, s71, 8192
    buffer_load_dwordx4 v7, s[44:47], s70 offen sc1 lds
    s_add_u32 s70, s70, 8192
    s_mov_b32 m0, s81
    s_add_u32 s81, s81, 8192
    buffer_load_dwordx4 v7, s[44:47], s80 offen sc1 lds
    s_add_u32 s80, s80, 8192
    s_mov_b32 m0, s81
    s_add_u32 s81, s81, 8192
    buffer_load_dwordx4 v7, s[44:47], s80 offen sc1 lds
    s_add_u32 s80, s80, 8192
    s_mov_b32 m0, s81
    s_add_u32 s81, s81, 8192
    buffer_load_dwordx4 v7, s[44:47], s80 offen sc1 lds
    s_add_u32 s80, s80, 8192
    s_add_u32 s78, s73, 1
    s_waitcnt vmcnt(3)
    s_barrier
    s_branch og_197
oh_193:
    s_waitcnt vmcnt(2)
    s_barrier
og_197:
    s_and_b32 s63, s73, 1
    s_mul_i32 s63, s63, 49152
    v_add_u32 v8, s63, v7
    s_mul_i32 s74, s73, 40960
    ds_read_b128 v[16:19], v8 offset:0
    ds_read_b128 v[20:23], v8 offset:1024
    ds_read_b128 v[24:27], v8 offset:2048
    ds_read_b128 v[28:31], v8 offset:3072
    ds_read_b128 v[32:35], v8 offset:4096
    ds_read_b128 v[36:39], v8 offset:5120
    ds_read_b128 v[40:43], v8 offset:6144
    ds_read_b128 v[44:47], v8 offset:7168
    s_waitcnt lgkmcnt(7)
    v_mfma_f32_16x16x32_bf16 v[48:51], v[64:67], v[16:19], 0
    ds_read_b128 v[16:19], v8 offset:8192
    s_waitcnt lgkmcnt(7)
    v_mfma_f32_16x16x32_bf16 v[48:51], v[68:71], v[20:23], v[48:51]
    ds_read_b128 v[20:23], v8 offset:9216
    s_waitcnt lgkmcnt(7)
    v_mfma_f32_16x16x32_bf16 v[48:51], v[72:75], v[24:27], v[48:51]
    ds_read_b128 v[24:27], v8 offset:10240
    s_waitcnt lgkmcnt(7)
    v_mfma_f32_16x16x32_bf16 v[48:51], v[76:79], v[28:31], v[48:51]
    ds_read_b128 v[28:31], v8 offset:11264
    s_waitcnt lgkmcnt(7)
    v_mfma_f32_16x16x32_bf16 v[48:51], v[80:83], v[32:35], v[48:51]
    ds_read_b128 v[32:35], v8 offset:12288
    s_waitcnt lgkmcnt(7)
    v_mfma_f32_16x16x32_bf16 v[48:51], v[84:87], v[36:39], v[48:51]
    ds_read_b128 v[36:39], v8 offset:13312
    s_waitcnt lgkmcnt(7)
    v_mfma_f32_16x16x32_bf16 v[48:51], v[88:91], v[40:43], v[48:51]
    ds_read_b128 v[40:43], v8 offset:14336
    s_waitcnt lgkmcnt(7)
    v_mfma_f32_16x16x32_bf16 v[48:51], v[92:95], v[44:47], v[48:51]
    ds_read_b128 v[44:47], v8 offset:15360
    s_waitcnt lgkmcnt(7)
    v_mfma_f32_16x16x32_bf16 v[48:51], v[96:99], v[16:19], v[48:51]
    ds_read_b128 v[16:19], v8 offset:16384
    s_waitcnt lgkmcnt(7)
    v_mfma_f32_16x16x32_bf16 v[48:51], v[100:103], v[20:23], v[48:51]
    ds_read_b128 v[20:23], v8 offset:17408
    s_waitcnt lgkmcnt(7)
    v_mfma_f32_16x16x32_bf16 v[48:51], v[104:107], v[24:27], v[48:51]
    ds_read_b128 v[24:27], v8 offset:18432
    s_waitcnt lgkmcnt(7)
    v_mfma_f32_16x16x32_bf16 v[48:51], v[108:111], v[28:31], v[48:51]
    ds_read_b128 v[28:31], v8 offset:19456
    s_waitcnt lgkmcnt(7)
    v_mfma_f32_16x16x32_bf16 v[48:51], v[112:115], v[32:35], v[48:51]
    ds_read_b128 v[32:35], v8 offset:20480
    s_waitcnt lgkmcnt(7)
    v_mfma_f32_16x16x32_bf16 v[48:51], v[116:119], v[36:39], v[48:51]
    ds_read_b128 v[36:39], v8 offset:21504
    s_waitcnt lgkmcnt(7)
    v_mfma_f32_16x16x32_bf16 v[48:51], v[120:123], v[40:43], v[48:51]
    ds_read_b128 v[40:43], v8 offset:22528
    s_waitcnt lgkmcnt(7)
    v_mfma_f32_16x16x32_bf16 v[48:51], v[124:127], v[44:47], v[48:51]
    ds_read_b128 v[44:47], v8 offset:23552
    s_waitcnt lgkmcnt(7)
    v_mfma_f32_16x16x32_bf16 v[48:51], v[128:131], v[16:19], v[48:51]
    s_waitcnt lgkmcnt(6)
    v_mfma_f32_16x16x32_bf16 v[48:51], v[132:135], v[20:23], v[48:51]
    s_waitcnt lgkmcnt(5)
    v_mfma_f32_16x16x32_bf16 v[48:51], v[136:139], v[24:27], v[48:51]
    s_waitcnt lgkmcnt(4)
    v_mfma_f32_16x16x32_bf16 v[48:51], v[140:143], v[28:31], v[48:51]
    s_waitcnt lgkmcnt(3)
    v_mfma_f32_16x16x32_bf16 v[48:51], v[144:147], v[32:35], v[48:51]
    s_waitcnt lgkmcnt(2)
    v_mfma_f32_16x16x32_bf16 v[48:51], v[148:151], v[36:39], v[48:51]
    s_waitcnt lgkmcnt(1)
    v_mfma_f32_16x16x32_bf16 v[48:51], v[152:155], v[40:43], v[48:51]
    s_waitcnt lgkmcnt(0)
    v_mfma_f32_16x16x32_bf16 v[48:51], v[156:159], v[44:47], v[48:51]
    s_waitcnt vmcnt(0) lgkmcnt(0)
    s_barrier
    ds_read_b32 v13, v10
    s_add_u32 s75, s73, 1
    s_waitcnt lgkmcnt(0)
    v_readfirstlane_b32 s63, v13
    s_cmp_lt_u32 s75, 64
    s_cselect_b32 s63, s63, 0
    s_cmp_eq_u32 s63, 0
    s_cbranch_scc1 ob_203
    s_add_u32 s78, s75, 1
    ds_read_b128 v[16:19], v8 offset:24576
    ds_read_b128 v[20:23], v8 offset:25600
    ds_read_b128 v[24:27], v8 offset:26624
    ds_read_b128 v[28:31], v8 offset:27648
    ds_read_b128 v[32:35], v8 offset:28672
    ds_read_b128 v[36:39], v8 offset:29696
    ds_read_b128 v[40:43], v8 offset:30720
    ds_read_b128 v[44:47], v8 offset:31744
    s_waitcnt lgkmcnt(7)
    v_mfma_f32_16x16x32_bf16 v[56:59], v[64:67], v[16:19], 0
    ds_read_b128 v[16:19], v8 offset:32768
    s_waitcnt lgkmcnt(7)
    v_mfma_f32_16x16x32_bf16 v[56:59], v[68:71], v[20:23], v[56:59]
    ds_read_b128 v[20:23], v8 offset:33792
    s_waitcnt lgkmcnt(7)
    v_mfma_f32_16x16x32_bf16 v[56:59], v[72:75], v[24:27], v[56:59]
    ds_read_b128 v[24:27], v8 offset:34816
    s_waitcnt lgkmcnt(7)
    v_mfma_f32_16x16x32_bf16 v[56:59], v[76:79], v[28:31], v[56:59]
    ds_read_b128 v[28:31], v8 offset:35840
    s_waitcnt lgkmcnt(7)
    v_mfma_f32_16x16x32_bf16 v[56:59], v[80:83], v[32:35], v[56:59]
    ds_read_b128 v[32:35], v8 offset:36864
    s_waitcnt lgkmcnt(7)
    v_mfma_f32_16x16x32_bf16 v[56:59], v[84:87], v[36:39], v[56:59]
    ds_read_b128 v[36:39], v8 offset:37888
    s_waitcnt lgkmcnt(7)
    v_mfma_f32_16x16x32_bf16 v[56:59], v[88:91], v[40:43], v[56:59]
    ds_read_b128 v[40:43], v8 offset:38912
    s_waitcnt lgkmcnt(7)
    v_mfma_f32_16x16x32_bf16 v[56:59], v[92:95], v[44:47], v[56:59]
    ds_read_b128 v[44:47], v8 offset:39936
    s_waitcnt lgkmcnt(7)
    v_mfma_f32_16x16x32_bf16 v[56:59], v[96:99], v[16:19], v[56:59]
    ds_read_b128 v[16:19], v8 offset:40960
    s_waitcnt lgkmcnt(7)
    v_mfma_f32_16x16x32_bf16 v[56:59], v[100:103], v[20:23], v[56:59]
    ds_read_b128 v[20:23], v8 offset:41984
    s_waitcnt lgkmcnt(7)
    v_mfma_f32_16x16x32_bf16 v[56:59], v[104:107], v[24:27], v[56:59]
    ds_read_b128 v[24:27], v8 offset:43008
    s_waitcnt lgkmcnt(7)
    v_mfma_f32_16x16x32_bf16 v[56:59], v[108:111], v[28:31], v[56:59]
    ds_read_b128 v[28:31], v8 offset:44032
    s_waitcnt lgkmcnt(7)
    v_mfma_f32_16x16x32_bf16 v[56:59], v[112:115], v[32:35], v[56:59]
    ds_read_b128 v[32:35], v8 offset:45056
    s_waitcnt lgkmcnt(7)
    v_mfma_f32_16x16x32_bf16 v[56:59], v[116:119], v[36:39], v[56:59]
    ds_read_b128 v[36:39], v8 offset:46080
    v_cvt_pk_bf16_f32 v48, v48, v49
    v_cvt_pk_bf16_f32 v49, v50, v51
    v_min_u32 v48, -2, v48
    v_min_u32 v49, -2, v49
    buffer_store_dwordx2 v[48:49], v9, s[44:47], s74 offen offset:0 sc1
    s_add_u32 s74, s74, 20480
    s_waitcnt lgkmcnt(7)
    v_mfma_f32_16x16x32_bf16 v[56:59], v[120:123], v[40:43], v[56:59]
    ds_read_b128 v[40:43], v8 offset:47104
    s_waitcnt lgkmcnt(7)
    v_mfma_f32_16x16x32_bf16 v[56:59], v[124:127], v[44:47], v[56:59]
    ds_read_b128 v[44:47], v8 offset:48128
    s_waitcnt lgkmcnt(7)
    v_mfma_f32_16x16x32_bf16 v[56:59], v[128:131], v[16:19], v[56:59]
    s_waitcnt lgkmcnt(6)
    v_mfma_f32_16x16x32_bf16 v[56:59], v[132:135], v[20:23], v[56:59]
    s_waitcnt lgkmcnt(5)
    v_mfma_f32_16x16x32_bf16 v[56:59], v[136:139], v[24:27], v[56:59]
    s_waitcnt lgkmcnt(4)
    v_mfma_f32_16x16x32_bf16 v[56:59], v[140:143], v[28:31], v[56:59]
    s_waitcnt lgkmcnt(3)
    v_mfma_f32_16x16x32_bf16 v[56:59], v[144:147], v[32:35], v[56:59]
    s_waitcnt lgkmcnt(2)
    v_mfma_f32_16x16x32_bf16 v[56:59], v[148:151], v[36:39], v[56:59]
    s_waitcnt lgkmcnt(1)
    v_mfma_f32_16x16x32_bf16 v[56:59], v[152:155], v[40:43], v[56:59]
    s_waitcnt lgkmcnt(0)
    v_mfma_f32_16x16x32_bf16 v[56:59], v[156:159], v[44:47], v[56:59]
    s_branch oj_195
ob_203:
    v_cvt_pk_bf16_f32 v48, v48, v49
    v_cvt_pk_bf16_f32 v49, v50, v51
    v_min_u32 v48, -2, v48
    v_min_u32 v49, -2, v49
    buffer_store_dwordx2 v[48:49], v9, s[44:47], s74 offen offset:0 sc1
    s_add_u32 s74, s74, 20480
    ds_read_b128 v[16:19], v8 offset:24576
    ds_read_b128 v[20:23], v8 offset:25600
    ds_read_b128 v[24:27], v8 offset:26624
    ds_read_b128 v[28:31], v8 offset:27648
    ds_read_b128 v[32:35], v8 offset:28672
    ds_read_b128 v[36:39], v8 offset:29696
    ds_read_b128 v[40:43], v8 offset:30720
    ds_read_b128 v[44:47], v8 offset:31744
    s_waitcnt lgkmcnt(7)
    v_mfma_f32_16x16x32_bf16 v[56:59], v[64:67], v[16:19], 0
    ds_read_b128 v[16:19], v8 offset:32768
    s_waitcnt lgkmcnt(7)
    v_mfma_f32_16x16x32_bf16 v[56:59], v[68:71], v[20:23], v[56:59]
    ds_read_b128 v[20:23], v8 offset:33792
    s_waitcnt lgkmcnt(7)
    v_mfma_f32_16x16x32_bf16 v[56:59], v[72:75], v[24:27], v[56:59]
    ds_read_b128 v[24:27], v8 offset:34816
    s_waitcnt lgkmcnt(7)
    v_mfma_f32_16x16x32_bf16 v[56:59], v[76:79], v[28:31], v[56:59]
    ds_read_b128 v[28:31], v8 offset:35840
    s_waitcnt lgkmcnt(7)
    v_mfma_f32_16x16x32_bf16 v[56:59], v[80:83], v[32:35], v[56:59]
    ds_read_b128 v[32:35], v8 offset:36864
    s_waitcnt lgkmcnt(7)
    v_mfma_f32_16x16x32_bf16 v[56:59], v[84:87], v[36:39], v[56:59]
    ds_read_b128 v[36:39], v8 offset:37888
    s_waitcnt lgkmcnt(7)
    v_mfma_f32_16x16x32_bf16 v[56:59], v[88:91], v[40:43], v[56:59]
    ds_read_b128 v[40:43], v8 offset:38912
    s_waitcnt lgkmcnt(7)
    v_mfma_f32_16x16x32_bf16 v[56:59], v[92:95], v[44:47], v[56:59]
    ds_read_b128 v[44:47], v8 offset:39936
    s_waitcnt lgkmcnt(7)
    v_mfma_f32_16x16x32_bf16 v[56:59], v[96:99], v[16:19], v[56:59]
    ds_read_b128 v[16:19], v8 offset:40960
    s_waitcnt lgkmcnt(7)
    v_mfma_f32_16x16x32_bf16 v[56:59], v[100:103], v[20:23], v[56:59]
    ds_read_b128 v[20:23], v8 offset:41984
    s_waitcnt lgkmcnt(7)
    v_mfma_f32_16x16x32_bf16 v[56:59], v[104:107], v[24:27], v[56:59]
    ds_read_b128 v[24:27], v8 offset:43008
    s_waitcnt lgkmcnt(7)
    v_mfma_f32_16x16x32_bf16 v[56:59], v[108:111], v[28:31], v[56:59]
    ds_read_b128 v[28:31], v8 offset:44032
    s_waitcnt lgkmcnt(7)
    v_mfma_f32_16x16x32_bf16 v[56:59], v[112:115], v[32:35], v[56:59]
    ds_read_b128 v[32:35], v8 offset:45056
    s_waitcnt lgkmcnt(7)
    v_mfma_f32_16x16x32_bf16 v[56:59], v[116:119], v[36:39], v[56:59]
    ds_read_b128 v[36:39], v8 offset:46080
    s_waitcnt lgkmcnt(7)
    v_mfma_f32_16x16x32_bf16 v[56:59], v[120:123], v[40:43], v[56:59]
    ds_read_b128 v[40:43], v8 offset:47104
    s_waitcnt lgkmcnt(7)
    v_mfma_f32_16x16x32_bf16 v[56:59], v[124:127], v[44:47], v[56:59]
    ds_read_b128 v[44:47], v8 offset:48128
    s_waitcnt lgkmcnt(7)
    v_mfma_f32_16x16x32_bf16 v[56:59], v[128:131], v[16:19], v[56:59]
    s_waitcnt lgkmcnt(6)
    v_mfma_f32_16x16x32_bf16 v[56:59], v[132:135], v[20:23], v[56:59]
    s_waitcnt lgkmcnt(5)
    v_mfma_f32_16x16x32_bf16 v[56:59], v[136:139], v[24:27], v[56:59]
    s_waitcnt lgkmcnt(4)
    v_mfma_f32_16x16x32_bf16 v[56:59], v[140:143], v[28:31], v[56:59]
    s_waitcnt lgkmcnt(3)
    v_mfma_f32_16x16x32_bf16 v[56:59], v[144:147], v[32:35], v[56:59]
    s_waitcnt lgkmcnt(2)
    v_mfma_f32_16x16x32_bf16 v[56:59], v[148:151], v[36:39], v[56:59]
    s_waitcnt lgkmcnt(1)
    v_mfma_f32_16x16x32_bf16 v[56:59], v[152:155], v[40:43], v[56:59]
    s_waitcnt lgkmcnt(0)
    v_mfma_f32_16x16x32_bf16 v[56:59], v[156:159], v[44:47], v[56:59]
oj_195:
    s_nop 7
    v_cvt_pk_bf16_f32 v56, v56, v57
    v_cvt_pk_bf16_f32 v57, v58, v59
    v_min_u32 v56, -2, v56
    v_min_u32 v57, -2, v57
    buffer_store_dwordx2 v[56:57], v9, s[44:47], s74 offen offset:0 sc1
    s_add_u32 s73, s73, 1
    s_branch o_192
of_196:
    s_endpgm
o2_171:
    .p2align 6
o_204:
    s_cmp_gt_u32 s78, s73
    s_cbranch_scc1 oh_205
    s_cmp_eq_u32 s3, 7
    s_cbranch_scc0 op_211
    buffer_load_dword v12, v11, s[44:47], 0 offen sc1
op_211:
    s_cmp_eq_u32 s3, 7
    s_cbranch_scc0 op_212
    s_waitcnt vmcnt(0)
    s_add_u32 s75, s73, 1
    v_cmp_gt_u32 vcc, s75, v12
    s_cmp_eq_u64 vcc, 0
    s_cselect_b32 s63, 1, 0
    v_mov_b32 v13, s63
    ds_write_b32 v10, v13
op_212:
    s_waitcnt vmcnt(0) lgkmcnt(0)
    s_barrier
    ds_read_b32 v13, v10
    s_waitcnt lgkmcnt(0)
    v_readfirstlane_b32 s63, v13
    s_cmp_lt_u32 s73, 64
    s_cselect_b32 s63, s63, 0
    s_cmp_eq_u32 s63, 1
    s_cbranch_scc1 or_210
    s_cmp_eq_u32 s73, 64
    s_cbranch_scc1 of_208
    s_add_u32 s75, s73, 1
    s_cmp_eq_u32 s3, 7
    s_cbranch_scc0 w0_213
    s_cmp_ge_u32 s77, s75
    s_cbranch_scc1 fwd_215
    s_mov_b32 s76, 4000000
fw_214:
    buffer_load_dword v12, v11, s[44:47], 0 offen sc1
    s_sub_u32 s76, s76, 1
    s_cbranch_scc1 fwd_215
    s_waitcnt vmcnt(0)
    v_cmp_gt_u32 vcc, s75, v12
    s_cbranch_vccz fwo_216
    s_sleep 1
    s_branch fw_214
fwo_216:
    s_mov_b32 s77, s75
fwd_215:
w0_213:
    s_barrier
or_210:
    s_and_b32 s70, s73, 7
    s_lshl_b32 s70, s70, 4
    s_add_u32 s70, s70, s4
    s_mul_i32 s70, s70, 24576
    s_add_u32 s70, s70, s67
    s_add_u32 s70, s70, 54525952
    s_add_u32 s80, s70, 196608
    s_and_b32 s71, s73, 1
    s_mul_i32 s71, s71, 49152
    s_add_u32 s71, s71, s67
    s_add_u32 s81, s71, 24576
    s_mov_b32 m0, s71
    s_add_u32 s71, s71, 8192
    buffer_load_dwordx4 v7, s[44:47], s70 offen sc1 lds
    s_add_u32 s70, s70, 8192
    s_mov_b32 m0, s71
    s_add_u32 s71, s71, 8192
    buffer_load_dwordx4 v7, s[44:47], s70 offen sc1 lds
    s_add_u32 s70, s70, 8192
    s_mov_b32 m0, s71
    s_add_u32 s71, s71, 8192
    buffer_load_dwordx4 v7, s[44:47], s70 offen sc1 lds
    s_add_u32 s70, s70, 8192
    s_mov_b32 m0, s81
    s_add_u32 s81, s81, 8192
    buffer_load_dwordx4 v7, s[44:47], s80 offen sc1 lds
    s_add_u32 s80, s80, 8192
    s_mov_b32 m0, s81
    s_add_u32 s81, s81, 8192
    buffer_load_dwordx4 v7, s[44:47], s80 offen sc1 lds
    s_add_u32 s80, s80, 8192
    s_mov_b32 m0, s81
    s_add_u32 s81, s81, 8192
    buffer_load_dwordx4 v7, s[44:47], s80 offen sc1 lds
    s_add_u32 s80, s80, 8192
    s_add_u32 s78, s73, 1
    s_waitcnt vmcnt(3)
    s_barrier
    s_branch og_209
oh_205:
    s_waitcnt vmcnt(2)
    s_barrier
og_209:
    s_and_b32 s63, s73, 1
    s_mul_i32 s63, s63, 49152
    v_add_u32 v8, s63, v7
    s_mul_i32 s74, s73, 40960
    ds_read_b128 v[16:19], v8 offset:0
    ds_read_b128 v[20:23], v8 offset:1024
    ds_read_b128 v[24:27], v8 offset:2048
    ds_read_b128 v[28:31], v8 offset:3072
    ds_read_b128 v[32:35], v8 offset:4096
    ds_read_b128 v[36:39], v8 offset:5120
    ds_read_b128 v[40:43], v8 offset:6144
    ds_read_b128 v[44:47], v8 offset:7168
    s_waitcnt lgkmcnt(7)
    v_mfma_f32_16x16x32_bf16 v[48:51], v[64:67], v[16:19], 0
    ds_read_b128 v[16:19], v8 offset:8192
    s_waitcnt lgkmcnt(7)
    v_mfma_f32_16x16x32_bf16 v[48:51], v[68:71], v[20:23], v[48:51]
    ds_read_b128 v[20:23], v8 offset:9216
    s_waitcnt lgkmcnt(7)
    v_mfma_f32_16x16x32_bf16 v[48:51], v[72:75], v[24:27], v[48:51]
    ds_read_b128 v[24:27], v8 offset:10240
    s_waitcnt lgkmcnt(7)
    v_mfma_f32_16x16x32_bf16 v[48:51], v[76:79], v[28:31], v[48:51]
    ds_read_b128 v[28:31], v8 offset:11264
    s_waitcnt lgkmcnt(7)
    v_mfma_f32_16x16x32_bf16 v[48:51], v[80:83], v[32:35], v[48:51]
    ds_read_b128 v[32:35], v8 offset:12288
    s_waitcnt lgkmcnt(7)
    v_mfma_f32_16x16x32_bf16 v[48:51], v[84:87], v[36:39], v[48:51]
    ds_read_b128 v[36:39], v8 offset:13312
    s_waitcnt lgkmcnt(7)
    v_mfma_f32_16x16x32_bf16 v[48:51], v[88:91], v[40:43], v[48:51]
    ds_read_b128 v[40:43], v8 offset:14336
    s_waitcnt lgkmcnt(7)
    v_mfma_f32_16x16x32_bf16 v[48:51], v[92:95], v[44:47], v[48:51]
    ds_read_b128 v[44:47], v8 offset:15360
    s_waitcnt lgkmcnt(7)
    v_mfma_f32_16x16x32_bf16 v[48:51], v[96:99], v[16:19], v[48:51]
    ds_read_b128 v[16:19], v8 offset:16384
    s_waitcnt lgkmcnt(7)
    v_mfma_f32_16x16x32_bf16 v[48:51], v[100:103], v[20:23], v[48:51]
    ds_read_b128 v[20:23], v8 offset:17408
    s_waitcnt lgkmcnt(7)
    v_mfma_f32_16x16x32_bf16 v[48:51], v[104:107], v[24:27], v[48:51]
    ds_read_b128 v[24:27], v8 offset:18432
    s_waitcnt lgkmcnt(7)
    v_mfma_f32_16x16x32_bf16 v[48:51], v[108:111], v[28:31], v[48:51]
    ds_read_b128 v[28:31], v8 offset:19456
    s_waitcnt lgkmcnt(7)
    v_mfma_f32_16x16x32_bf16 v[48:51], v[112:115], v[32:35], v[48:51]
    ds_read_b128 v[32:35], v8 offset:20480
    s_cmp_eq_u32 s3, 7
    s_cbranch_scc0 op_217
    buffer_load_dword v12, v11, s[44:47], 0 offen sc1
op_217:
    s_waitcnt lgkmcnt(7)
    v_mfma_f32_16x16x32_bf16 v[48:51], v[116:119], v[36:39], v[48:51]
    ds_read_b128 v[36:39], v8 offset:21504
    s_waitcnt lgkmcnt(7)
    v_mfma_f32_16x16x32_bf16 v[48:51], v[120:123], v[40:43], v[48:51]
    ds_read_b128 v[40:43], v8 offset:22528
    s_waitcnt lgkmcnt(7)
    v_mfma_f32_16x16x32_bf16 v[48:51], v[124:127], v[44:47], v[48:51]
    ds_read_b128 v[44:47], v8 offset:23552
    s_waitcnt lgkmcnt(7)
    v_mfma_f32_16x16x32_bf16 v[48:51], v[128:131], v[16:19], v[48:51]
    s_waitcnt lgkmcnt(6)
    v_mfma_f32_16x16x32_bf16 v[48:51], v[132:135], v[20:23], v[48:51]
    s_waitcnt lgkmcnt(5)
    v_mfma_f32_16x16x32_bf16 v[48:51], v[136:139], v[24:27], v[48:51]
    s_waitcnt lgkmcnt(4)
    v_mfma_f32_16x16x32_bf16 v[48:51], v[140:143], v[28:31], v[48:51]
    s_waitcnt lgkmcnt(3)
    v_mfma_f32_16x16x32_bf16 v[48:51], v[144:147], v[32:35], v[48:51]
    s_waitcnt lgkmcnt(2)
    v_mfma_f32_16x16x32_bf16 v[48:51], v[148:151], v[36:39], v[48:51]
    s_waitcnt lgkmcnt(1)
    v_mfma_f32_16x16x32_bf16 v[48:51], v[152:155], v[40:43], v[48:51]
    s_waitcnt lgkmcnt(0)
    v_mfma_f32_16x16x32_bf16 v[48:51], v[156:159], v[44:47], v[48:51]
    s_cmp_eq_u32 s3, 7
    s_cbranch_scc0 op_218
    s_waitcnt vmcnt(0)
    s_add_u32 s75, s73, 2
    v_cmp_gt_u32 vcc, s75, v12
    s_cmp_eq_u64 vcc, 0
    s_cselect_b32 s63, 1, 0
    v_mov_b32 v13, s63
    ds_write_b32 v10, v13
op_218:
    s_waitcnt vmcnt(0) lgkmcnt(0)
    s_barrier
    ds_read_b32 v13, v10
    s_add_u32 s75, s73, 1
    s_waitcnt lgkmcnt(0)
    v_readfirstlane_b32 s63, v13
    s_cmp_lt_u32 s75, 64
    s_cselect_b32 s63, s63, 0
    s_cmp_eq_u32 s63, 0
    s_cbranch_scc1 ob_219
    s_add_u32 s78, s75, 1
    s_and_b32 s70, s75, 7
    s_lshl_b32 s70, s70, 4
    s_add_u32 s70, s70, s4
    s_mul_i32 s70, s70, 24576
    s_add_u32 s70, s70, s66
    s_add_u32 s70, s70, 54525952
    s_add_u32 s80, s70, 196608
    s_and_b32 s71, s75, 1
    s_mul_i32 s71, s71, 49152
    s_add_u32 s71, s71, s66
    s_add_u32 s81, s71, 24576
    ds_read_b128 v[16:19], v8 offset:24576
    ds_read_b128 v[20:23], v8 offset:25600
    ds_read_b128 v[24:27], v8 offset:26624
    ds_read_b128 v[28:31], v8 offset:27648
    ds_read_b128 v[32:35], v8 offset:28672
    ds_read_b128 v[36:39], v8 offset:29696
    ds_read_b128 v[40:43], v8 offset:30720
    ds_read_b128 v[44:47], v8 offset:31744
    s_waitcnt lgkmcnt(7)
    v_mfma_f32_16x16x32_bf16 v[56:59], v[64:67], v[16:19], 0
    ds_read_b128 v[16:19], v8 offset:32768
    s_mov_b32 m0, s71
    s_add_u32 s71, s71, 4096
    buffer_load_dwordx4 v7, s[44:47], s70 offen sc1 lds
    s_add_u32 s70, s70, 4096
    s_waitcnt lgkmcnt(7)
    v_mfma_f32_16x16x32_bf16 v[56:59], v[68:71], v[20:23], v[56:59]
    ds_read_b128 v[20:23], v8 offset:33792
    s_mov_b32 m0, s71
    s_add_u32 s71, s71, 4096
    buffer_load_dwordx4 v7, s[44:47], s70 offen sc1 lds
    s_add_u32 s70, s70, 4096
    s_waitcnt lgkmcnt(7)
    v_mfma_f32_16x16x32_bf16 v[56:59], v[72:75], v[24:27], v[56:59]
    ds_read_b128 v[24:27], v8 offset:34816
    s_mov_b32 m0, s71
    s_add_u32 s71, s71, 4096
    buffer_load_dwordx4 v7, s[44:47], s70 offen sc1 lds
    s_add_u32 s70, s70, 4096
    s_waitcnt lgkmcnt(7)
    v_mfma_f32_16x16x32_bf16 v[56:59], v[76:79], v[28:31], v[56:59]
    ds_read_b128 v[28:31], v8 offset:35840
    s_mov_b32 m0, s71
    s_add_u32 s71, s71, 4096
    buffer_load_dwordx4 v7, s[44:47], s70 offen sc1 lds
    s_add_u32 s70, s70, 4096
    s_waitcnt lgkmcnt(7)
    v_mfma_f32_16x16x32_bf16 v[56:59], v[80:83], v[32:35], v[56:59]
    ds_read_b128 v[32:35], v8 offset:36864
    s_mov_b32 m0, s71
    s_add_u32 s71, s71, 4096
    buffer_load_dwordx4 v7, s[44:47], s70 offen sc1 lds
    s_add_u32 s70, s70, 4096
    s_waitcnt lgkmcnt(7)
    v_mfma_f32_16x16x32_bf16 v[56:59], v[84:87], v[36:39], v[56:59]
    ds_read_b128 v[36:39], v8 offset:37888
    s_mov_b32 m0, s71
    s_add_u32 s71, s71, 4096
    buffer_load_dwordx4 v7, s[44:47], s70 offen sc1 lds
    s_add_u32 s70, s70, 4096
    s_waitcnt lgkmcnt(7)
    v_mfma_f32_16x16x32_bf16 v[56:59], v[88:91], v[40:43], v[56:59]
    ds_read_b128 v[40:43], v8 offset:38912
    s_mov_b32 m0, s81
    s_add_u32 s81, s81, 4096
    buffer_load_dwordx4 v7, s[44:47], s80 offen sc1 lds
    s_add_u32 s80, s80, 4096
    s_waitcnt lgkmcnt(7)
    v_mfma_f32_16x16x32_bf16 v[56:59], v[92:95], v[44:47], v[56:59]
    ds_read_b128 v[44:47], v8 offset:39936
    s_mov_b32 m0, s81
    s_add_u32 s81, s81, 4096
    buffer_load_dwordx4 v7, s[44:47], s80 offen sc1 lds
    s_add_u32 s80, s80, 4096
    s_waitcnt lgkmcnt(7)
    v_mfma_f32_16x16x32_bf16 v[56:59], v[96:99], v[16:19], v[56:59]
    ds_read_b128 v[16:19], v8 offset:40960
    s_mov_b32 m0, s81
    s_add_u32 s81, s81, 4096
    buffer_load_dwordx4 v7, s[44:47], s80 offen sc1 lds
    s_add_u32 s80, s80, 4096
    s_waitcnt lgkmcnt(7)
    v_mfma_f32_16x16x32_bf16 v[56:59], v[100:103], v[20:23], v[56:59]
    ds_read_b128 v[20:23], v8 offset:41984
    s_mov_b32 m0, s81
    s_add_u32 s81, s81, 4096
    buffer_load_dwordx4 v7, s[44:47], s80 offen sc1 lds
    s_add_u32 s80, s80, 4096
    s_waitcnt lgkmcnt(7)
    v_mfma_f32_16x16x32_bf16 v[56:59], v[104:107], v[24:27], v[56:59]
    ds_read_b128 v[24:27], v8 offset:43008
    s_mov_b32 m0, s81
    s_add_u32 s81, s81, 4096
    buffer_load_dwordx4 v7, s[44:47], s80 offen sc1 lds
    s_add_u32 s80, s80, 4096
    s_waitcnt lgkmcnt(7)
    v_mfma_f32_16x16x32_bf16 v[56:59], v[108:111], v[28:31], v[56:59]
    ds_read_b128 v[28:31], v8 offset:44032
    s_mov_b32 m0, s81
    s_add_u32 s81, s81, 4096
    buffer_load_dwordx4 v7, s[44:47], s80 offen sc1 lds
    s_add_u32 s80, s80, 4096
    s_waitcnt lgkmcnt(7)
    v_mfma_f32_16x16x32_bf16 v[56:59], v[112:115], v[32:35], v[56:59]
    ds_read_b128 v[32:35], v8 offset:45056
    s_waitcnt lgkmcnt(7)
    v_mfma_f32_16x16x32_bf16 v[56:59], v[116:119], v[36:39], v[56:59]
    ds_read_b128 v[36:39], v8 offset:46080
    v_cvt_pk_bf16_f32 v48, v48, v49
    v_cvt_pk_bf16_f32 v49, v50, v51
    v_min_u32 v48, -2, v48
    v_min_u32 v49, -2, v49
    buffer_store_dwordx2 v[48:49], v9, s[44:47], s74 offen offset:0 sc1
    s_add_u32 s74, s74, 20480
    s_waitcnt lgkmcnt(7)
    v_mfma_f32_16x16x32_bf16 v[56:59], v[120:123], v[40:43], v[56:59]
    ds_read_b128 v[40:43], v8 offset:47104
    s_waitcnt lgkmcnt(7)
    v_mfma_f32_16x16x32_bf16 v[56:59], v[124:127], v[44:47], v[56:59]
    ds_read_b128 v[44:47], v8 offset:48128
    s_waitcnt lgkmcnt(7)
    v_mfma_f32_16x16x32_bf16 v[56:59], v[128:131], v[16:19], v[56:59]
    s_waitcnt lgkmcnt(6)
    v_mfma_f32_16x16x32_bf16 v[56:59], v[132:135], v[20:23], v[56:59]
    s_waitcnt lgkmcnt(5)
    v_mfma_f32_16x16x32_bf16 v[56:59], v[136:139], v[24:27], v[56:59]
    s_waitcnt lgkmcnt(4)
    v_mfma_f32_16x16x32_bf16 v[56:59], v[140:143], v[28:31], v[56:59]
    s_waitcnt lgkmcnt(3)
    v_mfma_f32_16x16x32_bf16 v[56:59], v[144:147], v[32:35], v[56:59]
    s_waitcnt lgkmcnt(2)
    v_mfma_f32_16x16x32_bf16 v[56:59], v[148:151], v[36:39], v[56:59]
    s_waitcnt lgkmcnt(1)
    v_mfma_f32_16x16x32_bf16 v[56:59], v[152:155], v[40:43], v[56:59]
    s_waitcnt lgkmcnt(0)
    v_mfma_f32_16x16x32_bf16 v[56:59], v[156:159], v[44:47], v[56:59]
    s_branch oj_207
ob_219:
    v_cvt_pk_bf16_f32 v48, v48, v49
    v_cvt_pk_bf16_f32 v49, v50, v51
    v_min_u32 v48, -2, v48
    v_min_u32 v49, -2, v49
    buffer_store_dwordx2 v[48:49], v9, s[44:47], s74 offen offset:0 sc1
    s_add_u32 s74, s74, 20480
    ds_read_b128 v[16:19], v8 offset:24576
    ds_read_b128 v[20:23], v8 offset:25600
    ds_read_b128 v[24:27], v8 offset:26624
    ds_read_b128 v[28:31], v8 offset:27648
    ds_read_b128 v[32:35], v8 offset:28672
    ds_read_b128 v[36:39], v8 offset:29696
    ds_read_b128 v[40:43], v8 offset:30720
    ds_read_b128 v[44:47], v8 offset:31744
    s_waitcnt lgkmcnt(7)
    v_mfma_f32_16x16x32_bf16 v[56:59], v[64:67], v[16:19], 0
    ds_read_b128 v[16:19], v8 offset:32768
    s_waitcnt lgkmcnt(7)
    v_mfma_f32_16x16x32_bf16 v[56:59], v[68:71], v[20:23], v[56:59]
    ds_read_b128 v[20:23], v8 offset:33792
    s_waitcnt lgkmcnt(7)
    v_mfma_f32_16x16x32_bf16 v[56:59], v[72:75], v[24:27], v[56:59]
    ds_read_b128 v[24:27], v8 offset:34816
    s_waitcnt lgkmcnt(7)
    v_mfma_f32_16x16x32_bf16 v[56:59], v[76:79], v[28:31], v[56:59]
    ds_read_b128 v[28:31], v8 offset:35840
    s_waitcnt lgkmcnt(7)
    v_mfma_f32_16x16x32_bf16 v[56:59], v[80:83], v[32:35], v[56:59]
    ds_read_b128 v[32:35], v8 offset:36864
    s_waitcnt lgkmcnt(7)
    v_mfma_f32_16x16x32_bf16 v[56:59], v[84:87], v[36:39], v[56:59]
    ds_read_b128 v[36:39], v8 offset:37888
    s_waitcnt lgkmcnt(7)
    v_mfma_f32_16x16x32_bf16 v[56:59], v[88:91], v[40:43], v[56:59]
    ds_read_b128 v[40:43], v8 offset:38912
    s_waitcnt lgkmcnt(7)
    v_mfma_f32_16x16x32_bf16 v[56:59], v[92:95], v[44:47], v[56:59]
    ds_read_b128 v[44:47], v8 offset:39936
    s_waitcnt lgkmcnt(7)
    v_mfma_f32_16x16x32_bf16 v[56:59], v[96:99], v[16:19], v[56:59]
    ds_read_b128 v[16:19], v8 offset:40960
    s_waitcnt lgkmcnt(7)
    v_mfma_f32_16x16x32_bf16 v[56:59], v[100:103], v[20:23], v[56:59]
    ds_read_b128 v[20:23], v8 offset:41984
    s_waitcnt lgkmcnt(7)
    v_mfma_f32_16x16x32_bf16 v[56:59], v[104:107], v[24:27], v[56:59]
    ds_read_b128 v[24:27], v8 offset:43008
    s_waitcnt lgkmcnt(7)
    v_mfma_f32_16x16x32_bf16 v[56:59], v[108:111], v[28:31], v[56:59]
    ds_read_b128 v[28:31], v8 offset:44032
    s_waitcnt lgkmcnt(7)
    v_mfma_f32_16x16x32_bf16 v[56:59], v[112:115], v[32:35], v[56:59]
    ds_read_b128 v[32:35], v8 offset:45056
    s_waitcnt lgkmcnt(7)
    v_mfma_f32_16x16x32_bf16 v[56:59], v[116:119], v[36:39], v[56:59]
    ds_read_b128 v[36:39], v8 offset:46080
    s_waitcnt lgkmcnt(7)
    v_mfma_f32_16x16x32_bf16 v[56:59], v[120:123], v[40:43], v[56:59]
    ds_read_b128 v[40:43], v8 offset:47104
    s_waitcnt lgkmcnt(7)
    v_mfma_f32_16x16x32_bf16 v[56:59], v[124:127], v[44:47], v[56:59]
    ds_read_b128 v[44:47], v8 offset:48128
    s_waitcnt lgkmcnt(7)
    v_mfma_f32_16x16x32_bf16 v[56:59], v[128:131], v[16:19], v[56:59]
    s_waitcnt lgkmcnt(6)
    v_mfma_f32_16x16x32_bf16 v[56:59], v[132:135], v[20:23], v[56:59]
    s_waitcnt lgkmcnt(5)
    v_mfma_f32_16x16x32_bf16 v[56:59], v[136:139], v[24:27], v[56:59]
    s_waitcnt lgkmcnt(4)
    v_mfma_f32_16x16x32_bf16 v[56:59], v[140:143], v[28:31], v[56:59]
    s_waitcnt lgkmcnt(3)
    v_mfma_f32_16x16x32_bf16 v[56:59], v[144:147], v[32:35], v[56:59]
    s_waitcnt lgkmcnt(2)
    v_mfma_f32_16x16x32_bf16 v[56:59], v[148:151], v[36:39], v[56:59]
    s_waitcnt lgkmcnt(1)
    v_mfma_f32_16x16x32_bf16 v[56:59], v[152:155], v[40:43], v[56:59]
    s_waitcnt lgkmcnt(0)
    v_mfma_f32_16x16x32_bf16 v[56:59], v[156:159], v[44:47], v[56:59]
oj_207:
    s_nop 7
    v_cvt_pk_bf16_f32 v56, v56, v57
    v_cvt_pk_bf16_f32 v57, v58, v59
    v_min_u32 v56, -2, v56
    v_min_u32 v57, -2, v57
    buffer_store_dwordx2 v[56:57], v9, s[44:47], s74 offen offset:0 sc1
    s_add_u32 s73, s73, 1
    s_branch o_204
of_208:
    s_endpgm
L_r:
    s_lshl_b32 s63, s15, 3
    s_add_u32 s63, s63, s3
    s_cmp_ge_u32 s63, 12
    s_cselect_b32 s64, 1, 0
    s_lshl_b32 s4, s9, 1
    s_add_u32 s4, s4, s64
    s_mul_i32 s65, s63, 86
    s_lshr_b32 s65, s65, 8
    s_mul_i32 s61, s65, 3
    s_sub_u32 s61, s63, s61
    s_lshl_b32 s62, s9, 3
    s_add_u32 s62, s62, s65
    s_lshl_b32 s8, s62, 7
    s_lshl_b32 s63, s61, 2
    s_add_u32 s8, s8, s63
    s_add_u32 s8, s8, 156835840
    v_mov_b32 v2, 0
    buffer_store_dword v2, v2, s[44:47], s8 offen sc1
    buffer_store_dword v2, v2, s[44:47], s8 offen offset:16 sc1
    s_and_b32 s63, s62, 3
    s_mul_i32 s63, s63, 3
    s_add_u32 s63, s63, s61
    s_lshl_b32 s63, s63, 2
    s_lshl_b32 s67, s4, 7
    s_add_u32 s67, s67, s63
    s_add_u32 s67, s67, 156764192
    buffer_store_dword v2, v2, s[44:47], s67 offen sc1
    v_lshlrev_b32 v7, 4, v1
    v_mov_b32 v16, -1
    v_mov_b32 v17, -1
    v_mov_b32 v18, -1
    v_mov_b32 v19, -1
    s_mul_i32 s63, s62, 6144
    s_lshl_b32 s64, s61, 11
    s_add_u32 s63, s63, s64
    s_lshr_b32 s64, s63, 1
    s_lshl_b32 s65, s61, 10
    s_sub_u32 s63, s63, s65
    s_add_u32 s63, s63, 180158464
    s_add_u32 s64, s64, 186548224
    buffer_store_dwordx4 v[16:19], v7, s[44:47], s63 offen sc1
    buffer_store_dwordx4 v[16:19], v7, s[44:47], s64 offen sc1
    s_waitcnt vmcnt(0)
    s_barrier
    s_cmp_eq_u32 s3, 0
    s_cbranch_scc0 arr_220
    s_getreg_b32 s12, hwreg(HW_REG_XCC_ID)
    s_and_b32 s12, s12, 15
    s_cmp_gt_u32 s12, 7
    s_cselect_b32 s13, s14, 0
    s_lshr_b32 s13, s13, 3
    s_add_u32 s12, s12, s13
    s_sub_u32 s12, s12, s14
    s_and_b32 s12, s12, 7
    s_mul_i32 s13, s12, s12
    s_lshl_b32 s12, s12, 9
    s_or_b32 s12, s12, 1
    v_mov_b32 v12, s12
    v_mov_b32 v13, s13
    v_mov_b32 v14, 1073741824
    v_cmp_eq_u32 vcc, 0, v1
    s_nop 1
    v_cndmask_b32 v14, v14, v1, vcc
    buffer_atomic_add_x2 v[12:13], v14, s[56:59], s10 offen sc1
arr_220:
    v_mov_b32 v8, 0
    s_cmp_eq_u32 s3, 0
    s_cbranch_scc0 wao_223
    s_mov_b32 s76, 1000000
wa_221:
    buffer_load_dword v9, v8, s[56:59], s10 offen offset:128 sc1
    s_sub_u32 s76, s76, 1
    s_cbranch_scc1 wad_222
    s_waitcnt vmcnt(0)
    v_readfirstlane_b32 s63, v9
    s_cmp_lg_u32 s63, 0
    s_cbranch_scc1 wad_222
    s_sleep 8
    s_branch wa_221
wad_222:
    s_waitcnt vmcnt(0)
    ds_write_b32 v8, v9
    s_waitcnt lgkmcnt(0)
wao_223:
    s_barrier
    ds_read_b32 v9, v8
    s_waitcnt lgkmcnt(0)
    v_readfirstlane_b32 s63, v9
    s_cmp_lg_u32 s63, 1
    s_cselect_b32 s6, 1, 0
    s_waitcnt vmcnt(0)
    s_barrier
    s_cbranch_scc0 wak_224
    s_cmp_eq_u32 s10, 0
    s_mov_b32 s10, 16
    s_cbranch_scc1 L_restart
wak_224:
    v_lshlrev_b32 v7, 4, v1
    s_lshl_b32 s63, s4, 8
    s_and_b32 s64, s62, 3
    s_mul_i32 s64, s64, 3
    s_add_u32 s64, s64, s61
    s_lshl_b32 s64, s64, 2
    s_add_u32 s63, s63, s64
    s_add_u32 s63, s63, 156762112
    v_mov_b32 v11, s63
    s_mul_i32 s63, s62, 6144
    s_lshl_b32 s64, s61, 11
    s_add_u32 s63, s63, s64
    v_add_u32 v5, s63, v7
    v_mov_b32 v4, 1073741824
    v_and_b32 v2, 2, v1
    v_cmp_eq_u32 vcc, 0, v2
    s_nop 1
    v_cndmask_b32 v5, v4, v5, vcc
    s_lshr_b32 s63, s63, 1
    v_add_u32 v6, s63, v7
    s_mul_i32 s63, s62, 6144
    s_lshl_b32 s64, s61, 10
    s_add_u32 s63, s63, s64
    v_lshrrev_b32 v8, 2, v1
    v_lshlrev_b32 v8, 5, v8
    v_and_b32 v9, 1, v1
    v_lshlrev_b32 v9, 4, v9
    v_add_u32 v8, v8, v9
    v_and_b32 v9, 2, v1
    v_lshlrev_b32 v9, 29, v9
    v_add_u32 v8, v8, v9
    v_add_u32 v8, s63, v8
    v_mov_b32 v2, 0
    s_mov_b32 s77, 0
    s_mov_b32 s73, 0
rl_225:
    s_add_u32 s75, s73, 1
    s_mul_i32 s70, s73, 196608
    s_lshr_b32 s71, s70, 1
    s_add_u32 s72, s70, 167772160
    s_add_u32 s74, s71, 180355072
    s_and_b32 s70, s73, 7
    s_mul_i32 s70, s70, 196608
    s_lshr_b32 s71, s70, 1
    s_add_u32 s70, s70, 79691776
    s_add_u32 s71, s71, 92274688
    s_cmp_ge_u32 s77, s75
    s_cbranch_scc1 fwd_227
    s_mov_b32 s76, 4000000
fw_226:
    buffer_load_dword v12, v11, s[44:47], 0 offen sc1
    s_sub_u32 s76, s76, 1
    s_cbranch_scc1 fwd_227
    s_waitcnt vmcnt(0)
    v_cmp_gt_u32 vcc, s75, v12
    s_cbranch_vccz fwo_228
    s_cmp_eq_u32 s76, 3999999
    s_cbranch_scc0 fwf_229
    s_sleep 16
fwf_229:
    s_sleep 3
    s_branch fw_226
fwo_228:
    s_mov_b32 s77, s75
fwd_227:
    buffer_load_dwordx4 v[16:19], v5, s[44:47], s70 offen offset:0 sc1
    buffer_load_dwordx4 v[20:23], v5, s[44:47], s70 offen offset:1024 sc1
    buffer_load_dwordx4 v[24:27], v6, s[44:47], s71 offen sc1
    s_waitcnt vmcnt(2)
    buffer_store_dwordx4 v[16:19], v8, s[44:47], s72 offen offset:0 sc1
    s_waitcnt vmcnt(2)
    buffer_store_dwordx4 v[20:23], v8, s[44:47], s72 offen offset:512 sc1
    s_waitcnt vmcnt(2)
    buffer_store_dwordx4 v[24:27], v6, s[44:47], s74 offen sc1
    v_mov_b32 v3, s75
    s_cmp_lg_u32 s6, 0
    s_cbranch_scc1 sf_230
    buffer_store_dword v3, v2, s[44:47], s67 offen
    s_branch sd_231
sf_230:
    buffer_store_dword v3, v2, s[44:47], s67 offen sc1
sd_231:
    s_waitcnt vmcnt(0)
    buffer_store_dword v3, v2, s[44:47], s8 offen sc1
    s_mov_b32 s73, s75
    s_cmp_lt_u32 s73, 63
    s_cbranch_scc1 rl_225
    s_endpgm
L_p:
    s_lshl_b32 s4, s9, 1
    s_add_u32 s4, s4, s15
    s_sub_u32 s4, s4, 3
    s_lshl_b32 s62, s4, 2
    s_lshr_b32 s63, s3, 1
    s_add_u32 s62, s62, s63
    s_and_b32 s61, s3, 1
    s_lshl_b32 s8, s4, 7
    s_lshl_b32 s63, s3, 2
    s_add_u32 s8, s8, s63
    s_add_u32 s8, s8, 156764160
    v_mov_b32 v2, 0
    buffer_store_dword v2, v2, s[44:47], s8 offen sc1
    s_waitcnt vmcnt(0)
    s_barrier
    s_cmp_eq_u32 s3, 0
    s_cbranch_scc0 arr_232
    s_getreg_b32 s12, hwreg(HW_REG_XCC_ID)
    s_and_b32 s12, s12, 15
    s_cmp_gt_u32 s12, 7
    s_cselect_b32 s13, s14, 0
    s_lshr_b32 s13, s13, 3
    s_add_u32 s12, s12, s13
    s_sub_u32 s12, s12, s14
    s_and_b32 s12, s12, 7
    s_mul_i32 s13, s12, s12
    s_lshl_b32 s12, s12, 9
    s_or_b32 s12, s12, 1
    v_mov_b32 v12, s12
    v_mov_b32 v13, s13
    v_mov_b32 v14, 1073741824
    v_cmp_eq_u32 vcc, 0, v1
    s_nop 1
    v_cndmask_b32 v14, v14, v1, vcc
    buffer_atomic_add_x2 v[12:13], v14, s[56:59], s10 offen sc1
arr_232:
    v_mov_b32 v8, 0
    s_cmp_eq_u32 s3, 0
    s_cbranch_scc0 wao_235
    s_mov_b32 s76, 1000000
wa_233:
    buffer_load_dword v9, v8, s[56:59], s10 offen offset:128 sc1
    s_sub_u32 s76, s76, 1
    s_cbranch_scc1 wad_234
    s_waitcnt vmcnt(0)
    v_readfirstlane_b32 s63, v9
    s_cmp_lg_u32 s63, 0
    s_cbranch_scc1 wad_234
    s_sleep 2
    s_branch wa_233
wad_234:
    s_waitcnt vmcnt(0)
    ds_write_b32 v8, v9
    s_waitcnt lgkmcnt(0)
wao_235:
    s_barrier
    ds_read_b32 v9, v8
    s_waitcnt lgkmcnt(0)
    v_readfirstlane_b32 s63, v9
    s_cmp_lg_u32 s63, 1
    s_cselect_b32 s6, 1, 0
    s_waitcnt vmcnt(0)
    s_barrier
    s_cbranch_scc0 wak_236
    s_cmp_eq_u32 s10, 0
    s_mov_b32 s10, 16
    s_cbranch_scc1 L_restart
wak_236:
    s_and_b32 s60, s62, 3
    s_lshl_b32 s63, s61, 2
    s_add_u32 s63, s63, s60
    s_lshl_b32 s63, s63, 3
    s_add_u32 s63, s63, s4
    s_lshl_b32 s63, s63, 7
    s_add_u32 s63, s63, 156807168
    v_mov_b32 v10, s63
    s_lshl_b32 s63, s4, 8
    s_mul_i32 s64, s60, 12
    s_add_u32 s63, s63, s64
    s_add_u32 s63, s63, 156762112
    v_mov_b32 v11, s63
    v_lshlrev_b32 v7, 6, v1
    s_mul_i32 s63, s62, 12288
    s_mul_i32 s64, s61, 25165824
    s_add_u32 s63, s63, s64
    s_add_u32 s63, s63, 4194304
    v_add_u32 v7, s63, v7
    v_mov_b32 v2, 0
    s_mov_b32 s77, 0
    s_mov_b32 s78, 0
    s_mov_b32 s73, 0
pl_237:
    s_max_u32 s75, s73, 6
    s_sub_u32 s75, s75, 6
    s_cmp_ge_u32 s78, s75
    s_cbranch_scc1 fwd_239
    s_mov_b32 s76, 4000000
fw_238:
    buffer_load_dword v12, v11, s[44:47], 0 offen sc1
    s_sub_u32 s76, s76, 1
    s_cbranch_scc1 fwd_239
    s_waitcnt vmcnt(0)
    v_cmp_gt_u32 vcc, s75, v12
    s_cbranch_vccz fwo_240
    s_cmp_eq_u32 s76, 3999999
    s_cbranch_scc0 fwf_241
    s_sleep 30
fwf_241:
    s_sleep 2
    s_branch fw_238
fwo_240:
    s_mov_b32 s78, s75
fwd_239:
    s_add_u32 s75, s73, 1
    s_cmp_ge_u32 s77, s75
    s_cbranch_scc1 fwd_243
    s_mov_b32 s76, 4000000
fw_242:
    buffer_load_dword v12, v10, s[44:47], 0 offen sc1
    s_sub_u32 s76, s76, 1
    s_cbranch_scc1 fwd_243
    s_waitcnt vmcnt(0)
    v_cmp_gt_u32 vcc, s75, v12
    s_cbranch_vccz fwo_244
    s_sleep 1
    s_branch fw_242
fwo_244:
    v_readfirstlane_b32 s77, v12
fwd_243:
    s_mul_i32 s70, s73, 393216
    buffer_load_dword v16, v7, s[44:47], s70 offen sc1
    s_add_u32 s70, s70, 4096
    buffer_load_dword v17, v7, s[44:47], s70 offen sc1
    s_add_u32 s70, s70, 4096
    buffer_load_dword v18, v7, s[44:47], s70 offen sc1
    s_add_u32 s70, s70, 4096
    v_mov_b32 v3, s75
    s_waitcnt vmcnt(0)
    s_cmp_lg_u32 s6, 0
    s_cbranch_scc1 sf_245
    buffer_store_dword v3, v2, s[44:47], s8 offen
    s_branch sd_246
sf_245:
    buffer_store_dword v3, v2, s[44:47], s8 offen sc1
sd_246:
    s_mov_b32 s73, s75
    s_cmp_lt_u32 s73, 64
    s_cbranch_scc1 pl_237
    s_endpgm
L_ph2:
    s_waitcnt lgkmcnt(0)
    s_barrier
    s_lshl_b32 s8, s15, 7
    s_add_u32 s8, s8, 156827648
    s_cmp_lt_u32 s15, 36
    s_cbranch_scc0 L_nf1
    s_mul_i32 s9, s15, 43
    s_lshr_b32 s9, s9, 9
    s_mul_i32 s60, s9, 12
    s_sub_u32 s60, s15, s60
    s_lshl_b32 s62, s60, 8
    v_lshrrev_b32 v11, 4, v1
    v_mul_u32_u24 v10, 2048, v11
    v_bfe_u32 v11, v1, 2, 2
    v_mul_u32_u24 v11, 256, v11
    v_add_u32 v10, v10, v11
    v_and_b32 v11, 3, v1
    v_mul_u32_u24 v11, 8, v11
    v_add_u32 v10, v10, v11
    s_lshl_b32 s63, s3, 5
    v_add_u32 v10, s63, v10
    s_mov_b32 s48, s32
    s_and_b32 s49, s33, 0xffff
    s_mov_b32 s50, 0x1e0000
    s_mov_b32 s51, 0x00020000
    v_add_u32 v3, 0, v1
    v_mul_u32_u24 v4, 4096, v3
    v_lshrrev_b32 v4, 16, v4
    v_mul_u32_u24 v2, 2816, v4
    v_lshlrev_b32 v3, 4, v3
    v_add_u32 v2, v2, v3
    s_mul_i32 s63, s3, 1024
    s_add_u32 s63, s63, 0
    s_mul_i32 s64, s3, 12288
    s_add_u32 s64, s64, s62
    s_add_u32 s64, s64, 0
    s_mov_b32 m0, s63
    s_add_u32 s63, s63, 8192
    buffer_load_dwordx4 v2, s[48:51], s64 offen lds
    s_add_u32 s64, s64, 98304
    s_mov_b32 m0, s63
    s_add_u32 s63, s63, 8192
    buffer_load_dwordx4 v2, s[48:51], s64 offen lds
    s_add_u32 s64, s64, 98304
    s_mov_b32 m0, s63
    s_add_u32 s63, s63, 8192
    buffer_load_dwordx4 v2, s[48:51], s64 offen lds
    s_add_u32 s64, s64, 98304
    s_mov_b32 m0, s63
    s_add_u32 s63, s63, 8192
    buffer_load_dwordx4 v2, s[48:51], s64 offen lds
    s_add_u32 s64, s64, 98304
    s_mov_b32 m0, s63
    s_add_u32 s63, s63, 8192
    buffer_load_dwordx4 v2, s[48:51], s64 offen lds
    s_add_u32 s64, s64, 98304
    s_mul_i32 s63, s3, 1024
    s_add_u32 s63, s63, 40960
    s_mul_i32 s64, s3, 12288
    s_add_u32 s64, s64, s62
    s_add_u32 s64, s64, 491520
    s_mov_b32 m0, s63
    s_add_u32 s63, s63, 8192
    buffer_load_dwordx4 v2, s[48:51], s64 offen lds
    s_add_u32 s64, s64, 98304
    s_mov_b32 m0, s63
    s_add_u32 s63, s63, 8192
    buffer_load_dwordx4 v2, s[48:51], s64 offen lds
    s_add_u32 s64, s64, 98304
    s_mov_b32 m0, s63
    s_add_u32 s63, s63, 8192
    buffer_load_dwordx4 v2, s[48:51], s64 offen lds
    s_add_u32 s64, s64, 98304
    s_mov_b32 m0, s63
    s_add_u32 s63, s63, 8192
    buffer_load_dwordx4 v2, s[48:51], s64 offen lds
    s_add_u32 s64, s64, 98304
    s_mov_b32 m0, s63
    s_add_u32 s63, s63, 8192
    buffer_load_dwordx4 v2, s[48:51], s64 offen lds
    s_add_u32 s64, s64, 98304
    s_mul_i32 s63, s3, 1024
    s_add_u32 s63, s63, 81920
    s_mul_i32 s64, s3, 12288
    s_add_u32 s64, s64, s62
    s_add_u32 s64, s64, 983040
    s_mov_b32 m0, s63
    s_add_u32 s63, s63, 8192
    buffer_load_dwordx4 v2, s[48:51], s64 offen lds
    s_add_u32 s64, s64, 98304
    s_mov_b32 m0, s63
    s_add_u32 s63, s63, 8192
    buffer_load_dwordx4 v2, s[48:51], s64 offen lds
    s_add_u32 s64, s64, 98304
    s_mov_b32 m0, s63
    s_add_u32 s63, s63, 8192
    buffer_load_dwordx4 v2, s[48:51], s64 offen lds
    s_add_u32 s64, s64, 98304
    s_mov_b32 m0, s63
    s_add_u32 s63, s63, 8192
    buffer_load_dwordx4 v2, s[48:51], s64 offen lds
    s_add_u32 s64, s64, 98304
    s_mov_b32 m0, s63
    s_add_u32 s63, s63, 8192
    buffer_load_dwordx4 v2, s[48:51], s64 offen lds
    s_add_u32 s64, s64, 98304
    s_mul_i32 s63, s3, 1024
    s_add_u32 s63, s63, 122880
    s_mul_i32 s64, s3, 12288
    s_add_u32 s64, s64, s62
    s_add_u32 s64, s64, 1474560
    s_mov_b32 m0, s63
    s_add_u32 s63, s63, 8192
    buffer_load_dwordx4 v2, s[48:51], s64 offen lds
    s_add_u32 s64, s64, 98304
    s_mov_b32 m0, s63
    s_add_u32 s63, s63, 8192
    buffer_load_dwordx4 v2, s[48:51], s64 offen lds
    s_add_u32 s64, s64, 98304
    s_mov_b32 m0, s63
    s_add_u32 s63, s63, 8192
    buffer_load_dwordx4 v2, s[48:51], s64 offen lds
    s_add_u32 s64, s64, 98304
    s_mov_b32 m0, s63
    s_add_u32 s63, s63, 8192
    buffer_load_dwordx4 v2, s[48:51], s64 offen lds
    s_add_u32 s64, s64, 98304
    s_mov_b32 m0, s63
    s_add_u32 s63, s63, 8192
    buffer_load_dwordx4 v2, s[48:51], s64 offen lds
    s_add_u32 s64, s64, 98304
    s_waitcnt vmcnt(15)
    s_barrier
    v_add_u32 v11, 0, v10
    ds_read_b64_tr_b16 v[96:97], v11 offset:0
    ds_read_b64_tr_b16 v[98:99], v11 offset:1024
    ds_read_b64_tr_b16 v[100:101], v11 offset:8192
    ds_read_b64_tr_b16 v[102:103], v11 offset:9216
    ds_read_b64_tr_b16 v[104:105], v11 offset:16384
    ds_read_b64_tr_b16 v[106:107], v11 offset:17408
    ds_read_b64_tr_b16 v[108:109], v11 offset:24576
    ds_read_b64_tr_b16 v[110:111], v11 offset:25600
    s_waitcnt lgkmcnt(6)
    ds_read_b64_tr_b16 v[112:113], v11 offset:32768
    ds_read_b64_tr_b16 v[114:115], v11 offset:33792
rd_247:
    s_waitcnt lgkmcnt(0)
    s_barrier
    s_waitcnt vmcnt(10)
    s_barrier
    v_add_u32 v11, 40960, v10
    ds_read_b64_tr_b16 v[116:117], v11 offset:0
    ds_read_b64_tr_b16 v[118:119], v11 offset:1024
    ds_read_b64_tr_b16 v[120:121], v11 offset:8192
    ds_read_b64_tr_b16 v[122:123], v11 offset:9216
    ds_read_b64_tr_b16 v[124:125], v11 offset:16384
    ds_read_b64_tr_b16 v[126:127], v11 offset:17408
    ds_read_b64_tr_b16 v[128:129], v11 offset:24576
    ds_read_b64_tr_b16 v[130:131], v11 offset:25600
    s_waitcnt lgkmcnt(6)
    ds_read_b64_tr_b16 v[132:133], v11 offset:32768
    ds_read_b64_tr_b16 v[134:135], v11 offset:33792
rd_248:
    s_waitcnt lgkmcnt(0)
    s_barrier
    s_waitcnt vmcnt(5)
    s_barrier
    v_add_u32 v11, 81920, v10
    ds_read_b64_tr_b16 v[136:137], v11 offset:0
    ds_read_b64_tr_b16 v[138:139], v11 offset:1024
    ds_read_b64_tr_b16 v[140:141], v11 offset:8192
    ds_read_b64_tr_b16 v[142:143], v11 offset:9216
    ds_read_b64_tr_b16 v[144:145], v11 offset:16384
    ds_read_b64_tr_b16 v[146:147], v11 offset:17408
    ds_read_b64_tr_b16 v[148:149], v11 offset:24576
    ds_read_b64_tr_b16 v[150:151], v11 offset:25600
    s_waitcnt lgkmcnt(6)
    ds_read_b64_tr_b16 v[152:153], v11 offset:32768
    ds_read_b64_tr_b16 v[154:155], v11 offset:33792
rd_249:
    s_waitcnt lgkmcnt(0)
    s_barrier
    s_waitcnt vmcnt(0)
    s_barrier
    v_add_u32 v11, 122880, v10
    ds_read_b64_tr_b16 v[156:157], v11 offset:0
    ds_read_b64_tr_b16 v[158:159], v11 offset:1024
    ds_read_b64_tr_b16 v[160:161], v11 offset:8192
    ds_read_b64_tr_b16 v[162:163], v11 offset:9216
    ds_read_b64_tr_b16 v[164:165], v11 offset:16384
    ds_read_b64_tr_b16 v[166:167], v11 offset:17408
    ds_read_b64_tr_b16 v[168:169], v11 offset:24576
    ds_read_b64_tr_b16 v[170:171], v11 offset:25600
    s_waitcnt lgkmcnt(6)
    ds_read_b64_tr_b16 v[172:173], v11 offset:32768
    ds_read_b64_tr_b16 v[174:175], v11 offset:33792
rd_250:
    s_waitcnt lgkmcnt(0)
    s_barrier
    v_lshrrev_b32 v11, 4, v1
    v_mul_u32_u24 v10, 2048, v11
    v_bfe_u32 v11, v1, 2, 2
    v_mul_u32_u24 v11, 256, v11
    v_add_u32 v10, v10, v11
    v_and_b32 v11, 3, v1
    v_mul_u32_u24 v11, 8, v11
    v_add_u32 v10, v10, v11
    s_lshl_b32 s63, s3, 5
    v_add_u32 v10, s63, v10
    s_mov_b32 s48, s34
    s_and_b32 s49, s35, 0xffff
    s_mov_b32 s50, 0x1e0000
    s_mov_b32 s51, 0x00020000
    v_add_u32 v3, 0, v1
    v_mul_u32_u24 v4, 4096, v3
    v_lshrrev_b32 v4, 16, v4
    v_mul_u32_u24 v2, 2816, v4
    v_lshlrev_b32 v3, 4, v3
    v_add_u32 v2, v2, v3
    s_mul_i32 s63, s3, 1024
    s_add_u32 s63, s63, 0
    s_mul_i32 s64, s3, 12288
    s_add_u32 s64, s64, s62
    s_add_u32 s64, s64, 0
    s_mov_b32 m0, s63
    s_add_u32 s63, s63, 8192
    buffer_load_dwordx4 v2, s[48:51], s64 offen lds
    s_add_u32 s64, s64, 98304
    s_mov_b32 m0, s63
    s_add_u32 s63, s63, 8192
    buffer_load_dwordx4 v2, s[48:51], s64 offen lds
    s_add_u32 s64, s64, 98304
    s_mov_b32 m0, s63
    s_add_u32 s63, s63, 8192
    buffer_load_dwordx4 v2, s[48:51], s64 offen lds
    s_add_u32 s64, s64, 98304
    s_mov_b32 m0, s63
    s_add_u32 s63, s63, 8192
    buffer_load_dwordx4 v2, s[48:51], s64 offen lds
    s_add_u32 s64, s64, 98304
    s_mov_b32 m0, s63
    s_add_u32 s63, s63, 8192
    buffer_load_dwordx4 v2, s[48:51], s64 offen lds
    s_add_u32 s64, s64, 98304
    s_mul_i32 s63, s3, 1024
    s_add_u32 s63, s63, 40960
    s_mul_i32 s64, s3, 12288
    s_add_u32 s64, s64, s62
    s_add_u32 s64, s64, 491520
    s_mov_b32 m0, s63
    s_add_u32 s63, s63, 8192
    buffer_load_dwordx4 v2, s[48:51], s64 offen lds
    s_add_u32 s64, s64, 98304
    s_mov_b32 m0, s63
    s_add_u32 s63, s63, 8192
    buffer_load_dwordx4 v2, s[48:51], s64 offen lds
    s_add_u32 s64, s64, 98304
    s_mov_b32 m0, s63
    s_add_u32 s63, s63, 8192
    buffer_load_dwordx4 v2, s[48:51], s64 offen lds
    s_add_u32 s64, s64, 98304
    s_mov_b32 m0, s63
    s_add_u32 s63, s63, 8192
    buffer_load_dwordx4 v2, s[48:51], s64 offen lds
    s_add_u32 s64, s64, 98304
    s_mov_b32 m0, s63
    s_add_u32 s63, s63, 8192
    buffer_load_dwordx4 v2, s[48:51], s64 offen lds
    s_add_u32 s64, s64, 98304
    s_mul_i32 s63, s3, 1024
    s_add_u32 s63, s63, 81920
    s_mul_i32 s64, s3, 12288
    s_add_u32 s64, s64, s62
    s_add_u32 s64, s64, 983040
    s_mov_b32 m0, s63
    s_add_u32 s63, s63, 8192
    buffer_load_dwordx4 v2, s[48:51], s64 offen lds
    s_add_u32 s64, s64, 98304
    s_mov_b32 m0, s63
    s_add_u32 s63, s63, 8192
    buffer_load_dwordx4 v2, s[48:51], s64 offen lds
    s_add_u32 s64, s64, 98304
    s_mov_b32 m0, s63
    s_add_u32 s63, s63, 8192
    buffer_load_dwordx4 v2, s[48:51], s64 offen lds
    s_add_u32 s64, s64, 98304
    s_mov_b32 m0, s63
    s_add_u32 s63, s63, 8192
    buffer_load_dwordx4 v2, s[48:51], s64 offen lds
    s_add_u32 s64, s64, 98304
    s_mov_b32 m0, s63
    s_add_u32 s63, s63, 8192
    buffer_load_dwordx4 v2, s[48:51], s64 offen lds
    s_add_u32 s64, s64, 98304
    s_mul_i32 s63, s3, 1024
    s_add_u32 s63, s63, 122880
    s_mul_i32 s64, s3, 12288
    s_add_u32 s64, s64, s62
    s_add_u32 s64, s64, 1474560
    s_mov_b32 m0, s63
    s_add_u32 s63, s63, 8192
    buffer_load_dwordx4 v2, s[48:51], s64 offen lds
    s_add_u32 s64, s64, 98304
    s_mov_b32 m0, s63
    s_add_u32 s63, s63, 8192
    buffer_load_dwordx4 v2, s[48:51], s64 offen lds
    s_add_u32 s64, s64, 98304
    s_mov_b32 m0, s63
    s_add_u32 s63, s63, 8192
    buffer_load_dwordx4 v2, s[48:51], s64 offen lds
    s_add_u32 s64, s64, 98304
    s_mov_b32 m0, s63
    s_add_u32 s63, s63, 8192
    buffer_load_dwordx4 v2, s[48:51], s64 offen lds
    s_add_u32 s64, s64, 98304
    s_mov_b32 m0, s63
    s_add_u32 s63, s63, 8192
    buffer_load_dwordx4 v2, s[48:51], s64 offen lds
    s_add_u32 s64, s64, 98304
    s_waitcnt vmcnt(15)
    s_barrier
    v_add_u32 v11, 0, v10
    ds_read_b64_tr_b16 v[176:177], v11 offset:0
    ds_read_b64_tr_b16 v[178:179], v11 offset:1024
    ds_read_b64_tr_b16 v[180:181], v11 offset:8192
    ds_read_b64_tr_b16 v[182:183], v11 offset:9216
    ds_read_b64_tr_b16 v[184:185], v11 offset:16384
    ds_read_b64_tr_b16 v[186:187], v11 offset:17408
    ds_read_b64_tr_b16 v[188:189], v11 offset:24576
    ds_read_b64_tr_b16 v[190:191], v11 offset:25600
    s_waitcnt lgkmcnt(6)
    ds_read_b64_tr_b16 v[192:193], v11 offset:32768
    ds_read_b64_tr_b16 v[194:195], v11 offset:33792
rd_251:
    s_waitcnt lgkmcnt(0)
    s_barrier
    s_waitcnt vmcnt(10)
    s_barrier
    v_add_u32 v11, 40960, v10
    ds_read_b64_tr_b16 v[196:197], v11 offset:0
    ds_read_b64_tr_b16 v[198:199], v11 offset:1024
    ds_read_b64_tr_b16 v[200:201], v11 offset:8192
    ds_read_b64_tr_b16 v[202:203], v11 offset:9216
    ds_read_b64_tr_b16 v[204:205], v11 offset:16384
    ds_read_b64_tr_b16 v[206:207], v11 offset:17408
    ds_read_b64_tr_b16 v[208:209], v11 offset:24576
    ds_read_b64_tr_b16 v[210:211], v11 offset:25600
    s_waitcnt lgkmcnt(6)
    ds_read_b64_tr_b16 v[212:213], v11 offset:32768
    ds_read_b64_tr_b16 v[214:215], v11 offset:33792
rd_252:
    s_waitcnt lgkmcnt(0)
    s_barrier
    s_waitcnt vmcnt(5)
    s_barrier
    v_add_u32 v11, 81920, v10
    ds_read_b64_tr_b16 v[216:217], v11 offset:0
    ds_read_b64_tr_b16 v[218:219], v11 offset:1024
    ds_read_b64_tr_b16 v[220:221], v11 offset:8192
    ds_read_b64_tr_b16 v[222:223], v11 offset:9216
    ds_read_b64_tr_b16 v[224:225], v11 offset:16384
    ds_read_b64_tr_b16 v[226:227], v11 offset:17408
    ds_read_b64_tr_b16 v[228:229], v11 offset:24576
    ds_read_b64_tr_b16 v[230:231], v11 offset:25600
    s_waitcnt lgkmcnt(6)
    ds_read_b64_tr_b16 v[232:233], v11 offset:32768
    ds_read_b64_tr_b16 v[234:235], v11 offset:33792
rd_253:
    s_waitcnt lgkmcnt(0)
    s_barrier
    s_waitcnt vmcnt(0)
    s_barrier
    v_add_u32 v11, 122880, v10
    ds_read_b64_tr_b16 v[236:237], v11 offset:0
    ds_read_b64_tr_b16 v[238:239], v11 offset:1024
    ds_read_b64_tr_b16 v[240:241], v11 offset:8192
    ds_read_b64_tr_b16 v[242:243], v11 offset:9216
    ds_read_b64_tr_b16 v[244:245], v11 offset:16384
    ds_read_b64_tr_b16 v[246:247], v11 offset:17408
    ds_read_b64_tr_b16 v[248:249], v11 offset:24576
    ds_read_b64_tr_b16 v[250:251], v11 offset:25600
    s_waitcnt lgkmcnt(6)
    ds_read_b64_tr_b16 v[252:253], v11 offset:32768
    ds_read_b64_tr_b16 v[254:255], v11 offset:33792
rd_254:
    s_waitcnt lgkmcnt(0)
    s_barrier
    v_lshlrev_b32 v7, 4, v1
    s_lshl_b32 s63, s60, 3
    s_add_u32 s63, s63, s3
    s_lshl_b32 s63, s63, 9
    s_add_u32 s63, s63, 98566144
    v_lshrrev_b32 v9, 5, v1
    v_lshlrev_b32 v9, 8, v9
    v_and_b32 v10, 15, v1
    v_lshlrev_b32 v10, 4, v10
    v_add_u32 v9, v9, v10
    v_bfe_u32 v10, v1, 4, 1
    v_lshlrev_b32 v10, 3, v10
    v_add_u32 v9, v9, v10
    v_add_u32 v9, s63, v9
    v_add_u32 v10, 49152, v9
    v_lshlrev_b32 v7, 4, v1
    s_mov_b32 s73, s9
    s_add_u32 s70, s73, 42
    s_mul_i32 s70, s70, 40960
    s_mov_b32 s71, 0
    s_lshl_b32 s63, s3, 10
    s_add_u32 s64, s63, s70
    s_add_u32 s63, s63, s71
    s_mov_b32 m0, s63
    s_add_u32 s63, s63, 8192
    buffer_load_dwordx4 v7, s[44:47], s64 offen sc1 lds
    s_add_u32 s64, s64, 8192
    s_mov_b32 m0, s63
    s_add_u32 s63, s63, 8192
    buffer_load_dwordx4 v7, s[44:47], s64 offen sc1 lds
    s_add_u32 s64, s64, 8192
    s_mov_b32 m0, s63
    s_add_u32 s63, s63, 8192
    buffer_load_dwordx4 v7, s[44:47], s64 offen sc1 lds
    s_add_u32 s64, s64, 8192
    s_mov_b32 m0, s63
    s_add_u32 s63, s63, 8192
    buffer_load_dwordx4 v7, s[44:47], s64 offen sc1 lds
    s_add_u32 s64, s64, 8192
    s_mov_b32 m0, s63
    s_add_u32 s63, s63, 8192
    buffer_load_dwordx4 v7, s[44:47], s64 offen sc1 lds
    s_add_u32 s64, s64, 8192
    s_add_u32 s70, s70, 122880
    s_mov_b32 s71, 40960
    s_lshl_b32 s63, s3, 10
    s_add_u32 s64, s63, s70
    s_add_u32 s63, s63, s71
    s_mov_b32 m0, s63
    s_add_u32 s63, s63, 8192
    buffer_load_dwordx4 v7, s[44:47], s64 offen sc1 lds
    s_add_u32 s64, s64, 8192
    s_mov_b32 m0, s63
    s_add_u32 s63, s63, 8192
    buffer_load_dwordx4 v7, s[44:47], s64 offen sc1 lds
    s_add_u32 s64, s64, 8192
    s_mov_b32 m0, s63
    s_add_u32 s63, s63, 8192
    buffer_load_dwordx4 v7, s[44:47], s64 offen sc1 lds
    s_add_u32 s64, s64, 8192
    s_mov_b32 m0, s63
    s_add_u32 s63, s63, 8192
    buffer_load_dwordx4 v7, s[44:47], s64 offen sc1 lds
    s_add_u32 s64, s64, 8192
    s_mov_b32 m0, s63
    s_add_u32 s63, s63, 8192
    buffer_load_dwordx4 v7, s[44:47], s64 offen sc1 lds
    s_add_u32 s64, s64, 8192
    s_mov_b32 s79, 0
    s_mov_b32 s80, 81920
    s_setprio 0
    s_waitcnt vmcnt(5)
    s_mov_b32 s78, s73
    s_branch xb_257
xst_256:
    s_waitcnt vmcnt(0)
    s_mov_b32 s78, s73
    .p2align 6
xb_257:
    s_barrier
    s_cmp_eq_u32 s3, 0
    s_cbranch_scc0 fs_258
    v_mov_b32 v2, 0
    v_mov_b32 v3, s78
    buffer_store_dword v3, v2, s[44:47], s8 offen sc1
fs_258:
    s_cmp_ge_u32 s73, 64
    s_cbranch_scc1 L_ph3
    s_add_u32 s72, s73, 6
    s_min_u32 s72, s72, 63
    s_add_u32 s72, s72, 42
    s_and_b32 s72, s72, 63
    s_mul_i32 s70, s72, 40960
    s_lshl_b32 s63, s3, 10
    s_add_u32 s70, s70, s63
    v_add_u32 v8, s79, v7
    s_add_u32 s71, s80, s63
    s_mov_b32 s80, s79
    s_add_u32 s79, s79, 40960
    s_cmp_eq_u32 s79, 122880
    s_cselect_b32 s79, 0, s79
    s_add_u32 s74, s73, 42
    s_and_b32 s74, s74, 63
    s_mul_i32 s74, s74, 98304
    ds_read_b128 v[16:19], v8 offset:0
    ds_read_b128 v[20:23], v8 offset:1024
    ds_read_b128 v[24:27], v8 offset:2048
    ds_read_b128 v[28:31], v8 offset:3072
    ds_read_b128 v[32:35], v8 offset:4096
    ds_read_b128 v[36:39], v8 offset:5120
    ds_read_b128 v[40:43], v8 offset:6144
    ds_read_b128 v[44:47], v8 offset:7168
    s_waitcnt lgkmcnt(7)
    v_mfma_f32_16x16x32_bf16 v[48:51], v[96:99], v[16:19], 0
    v_mfma_f32_16x16x32_bf16 v[52:55], v[176:179], v[16:19], 0
    ds_read_b128 v[16:19], v8 offset:8192
    s_waitcnt lgkmcnt(7)
    v_mfma_f32_16x16x32_bf16 v[48:51], v[100:103], v[20:23], v[48:51]
    v_mfma_f32_16x16x32_bf16 v[52:55], v[180:183], v[20:23], v[52:55]
    ds_read_b128 v[20:23], v8 offset:9216
    s_mov_b32 m0, s71
    s_add_u32 s71, s71, 8192
    buffer_load_dwordx4 v7, s[44:47], s70 offen sc1 lds
    s_add_u32 s70, s70, 8192
    s_waitcnt lgkmcnt(7)
    v_mfma_f32_16x16x32_bf16 v[48:51], v[104:107], v[24:27], v[48:51]
    v_mfma_f32_16x16x32_bf16 v[52:55], v[184:187], v[24:27], v[52:55]
    ds_read_b128 v[24:27], v8 offset:10240
    s_waitcnt lgkmcnt(7)
    v_mfma_f32_16x16x32_bf16 v[48:51], v[108:111], v[28:31], v[48:51]
    v_mfma_f32_16x16x32_bf16 v[52:55], v[188:191], v[28:31], v[52:55]
    ds_read_b128 v[28:31], v8 offset:11264
    s_waitcnt lgkmcnt(7)
    v_mfma_f32_16x16x32_bf16 v[48:51], v[112:115], v[32:35], v[48:51]
    v_mfma_f32_16x16x32_bf16 v[52:55], v[192:195], v[32:35], v[52:55]
    ds_read_b128 v[32:35], v8 offset:12288
    s_waitcnt lgkmcnt(7)
    v_mfma_f32_16x16x32_bf16 v[48:51], v[116:119], v[36:39], v[48:51]
    v_mfma_f32_16x16x32_bf16 v[52:55], v[196:199], v[36:39], v[52:55]
    ds_read_b128 v[36:39], v8 offset:13312
    s_waitcnt lgkmcnt(7)
    v_mfma_f32_16x16x32_bf16 v[48:51], v[120:123], v[40:43], v[48:51]
    v_mfma_f32_16x16x32_bf16 v[52:55], v[200:203], v[40:43], v[52:55]
    ds_read_b128 v[40:43], v8 offset:14336
    s_waitcnt lgkmcnt(7)
    v_mfma_f32_16x16x32_bf16 v[48:51], v[124:127], v[44:47], v[48:51]
    v_mfma_f32_16x16x32_bf16 v[52:55], v[204:207], v[44:47], v[52:55]
    ds_read_b128 v[44:47], v8 offset:15360
    s_mov_b32 m0, s71
    s_add_u32 s71, s71, 8192
    buffer_load_dwordx4 v7, s[44:47], s70 offen sc1 lds
    s_add_u32 s70, s70, 8192
    s_waitcnt lgkmcnt(7)
    v_mfma_f32_16x16x32_bf16 v[48:51], v[128:131], v[16:19], v[48:51]
    v_mfma_f32_16x16x32_bf16 v[52:55], v[208:211], v[16:19], v[52:55]
    ds_read_b128 v[16:19], v8 offset:16384
    s_waitcnt lgkmcnt(7)
    v_mfma_f32_16x16x32_bf16 v[48:51], v[132:135], v[20:23], v[48:51]
    v_mfma_f32_16x16x32_bf16 v[52:55], v[212:215], v[20:23], v[52:55]
    ds_read_b128 v[20:23], v8 offset:17408
    s_waitcnt lgkmcnt(7)
    v_mfma_f32_16x16x32_bf16 v[48:51], v[136:139], v[24:27], v[48:51]
    v_mfma_f32_16x16x32_bf16 v[52:55], v[216:219], v[24:27], v[52:55]
    ds_read_b128 v[24:27], v8 offset:18432
    s_waitcnt lgkmcnt(7)
    v_mfma_f32_16x16x32_bf16 v[48:51], v[140:143], v[28:31], v[48:51]
    v_mfma_f32_16x16x32_bf16 v[52:55], v[220:223], v[28:31], v[52:55]
    ds_read_b128 v[28:31], v8 offset:19456
    s_waitcnt lgkmcnt(7)
    v_mfma_f32_16x16x32_bf16 v[48:51], v[144:147], v[32:35], v[48:51]
    v_mfma_f32_16x16x32_bf16 v[52:55], v[224:227], v[32:35], v[52:55]
    ds_read_b128 v[32:35], v8 offset:20480
    s_waitcnt lgkmcnt(7)
    v_mfma_f32_16x16x32_bf16 v[48:51], v[148:151], v[36:39], v[48:51]
    v_mfma_f32_16x16x32_bf16 v[52:55], v[228:231], v[36:39], v[52:55]
    ds_read_b128 v[36:39], v8 offset:21504
    s_mov_b32 m0, s71
    s_add_u32 s71, s71, 8192
    buffer_load_dwordx4 v7, s[44:47], s70 offen sc1 lds
    s_add_u32 s70, s70, 8192
    s_waitcnt lgkmcnt(7)
    v_mfma_f32_16x16x32_bf16 v[48:51], v[152:155], v[40:43], v[48:51]
    v_mfma_f32_16x16x32_bf16 v[52:55], v[232:235], v[40:43], v[52:55]
    ds_read_b128 v[40:43], v8 offset:22528
    s_waitcnt lgkmcnt(7)
    v_mfma_f32_16x16x32_bf16 v[48:51], v[156:159], v[44:47], v[48:51]
    v_mfma_f32_16x16x32_bf16 v[52:55], v[236:239], v[44:47], v[52:55]
    ds_read_b128 v[44:47], v8 offset:23552
    s_waitcnt lgkmcnt(7)
    v_mfma_f32_16x16x32_bf16 v[48:51], v[160:163], v[16:19], v[48:51]
    v_mfma_f32_16x16x32_bf16 v[52:55], v[240:243], v[16:19], v[52:55]
    ds_read_b128 v[16:19], v8 offset:24576
    s_waitcnt lgkmcnt(7)
    v_mfma_f32_16x16x32_bf16 v[48:51], v[164:167], v[20:23], v[48:51]
    v_mfma_f32_16x16x32_bf16 v[52:55], v[244:247], v[20:23], v[52:55]
    ds_read_b128 v[20:23], v8 offset:25600
    s_waitcnt lgkmcnt(7)
    v_mfma_f32_16x16x32_bf16 v[48:51], v[168:171], v[24:27], v[48:51]
    v_mfma_f32_16x16x32_bf16 v[52:55], v[248:251], v[24:27], v[52:55]
    ds_read_b128 v[24:27], v8 offset:26624
    s_waitcnt lgkmcnt(7)
    v_mfma_f32_16x16x32_bf16 v[48:51], v[172:175], v[28:31], v[48:51]
    v_mfma_f32_16x16x32_bf16 v[52:55], v[252:255], v[28:31], v[52:55]
    ds_read_b128 v[28:31], v8 offset:27648
    s_mov_b32 m0, s71
    s_add_u32 s71, s71, 8192
    buffer_load_dwordx4 v7, s[44:47], s70 offen sc1 lds
    s_add_u32 s70, s70, 8192
    s_waitcnt lgkmcnt(7)
    v_mfma_f32_16x16x32_bf16 v[56:59], v[96:99], v[32:35], 0
    v_mfma_f32_16x16x32_bf16 v[60:63], v[176:179], v[32:35], 0
    ds_read_b128 v[32:35], v8 offset:28672
    s_waitcnt lgkmcnt(7)
    v_mfma_f32_16x16x32_bf16 v[56:59], v[100:103], v[36:39], v[56:59]
    v_mfma_f32_16x16x32_bf16 v[60:63], v[180:183], v[36:39], v[60:63]
    ds_read_b128 v[36:39], v8 offset:29696
    s_waitcnt lgkmcnt(7)
    v_mfma_f32_16x16x32_bf16 v[56:59], v[104:107], v[40:43], v[56:59]
    v_mfma_f32_16x16x32_bf16 v[60:63], v[184:187], v[40:43], v[60:63]
    ds_read_b128 v[40:43], v8 offset:30720
    s_waitcnt lgkmcnt(7)
    v_mfma_f32_16x16x32_bf16 v[56:59], v[108:111], v[44:47], v[56:59]
    v_mfma_f32_16x16x32_bf16 v[60:63], v[188:191], v[44:47], v[60:63]
    ds_read_b128 v[44:47], v8 offset:31744
    s_waitcnt lgkmcnt(7)
    v_mfma_f32_16x16x32_bf16 v[56:59], v[112:115], v[16:19], v[56:59]
    v_mfma_f32_16x16x32_bf16 v[60:63], v[192:195], v[16:19], v[60:63]
    ds_read_b128 v[16:19], v8 offset:32768
    s_waitcnt lgkmcnt(7)
    v_mfma_f32_16x16x32_bf16 v[56:59], v[116:119], v[20:23], v[56:59]
    v_mfma_f32_16x16x32_bf16 v[60:63], v[196:199], v[20:23], v[60:63]
    ds_read_b128 v[20:23], v8 offset:33792
    s_mov_b32 m0, s71
    s_add_u32 s71, s71, 8192
    buffer_load_dwordx4 v7, s[44:47], s70 offen sc1 lds
    s_add_u32 s70, s70, 8192
    s_waitcnt lgkmcnt(7)
    v_mfma_f32_16x16x32_bf16 v[56:59], v[120:123], v[24:27], v[56:59]
    v_mfma_f32_16x16x32_bf16 v[60:63], v[200:203], v[24:27], v[60:63]
    ds_read_b128 v[24:27], v8 offset:34816
    s_waitcnt lgkmcnt(7)
    v_mfma_f32_16x16x32_bf16 v[56:59], v[124:127], v[28:31], v[56:59]
    v_mfma_f32_16x16x32_bf16 v[60:63], v[204:207], v[28:31], v[60:63]
    ds_read_b128 v[28:31], v8 offset:35840
    s_waitcnt lgkmcnt(7)
    v_mfma_f32_16x16x32_bf16 v[56:59], v[128:131], v[32:35], v[56:59]
    v_mfma_f32_16x16x32_bf16 v[60:63], v[208:211], v[32:35], v[60:63]
    ds_read_b128 v[32:35], v8 offset:36864
    s_waitcnt lgkmcnt(7)
    v_mfma_f32_16x16x32_bf16 v[56:59], v[132:135], v[36:39], v[56:59]
    v_mfma_f32_16x16x32_bf16 v[60:63], v[212:215], v[36:39], v[60:63]
    ds_read_b128 v[36:39], v8 offset:37888
    s_waitcnt lgkmcnt(7)
    v_mfma_f32_16x16x32_bf16 v[56:59], v[136:139], v[40:43], v[56:59]
    v_mfma_f32_16x16x32_bf16 v[60:63], v[216:219], v[40:43], v[60:63]
    ds_read_b128 v[40:43], v8 offset:38912
    s_waitcnt lgkmcnt(7)
    v_mfma_f32_16x16x32_bf16 v[56:59], v[140:143], v[44:47], v[56:59]
    v_mfma_f32_16x16x32_bf16 v[60:63], v[220:223], v[44:47], v[60:63]
    ds_read_b128 v[44:47], v8 offset:39936
    s_waitcnt lgkmcnt(7)
    v_mfma_f32_16x16x32_bf16 v[56:59], v[144:147], v[16:19], v[56:59]
    v_mfma_f32_16x16x32_bf16 v[60:63], v[224:227], v[16:19], v[60:63]
    s_waitcnt lgkmcnt(6)
    v_mfma_f32_16x16x32_bf16 v[56:59], v[148:151], v[20:23], v[56:59]
    v_mfma_f32_16x16x32_bf16 v[60:63], v[228:231], v[20:23], v[60:63]
    s_waitcnt lgkmcnt(5)
    v_mfma_f32_16x16x32_bf16 v[56:59], v[152:155], v[24:27], v[56:59]
    v_mfma_f32_16x16x32_bf16 v[60:63], v[232:235], v[24:27], v[60:63]
    s_waitcnt lgkmcnt(4)
    v_mfma_f32_16x16x32_bf16 v[56:59], v[156:159], v[28:31], v[56:59]
    v_mfma_f32_16x16x32_bf16 v[60:63], v[236:239], v[28:31], v[60:63]
    s_waitcnt lgkmcnt(3)
    v_mfma_f32_16x16x32_bf16 v[56:59], v[160:163], v[32:35], v[56:59]
    v_mfma_f32_16x16x32_bf16 v[60:63], v[240:243], v[32:35], v[60:63]
    s_waitcnt lgkmcnt(2)
    v_mfma_f32_16x16x32_bf16 v[56:59], v[164:167], v[36:39], v[56:59]
    v_mfma_f32_16x16x32_bf16 v[60:63], v[244:247], v[36:39], v[60:63]
    s_waitcnt lgkmcnt(1)
    v_mfma_f32_16x16x32_bf16 v[56:59], v[168:171], v[40:43], v[56:59]
    v_mfma_f32_16x16x32_bf16 v[60:63], v[248:251], v[40:43], v[60:63]
    s_waitcnt lgkmcnt(0)
    v_mfma_f32_16x16x32_bf16 v[56:59], v[172:175], v[44:47], v[56:59]
    v_mfma_f32_16x16x32_bf16 v[60:63], v[252:255], v[44:47], v[60:63]
    s_nop 7
    v_cvt_pk_bf16_f32 v48, v48, v48
    v_and_b32 v48, 0xffff0000, v48
    v_cvt_pk_bf16_f32 v49, v49, v49
    v_and_b32 v49, 0xffff0000, v49
    v_cvt_pk_bf16_f32 v50, v50, v50
    v_and_b32 v50, 0xffff0000, v50
    v_cvt_pk_bf16_f32 v51, v51, v51
    v_and_b32 v51, 0xffff0000, v51
    v_cvt_pk_bf16_f32 v52, v52, v52
    v_and_b32 v52, 0xffff0000, v52
    v_cvt_pk_bf16_f32 v53, v53, v53
    v_and_b32 v53, 0xffff0000, v53
    v_cvt_pk_bf16_f32 v54, v54, v54
    v_and_b32 v54, 0xffff0000, v54
    v_cvt_pk_bf16_f32 v55, v55, v55
    v_and_b32 v55, 0xffff0000, v55
    v_cvt_pk_bf16_f32 v56, v56, v56
    v_and_b32 v56, 0xffff0000, v56
    v_cvt_pk_bf16_f32 v57, v57, v57
    v_and_b32 v57, 0xffff0000, v57
    v_cvt_pk_bf16_f32 v58, v58, v58
    v_and_b32 v58, 0xffff0000, v58
    v_cvt_pk_bf16_f32 v59, v59, v59
    v_and_b32 v59, 0xffff0000, v59
    v_cvt_pk_bf16_f32 v60, v60, v60
    v_and_b32 v60, 0xffff0000, v60
    v_cvt_pk_bf16_f32 v61, v61, v61
    v_and_b32 v61, 0xffff0000, v61
    v_cvt_pk_bf16_f32 v62, v62, v62
    v_and_b32 v62, 0xffff0000, v62
    v_cvt_pk_bf16_f32 v63, v63, v63
    v_and_b32 v63, 0xffff0000, v63
    v_mul_f32 v48, v48, v52
    v_mul_f32 v49, v49, v53
    v_mul_f32 v50, v50, v54
    v_mul_f32 v51, v51, v55
    v_mul_f32 v56, v56, v60
    v_mul_f32 v57, v57, v61
    v_mul_f32 v58, v58, v62
    v_mul_f32 v59, v59, v63
    v_cvt_pk_bf16_f32 v64, v48, v49
    v_cvt_pk_bf16_f32 v65, v50, v51
    v_cvt_pk_bf16_f32 v66, v56, v57
    v_cvt_pk_bf16_f32 v67, v58, v59
    buffer_store_dwordx2 v[64:65], v9, s[44:47], s74 offen sc1
    buffer_store_dwordx2 v[66:67], v10, s[44:47], s74 offen sc1
    s_mov_b32 s78, s73
    s_add_u32 s73, s73, 3
    s_cmp_ge_u32 s73, 64
    s_cbranch_scc1 xst_256
    s_cmp_lt_u32 s73, 6
    s_cbranch_scc1 xst_256
    s_waitcnt vmcnt(7)
    s_branch xb_257
L_nf1:
    s_cmp_lt_u32 s15, 61
    s_cbranch_scc0 L_ph3
    s_sub_u32 s63, s15, 36
    s_mul_i32 s9, s63, 52
    s_lshr_b32 s9, s9, 8
    s_mul_i32 s61, s9, 5
    s_sub_u32 s61, s63, s61
    s_lshl_b32 s62, s61, 8
    v_lshrrev_b32 v11, 4, v1
    v_mul_u32_u24 v10, 2048, v11
    v_bfe_u32 v11, v1, 2, 2
    v_mul_u32_u24 v11, 256, v11
    v_add_u32 v10, v10, v11
    v_and_b32 v11, 3, v1
    v_mul_u32_u24 v11, 8, v11
    v_add_u32 v10, v10, v11
    s_lshl_b32 s63, s3, 5
    v_add_u32 v10, s63, v10
    s_mov_b32 s48, s36
    s_and_b32 s49, s37, 0xffff
    s_mov_b32 s50, 0x1e0000
    s_mov_b32 s51, 0x00020000
    v_add_u32 v3, 0, v1
    v_mul_u32_u24 v4, 4096, v3
    v_lshrrev_b32 v4, 16, v4
    v_mul_u32_u24 v2, 1024, v4
    v_lshlrev_b32 v3, 4, v3
    v_add_u32 v2, v2, v3
    s_mul_i32 s63, s3, 1024
    s_add_u32 s63, s63, 0
    s_mul_i32 s64, s3, 5120
    s_add_u32 s64, s64, s62
    s_add_u32 s64, s64, 0
    s_mov_b32 m0, s63
    s_add_u32 s63, s63, 8192
    buffer_load_dwordx4 v2, s[48:51], s64 offen lds
    s_add_u32 s64, s64, 40960
    s_mov_b32 m0, s63
    s_add_u32 s63, s63, 8192
    buffer_load_dwordx4 v2, s[48:51], s64 offen lds
    s_add_u32 s64, s64, 40960
    s_mov_b32 m0, s63
    s_add_u32 s63, s63, 8192
    buffer_load_dwordx4 v2, s[48:51], s64 offen lds
    s_add_u32 s64, s64, 40960
    s_mov_b32 m0, s63
    s_add_u32 s63, s63, 8192
    buffer_load_dwordx4 v2, s[48:51], s64 offen lds
    s_add_u32 s64, s64, 40960
    s_mov_b32 m0, s63
    s_add_u32 s63, s63, 8192
    buffer_load_dwordx4 v2, s[48:51], s64 offen lds
    s_add_u32 s64, s64, 40960
    s_mov_b32 m0, s63
    s_add_u32 s63, s63, 8192
    buffer_load_dwordx4 v2, s[48:51], s64 offen lds
    s_add_u32 s64, s64, 40960
    s_mul_i32 s63, s3, 1024
    s_add_u32 s63, s63, 49152
    s_mul_i32 s64, s3, 5120
    s_add_u32 s64, s64, s62
    s_add_u32 s64, s64, 245760
    s_mov_b32 m0, s63
    s_add_u32 s63, s63, 8192
    buffer_load_dwordx4 v2, s[48:51], s64 offen lds
    s_add_u32 s64, s64, 40960
    s_mov_b32 m0, s63
    s_add_u32 s63, s63, 8192
    buffer_load_dwordx4 v2, s[48:51], s64 offen lds
    s_add_u32 s64, s64, 40960
    s_mov_b32 m0, s63
    s_add_u32 s63, s63, 8192
    buffer_load_dwordx4 v2, s[48:51], s64 offen lds
    s_add_u32 s64, s64, 40960
    s_mov_b32 m0, s63
    s_add_u32 s63, s63, 8192
    buffer_load_dwordx4 v2, s[48:51], s64 offen lds
    s_add_u32 s64, s64, 40960
    s_mov_b32 m0, s63
    s_add_u32 s63, s63, 8192
    buffer_load_dwordx4 v2, s[48:51], s64 offen lds
    s_add_u32 s64, s64, 40960
    s_mov_b32 m0, s63
    s_add_u32 s63, s63, 8192
    buffer_load_dwordx4 v2, s[48:51], s64 offen lds
    s_add_u32 s64, s64, 40960
    s_mul_i32 s63, s3, 1024
    s_add_u32 s63, s63, 98304
    s_mul_i32 s64, s3, 5120
    s_add_u32 s64, s64, s62
    s_add_u32 s64, s64, 491520
    s_mov_b32 m0, s63
    s_add_u32 s63, s63, 8192
    buffer_load_dwordx4 v2, s[48:51], s64 offen lds
    s_add_u32 s64, s64, 40960
    s_mov_b32 m0, s63
    s_add_u32 s63, s63, 8192
    buffer_load_dwordx4 v2, s[48:51], s64 offen lds
    s_add_u32 s64, s64, 40960
    s_mov_b32 m0, s63
    s_add_u32 s63, s63, 8192
    buffer_load_dwordx4 v2, s[48:51], s64 offen lds
    s_add_u32 s64, s64, 40960
    s_mov_b32 m0, s63
    s_add_u32 s63, s63, 8192
    buffer_load_dwordx4 v2, s[48:51], s64 offen lds
    s_add_u32 s64, s64, 40960
    s_mov_b32 m0, s63
    s_add_u32 s63, s63, 8192
    buffer_load_dwordx4 v2, s[48:51], s64 offen lds
    s_add_u32 s64, s64, 40960
    s_mov_b32 m0, s63
    s_add_u32 s63, s63, 8192
    buffer_load_dwordx4 v2, s[48:51], s64 offen lds
    s_add_u32 s64, s64, 40960
    s_waitcnt vmcnt(12)
    s_barrier
    v_add_u32 v11, 0, v10
    ds_read_b64_tr_b16 v[64:65], v11 offset:0
    ds_read_b64_tr_b16 v[66:67], v11 offset:1024
    ds_read_b64_tr_b16 v[68:69], v11 offset:8192
    ds_read_b64_tr_b16 v[70:71], v11 offset:9216
    ds_read_b64_tr_b16 v[72:73], v11 offset:16384
    ds_read_b64_tr_b16 v[74:75], v11 offset:17408
    ds_read_b64_tr_b16 v[76:77], v11 offset:24576
    ds_read_b64_tr_b16 v[78:79], v11 offset:25600
    s_waitcnt lgkmcnt(6)
    ds_read_b64_tr_b16 v[80:81], v11 offset:32768
    ds_read_b64_tr_b16 v[82:83], v11 offset:33792
    ds_read_b64_tr_b16 v[84:85], v11 offset:40960
    ds_read_b64_tr_b16 v[86:87], v11 offset:41984
rd_259:
    s_waitcnt lgkmcnt(0)
    s_barrier
    s_mul_i32 s63, s3, 1024
    s_add_u32 s63, s63, 0
    s_mul_i32 s64, s3, 5120
    s_add_u32 s64, s64, s62
    s_add_u32 s64, s64, 737280
    s_mov_b32 m0, s63
    s_add_u32 s63, s63, 8192
    buffer_load_dwordx4 v2, s[48:51], s64 offen lds
    s_add_u32 s64, s64, 40960
    s_mov_b32 m0, s63
    s_add_u32 s63, s63, 8192
    buffer_load_dwordx4 v2, s[48:51], s64 offen lds
    s_add_u32 s64, s64, 40960
    s_mov_b32 m0, s63
    s_add_u32 s63, s63, 8192
    buffer_load_dwordx4 v2, s[48:51], s64 offen lds
    s_add_u32 s64, s64, 40960
    s_mov_b32 m0, s63
    s_add_u32 s63, s63, 8192
    buffer_load_dwordx4 v2, s[48:51], s64 offen lds
    s_add_u32 s64, s64, 40960
    s_mov_b32 m0, s63
    s_add_u32 s63, s63, 8192
    buffer_load_dwordx4 v2, s[48:51], s64 offen lds
    s_add_u32 s64, s64, 40960
    s_mov_b32 m0, s63
    s_add_u32 s63, s63, 8192
    buffer_load_dwordx4 v2, s[48:51], s64 offen lds
    s_add_u32 s64, s64, 40960
    s_waitcnt vmcnt(12)
    s_barrier
    v_add_u32 v11, 49152, v10
    ds_read_b64_tr_b16 v[88:89], v11 offset:0
    ds_read_b64_tr_b16 v[90:91], v11 offset:1024
    ds_read_b64_tr_b16 v[92:93], v11 offset:8192
    ds_read_b64_tr_b16 v[94:95], v11 offset:9216
    ds_read_b64_tr_b16 v[96:97], v11 offset:16384
    ds_read_b64_tr_b16 v[98:99], v11 offset:17408
    ds_read_b64_tr_b16 v[100:101], v11 offset:24576
    ds_read_b64_tr_b16 v[102:103], v11 offset:25600
    s_waitcnt lgkmcnt(6)
    ds_read_b64_tr_b16 v[104:105], v11 offset:32768
    ds_read_b64_tr_b16 v[106:107], v11 offset:33792
    ds_read_b64_tr_b16 v[108:109], v11 offset:40960
    ds_read_b64_tr_b16 v[110:111], v11 offset:41984
rd_260:
    s_waitcnt lgkmcnt(0)
    s_barrier
    s_mul_i32 s63, s3, 1024
    s_add_u32 s63, s63, 49152
    s_mul_i32 s64, s3, 5120
    s_add_u32 s64, s64, s62
    s_add_u32 s64, s64, 983040
    s_mov_b32 m0, s63
    s_add_u32 s63, s63, 8192
    buffer_load_dwordx4 v2, s[48:51], s64 offen lds
    s_add_u32 s64, s64, 40960
    s_mov_b32 m0, s63
    s_add_u32 s63, s63, 8192
    buffer_load_dwordx4 v2, s[48:51], s64 offen lds
    s_add_u32 s64, s64, 40960
    s_mov_b32 m0, s63
    s_add_u32 s63, s63, 8192
    buffer_load_dwordx4 v2, s[48:51], s64 offen lds
    s_add_u32 s64, s64, 40960
    s_mov_b32 m0, s63
    s_add_u32 s63, s63, 8192
    buffer_load_dwordx4 v2, s[48:51], s64 offen lds
    s_add_u32 s64, s64, 40960
    s_mov_b32 m0, s63
    s_add_u32 s63, s63, 8192
    buffer_load_dwordx4 v2, s[48:51], s64 offen lds
    s_add_u32 s64, s64, 40960
    s_mov_b32 m0, s63
    s_add_u32 s63, s63, 8192
    buffer_load_dwordx4 v2, s[48:51], s64 offen lds
    s_add_u32 s64, s64, 40960
    s_waitcnt vmcnt(12)
    s_barrier
    v_add_u32 v11, 98304, v10
    ds_read_b64_tr_b16 v[112:113], v11 offset:0
    ds_read_b64_tr_b16 v[114:115], v11 offset:1024
    ds_read_b64_tr_b16 v[116:117], v11 offset:8192
    ds_read_b64_tr_b16 v[118:119], v11 offset:9216
    ds_read_b64_tr_b16 v[120:121], v11 offset:16384
    ds_read_b64_tr_b16 v[122:123], v11 offset:17408
    ds_read_b64_tr_b16 v[124:125], v11 offset:24576
    ds_read_b64_tr_b16 v[126:127], v11 offset:25600
    s_waitcnt lgkmcnt(6)
    ds_read_b64_tr_b16 v[128:129], v11 offset:32768
    ds_read_b64_tr_b16 v[130:131], v11 offset:33792
    ds_read_b64_tr_b16 v[132:133], v11 offset:40960
    ds_read_b64_tr_b16 v[134:135], v11 offset:41984
rd_261:
    s_waitcnt lgkmcnt(0)
    s_barrier
    s_mul_i32 s63, s3, 1024
    s_add_u32 s63, s63, 98304
    s_mul_i32 s64, s3, 5120
    s_add_u32 s64, s64, s62
    s_add_u32 s64, s64, 1228800
    s_mov_b32 m0, s63
    s_add_u32 s63, s63, 8192
    buffer_load_dwordx4 v2, s[48:51], s64 offen lds
    s_add_u32 s64, s64, 40960
    s_mov_b32 m0, s63
    s_add_u32 s63, s63, 8192
    buffer_load_dwordx4 v2, s[48:51], s64 offen lds
    s_add_u32 s64, s64, 40960
    s_mov_b32 m0, s63
    s_add_u32 s63, s63, 8192
    buffer_load_dwordx4 v2, s[48:51], s64 offen lds
    s_add_u32 s64, s64, 40960
    s_mov_b32 m0, s63
    s_add_u32 s63, s63, 8192
    buffer_load_dwordx4 v2, s[48:51], s64 offen lds
    s_add_u32 s64, s64, 40960
    s_mov_b32 m0, s63
    s_add_u32 s63, s63, 8192
    buffer_load_dwordx4 v2, s[48:51], s64 offen lds
    s_add_u32 s64, s64, 40960
    s_mov_b32 m0, s63
    s_add_u32 s63, s63, 8192
    buffer_load_dwordx4 v2, s[48:51], s64 offen lds
    s_add_u32 s64, s64, 40960
    s_waitcnt vmcnt(12)
    s_barrier
    v_add_u32 v11, 0, v10
    ds_read_b64_tr_b16 v[136:137], v11 offset:0
    ds_read_b64_tr_b16 v[138:139], v11 offset:1024
    ds_read_b64_tr_b16 v[140:141], v11 offset:8192
    ds_read_b64_tr_b16 v[142:143], v11 offset:9216
    ds_read_b64_tr_b16 v[144:145], v11 offset:16384
    ds_read_b64_tr_b16 v[146:147], v11 offset:17408
    ds_read_b64_tr_b16 v[148:149], v11 offset:24576
    ds_read_b64_tr_b16 v[150:151], v11 offset:25600
    s_waitcnt lgkmcnt(6)
    ds_read_b64_tr_b16 v[152:153], v11 offset:32768
    ds_read_b64_tr_b16 v[154:155], v11 offset:33792
    ds_read_b64_tr_b16 v[156:157], v11 offset:40960
    ds_read_b64_tr_b16 v[158:159], v11 offset:41984
rd_262:
    s_waitcnt lgkmcnt(0)
    s_barrier
    s_mul_i32 s63, s3, 1024
    s_add_u32 s63, s63, 0
    s_mul_i32 s64, s3, 5120
    s_add_u32 s64, s64, s62
    s_add_u32 s64, s64, 1474560
    s_mov_b32 m0, s63
    s_add_u32 s63, s63, 8192
    buffer_load_dwordx4 v2, s[48:51], s64 offen lds
    s_add_u32 s64, s64, 40960
    s_mov_b32 m0, s63
    s_add_u32 s63, s63, 8192
    buffer_load_dwordx4 v2, s[48:51], s64 offen lds
    s_add_u32 s64, s64, 40960
    s_mov_b32 m0, s63
    s_add_u32 s63, s63, 8192
    buffer_load_dwordx4 v2, s[48:51], s64 offen lds
    s_add_u32 s64, s64, 40960
    s_mov_b32 m0, s63
    s_add_u32 s63, s63, 8192
    buffer_load_dwordx4 v2, s[48:51], s64 offen lds
    s_add_u32 s64, s64, 40960
    s_mov_b32 m0, s63
    s_add_u32 s63, s63, 8192
    buffer_load_dwordx4 v2, s[48:51], s64 offen lds
    s_add_u32 s64, s64, 40960
    s_mov_b32 m0, s63
    s_add_u32 s63, s63, 8192
    buffer_load_dwordx4 v2, s[48:51], s64 offen lds
    s_add_u32 s64, s64, 40960
    s_waitcnt vmcnt(12)
    s_barrier
    v_add_u32 v11, 49152, v10
    ds_read_b64_tr_b16 v[160:161], v11 offset:0
    ds_read_b64_tr_b16 v[162:163], v11 offset:1024
    ds_read_b64_tr_b16 v[164:165], v11 offset:8192
    ds_read_b64_tr_b16 v[166:167], v11 offset:9216
    ds_read_b64_tr_b16 v[168:169], v11 offset:16384
    ds_read_b64_tr_b16 v[170:171], v11 offset:17408
    ds_read_b64_tr_b16 v[172:173], v11 offset:24576
    ds_read_b64_tr_b16 v[174:175], v11 offset:25600
    s_waitcnt lgkmcnt(6)
    ds_read_b64_tr_b16 v[176:177], v11 offset:32768
    ds_read_b64_tr_b16 v[178:179], v11 offset:33792
    ds_read_b64_tr_b16 v[180:181], v11 offset:40960
    ds_read_b64_tr_b16 v[182:183], v11 offset:41984
rd_263:
    s_waitcnt lgkmcnt(0)
    s_barrier
    s_mul_i32 s63, s3, 1024
    s_add_u32 s63, s63, 49152
    s_mul_i32 s64, s3, 5120
    s_add_u32 s64, s64, s62
    s_add_u32 s64, s64, 1720320
    s_mov_b32 m0, s63
    s_add_u32 s63, s63, 8192
    buffer_load_dwordx4 v2, s[48:51], s64 offen lds
    s_add_u32 s64, s64, 40960
    s_mov_b32 m0, s63
    s_add_u32 s63, s63, 8192
    buffer_load_dwordx4 v2, s[48:51], s64 offen lds
    s_add_u32 s64, s64, 40960
    s_mov_b32 m0, s63
    s_add_u32 s63, s63, 8192
    buffer_load_dwordx4 v2, s[48:51], s64 offen lds
    s_add_u32 s64, s64, 40960
    s_mov_b32 m0, s63
    s_add_u32 s63, s63, 8192
    buffer_load_dwordx4 v2, s[48:51], s64 offen lds
    s_add_u32 s64, s64, 40960
    s_mov_b32 m0, s63
    s_add_u32 s63, s63, 8192
    buffer_load_dwordx4 v2, s[48:51], s64 offen lds
    s_add_u32 s64, s64, 40960
    s_mov_b32 m0, s63
    s_add_u32 s63, s63, 8192
    buffer_load_dwordx4 v2, s[48:51], s64 offen lds
    s_add_u32 s64, s64, 40960
    s_waitcnt vmcnt(12)
    s_barrier
    v_add_u32 v11, 98304, v10
    ds_read_b64_tr_b16 v[184:185], v11 offset:0
    ds_read_b64_tr_b16 v[186:187], v11 offset:1024
    ds_read_b64_tr_b16 v[188:189], v11 offset:8192
    ds_read_b64_tr_b16 v[190:191], v11 offset:9216
    ds_read_b64_tr_b16 v[192:193], v11 offset:16384
    ds_read_b64_tr_b16 v[194:195], v11 offset:17408
    ds_read_b64_tr_b16 v[196:197], v11 offset:24576
    ds_read_b64_tr_b16 v[198:199], v11 offset:25600
    s_waitcnt lgkmcnt(6)
    ds_read_b64_tr_b16 v[200:201], v11 offset:32768
    ds_read_b64_tr_b16 v[202:203], v11 offset:33792
    ds_read_b64_tr_b16 v[204:205], v11 offset:40960
    ds_read_b64_tr_b16 v[206:207], v11 offset:41984
rd_264:
    s_waitcnt lgkmcnt(0)
    s_barrier
    s_waitcnt vmcnt(6)
    s_barrier
    v_add_u32 v11, 0, v10
    ds_read_b64_tr_b16 v[208:209], v11 offset:0
    ds_read_b64_tr_b16 v[210:211], v11 offset:1024
    ds_read_b64_tr_b16 v[212:213], v11 offset:8192
    ds_read_b64_tr_b16 v[214:215], v11 offset:9216
    ds_read_b64_tr_b16 v[216:217], v11 offset:16384
    ds_read_b64_tr_b16 v[218:219], v11 offset:17408
    ds_read_b64_tr_b16 v[220:221], v11 offset:24576
    ds_read_b64_tr_b16 v[222:223], v11 offset:25600
    s_waitcnt lgkmcnt(6)
    ds_read_b64_tr_b16 v[224:225], v11 offset:32768
    ds_read_b64_tr_b16 v[226:227], v11 offset:33792
    ds_read_b64_tr_b16 v[228:229], v11 offset:40960
    ds_read_b64_tr_b16 v[230:231], v11 offset:41984
rd_265:
    s_waitcnt lgkmcnt(0)
    s_barrier
    s_waitcnt vmcnt(0)
    s_barrier
    v_add_u32 v11, 49152, v10
    ds_read_b64_tr_b16 v[232:233], v11 offset:0
    ds_read_b64_tr_b16 v[234:235], v11 offset:1024
    ds_read_b64_tr_b16 v[236:237], v11 offset:8192
    ds_read_b64_tr_b16 v[238:239], v11 offset:9216
    ds_read_b64_tr_b16 v[240:241], v11 offset:16384
    ds_read_b64_tr_b16 v[242:243], v11 offset:17408
    ds_read_b64_tr_b16 v[244:245], v11 offset:24576
    ds_read_b64_tr_b16 v[246:247], v11 offset:25600
    s_waitcnt lgkmcnt(6)
    ds_read_b64_tr_b16 v[248:249], v11 offset:32768
    ds_read_b64_tr_b16 v[250:251], v11 offset:33792
    ds_read_b64_tr_b16 v[252:253], v11 offset:40960
    ds_read_b64_tr_b16 v[254:255], v11 offset:41984
rd_266:
    s_waitcnt lgkmcnt(0)
    s_barrier
    s_mov_b32 s52, s16
    s_and_b32 s53, s17, 0xffff
    s_mov_b32 s54, 0x280000
    s_mov_b32 s55, 0x00020000
    s_mov_b32 s48, s38
    s_and_b32 s49, s39, 0xffff
    s_mov_b32 s50, 0x280000
    s_mov_b32 s51, 0x00020000
    v_lshlrev_b32 v7, 4, v1
    v_lshlrev_b32 v9, 3, v1
    s_lshl_b32 s63, s61, 3
    s_add_u32 s63, s63, s3
    s_lshl_b32 s64, s63, 9
    v_add_u32 v9, s64, v9
    v_and_b32 v10, 15, v1
    v_mul_u32_u24 v10, 1280, v10
    v_lshrrev_b32 v4, 4, v1
    v_lshlrev_b32 v4, 3, v4
    s_lshl_b32 s64, s63, 5
    v_add3_u32 v10, v10, v4, s64
    v_min_u32 v11, 45, v1
    v_lshlrev_b32 v11, 7, v11
    v_cmp_le_u32 s[66:67], 36, v1
    v_mov_b32 v4, 156827648
    v_mov_b32 v5, 156839424
    v_cndmask_b32 v4, v4, v5, s[66:67]
    v_add_u32 v11, v11, v4
    s_mov_b32 s77, -1
    s_lshl_b32 s73, s9, 1
    s_cmp_eq_u32 s3, 0
    s_cbranch_scc0 f2n_267
    s_lshr_b32 s75, s73, 1
    s_cmp_eq_u32 s75, s77
    s_cbranch_scc1 f2n_267
    s_mov_b32 s77, s75
    s_add_u32 s64, s75, 1
    s_max_u32 s65, s64, 22
    s_sub_u32 s65, s65, 22
    v_mov_b32 v4, s64
    v_mov_b32 v5, s65
    v_cndmask_b32 v4, v4, v5, s[66:67]
    s_mov_b32 s76, 4000000
fv_268:
    buffer_load_dword v12, v11, s[44:47], 0 offen sc1
    s_sub_u32 s76, s76, 1
    s_cbranch_scc1 fvd_269
    s_waitcnt vmcnt(0)
    v_cmp_gt_u32 vcc, v4, v12
    s_cbranch_vccz fvd_269
    s_sleep 4
    s_branch fv_268
fvd_269:
f2n_267:
    s_barrier
    s_add_u32 s70, s73, 84
    s_and_b32 s70, s70, 127
    s_mul_i32 s70, s70, 49152
    s_add_u32 s70, s70, 98566144
    s_mov_b32 s71, 0
    s_lshl_b32 s63, s3, 10
    s_add_u32 s64, s63, s70
    s_add_u32 s63, s63, s71
    s_mov_b32 m0, s63
    s_add_u32 s63, s63, 8192
    buffer_load_dwordx4 v7, s[44:47], s64 offen sc1 lds
    s_add_u32 s64, s64, 8192
    s_mov_b32 m0, s63
    s_add_u32 s63, s63, 8192
    buffer_load_dwordx4 v7, s[44:47], s64 offen sc1 lds
    s_add_u32 s64, s64, 8192
    s_mov_b32 m0, s63
    s_add_u32 s63, s63, 8192
    buffer_load_dwordx4 v7, s[44:47], s64 offen sc1 lds
    s_add_u32 s64, s64, 8192
    s_mov_b32 m0, s63
    s_add_u32 s63, s63, 8192
    buffer_load_dwordx4 v7, s[44:47], s64 offen sc1 lds
    s_add_u32 s64, s64, 8192
    s_mov_b32 m0, s63
    s_add_u32 s63, s63, 8192
    buffer_load_dwordx4 v7, s[44:47], s64 offen sc1 lds
    s_add_u32 s64, s64, 8192
    s_mov_b32 m0, s63
    s_add_u32 s63, s63, 8192
    buffer_load_dwordx4 v7, s[44:47], s64 offen sc1 lds
    s_add_u32 s64, s64, 8192
    s_add_u32 s70, s70, 49152
    s_mov_b32 s71, 49152
    s_lshl_b32 s63, s3, 10
    s_add_u32 s64, s63, s70
    s_add_u32 s63, s63, s71
    s_mov_b32 m0, s63
    s_add_u32 s63, s63, 8192
    buffer_load_dwordx4 v7, s[44:47], s64 offen sc1 lds
    s_add_u32 s64, s64, 8192
    s_mov_b32 m0, s63
    s_add_u32 s63, s63, 8192
    buffer_load_dwordx4 v7, s[44:47], s64 offen sc1 lds
    s_add_u32 s64, s64, 8192
    s_mov_b32 m0, s63
    s_add_u32 s63, s63, 8192
    buffer_load_dwordx4 v7, s[44:47], s64 offen sc1 lds
    s_add_u32 s64, s64, 8192
    s_mov_b32 m0, s63
    s_add_u32 s63, s63, 8192
    buffer_load_dwordx4 v7, s[44:47], s64 offen sc1 lds
    s_add_u32 s64, s64, 8192
    s_mov_b32 m0, s63
    s_add_u32 s63, s63, 8192
    buffer_load_dwordx4 v7, s[44:47], s64 offen sc1 lds
    s_add_u32 s64, s64, 8192
    s_mov_b32 m0, s63
    s_add_u32 s63, s63, 8192
    buffer_load_dwordx4 v7, s[44:47], s64 offen sc1 lds
    s_add_u32 s64, s64, 8192
    s_mov_b32 s79, 0
    s_mov_b32 s68, 98304
    s_lshr_b32 s78, s73, 1
    s_waitcnt vmcnt(6)
    .p2align 6
f2_270:
    s_and_b32 s63, s73, 1
    s_mul_i32 s63, s63, 8
    s_add_u32 s72, s73, s63
    s_add_u32 s72, s72, 1
    s_and_b32 s63, s72, 1
    s_mul_i32 s63, s63, 8
    s_add_u32 s80, s72, s63
    s_add_u32 s80, s80, 1
    s_cmp_lt_u32 s80, 128
    s_cselect_b32 s80, s80, s73
    s_min_u32 s80, s80, 127
    s_cmp_ge_u32 s73, 128
    s_cbranch_scc1 f2s_271
    s_cmp_eq_u32 s3, 0
    s_cbranch_scc0 f2n_272
    s_lshr_b32 s75, s80, 1
    s_cmp_eq_u32 s75, s77
    s_cbranch_scc1 f2n_272
    s_mov_b32 s77, s75
    s_add_u32 s64, s75, 1
    s_max_u32 s65, s64, 22
    s_sub_u32 s65, s65, 22
    v_mov_b32 v4, s64
    v_mov_b32 v5, s65
    v_cndmask_b32 v4, v4, v5, s[66:67]
    s_mov_b32 s76, 4000000
fv_273:
    buffer_load_dword v12, v11, s[44:47], 0 offen sc1
    s_sub_u32 s76, s76, 1
    s_cbranch_scc1 fvd_274
    s_waitcnt vmcnt(0)
    v_cmp_gt_u32 vcc, v4, v12
    s_cbranch_vccz fvd_274
    s_sleep 4
    s_branch fv_273
fvd_274:
f2n_272:
f2s_271:
    s_barrier
    s_cmp_eq_u32 s3, 0
    s_cbranch_scc0 fs_275
    v_mov_b32 v2, 0
    v_mov_b32 v3, s78
    buffer_store_dword v3, v2, s[44:47], s8 offen sc1
fs_275:
    s_cmp_ge_u32 s73, 128
    s_cbranch_scc1 L_ph3
    v_add_u32 v8, s79, v7
    s_lshl_b32 s63, s3, 10
    s_add_u32 s71, s68, s63
    s_mov_b32 s68, s79
    s_add_u32 s79, s79, 49152
    s_cmp_eq_u32 s79, 147456
    s_cselect_b32 s79, 0, s79
    s_add_u32 s70, s80, 84
    s_and_b32 s70, s70, 127
    s_mul_i32 s70, s70, 49152
    s_add_u32 s70, s70, s63
    s_add_u32 s70, s70, 98566144
    s_add_u32 s74, s73, 84
    s_and_b32 s74, s74, 127
    s_mul_i32 s74, s74, 20480
    s_add_u32 s81, s74, 188743680
    buffer_load_dwordx2 v[12:13], v9, s[44:47], s81 offen sc1
    buffer_load_dwordx2 v[14:15], v10, s[52:55], s74 offen
    ds_read_b128 v[16:19], v8 offset:0
    ds_read_b128 v[20:23], v8 offset:1024
    ds_read_b128 v[24:27], v8 offset:2048
    ds_read_b128 v[28:31], v8 offset:3072
    ds_read_b128 v[32:35], v8 offset:4096
    ds_read_b128 v[36:39], v8 offset:5120
    ds_read_b128 v[40:43], v8 offset:6144
    ds_read_b128 v[44:47], v8 offset:7168
    s_waitcnt lgkmcnt(7)
    v_mfma_f32_16x16x32_bf16 v[48:51], v[64:67], v[16:19], 0
    ds_read_b128 v[16:19], v8 offset:8192
    s_waitcnt lgkmcnt(7)
    v_mfma_f32_16x16x32_bf16 v[48:51], v[68:71], v[20:23], v[48:51]
    ds_read_b128 v[20:23], v8 offset:9216
    s_waitcnt lgkmcnt(7)
    v_mfma_f32_16x16x32_bf16 v[48:51], v[72:75], v[24:27], v[48:51]
    ds_read_b128 v[24:27], v8 offset:10240
    s_mov_b32 m0, s71
    s_add_u32 s71, s71, 8192
    buffer_load_dwordx4 v7, s[44:47], s70 offen sc1 lds
    s_add_u32 s70, s70, 8192
    s_waitcnt lgkmcnt(7)
    v_mfma_f32_16x16x32_bf16 v[48:51], v[76:79], v[28:31], v[48:51]
    ds_read_b128 v[28:31], v8 offset:11264
    s_waitcnt lgkmcnt(7)
    v_mfma_f32_16x16x32_bf16 v[48:51], v[80:83], v[32:35], v[48:51]
    ds_read_b128 v[32:35], v8 offset:12288
    s_waitcnt lgkmcnt(7)
    v_mfma_f32_16x16x32_bf16 v[48:51], v[84:87], v[36:39], v[48:51]
    ds_read_b128 v[36:39], v8 offset:13312
    s_waitcnt lgkmcnt(7)
    v_mfma_f32_16x16x32_bf16 v[48:51], v[88:91], v[40:43], v[48:51]
    ds_read_b128 v[40:43], v8 offset:14336
    s_waitcnt lgkmcnt(7)
    v_mfma_f32_16x16x32_bf16 v[48:51], v[92:95], v[44:47], v[48:51]
    ds_read_b128 v[44:47], v8 offset:15360
    s_waitcnt lgkmcnt(7)
    v_mfma_f32_16x16x32_bf16 v[48:51], v[96:99], v[16:19], v[48:51]
    ds_read_b128 v[16:19], v8 offset:16384
    s_waitcnt lgkmcnt(7)
    v_mfma_f32_16x16x32_bf16 v[48:51], v[100:103], v[20:23], v[48:51]
    ds_read_b128 v[20:23], v8 offset:17408
    s_mov_b32 m0, s71
    s_add_u32 s71, s71, 8192
    buffer_load_dwordx4 v7, s[44:47], s70 offen sc1 lds
    s_add_u32 s70, s70, 8192
    s_waitcnt lgkmcnt(7)
    v_mfma_f32_16x16x32_bf16 v[48:51], v[104:107], v[24:27], v[48:51]
    ds_read_b128 v[24:27], v8 offset:18432
    s_waitcnt lgkmcnt(7)
    v_mfma_f32_16x16x32_bf16 v[48:51], v[108:111], v[28:31], v[48:51]
    ds_read_b128 v[28:31], v8 offset:19456
    s_waitcnt lgkmcnt(7)
    v_mfma_f32_16x16x32_bf16 v[48:51], v[112:115], v[32:35], v[48:51]
    ds_read_b128 v[32:35], v8 offset:20480
    s_waitcnt lgkmcnt(7)
    v_mfma_f32_16x16x32_bf16 v[48:51], v[116:119], v[36:39], v[48:51]
    ds_read_b128 v[36:39], v8 offset:21504
    s_waitcnt lgkmcnt(7)
    v_mfma_f32_16x16x32_bf16 v[48:51], v[120:123], v[40:43], v[48:51]
    ds_read_b128 v[40:43], v8 offset:22528
    s_waitcnt lgkmcnt(7)
    v_mfma_f32_16x16x32_bf16 v[48:51], v[124:127], v[44:47], v[48:51]
    ds_read_b128 v[44:47], v8 offset:23552
    s_waitcnt lgkmcnt(7)
    v_mfma_f32_16x16x32_bf16 v[48:51], v[128:131], v[16:19], v[48:51]
    ds_read_b128 v[16:19], v8 offset:24576
    s_mov_b32 m0, s71
    s_add_u32 s71, s71, 8192
    buffer_load_dwordx4 v7, s[44:47], s70 offen sc1 lds
    s_add_u32 s70, s70, 8192
    s_waitcnt lgkmcnt(7)
    v_mfma_f32_16x16x32_bf16 v[48:51], v[132:135], v[20:23], v[48:51]
    ds_read_b128 v[20:23], v8 offset:25600
    s_waitcnt lgkmcnt(7)
    v_mfma_f32_16x16x32_bf16 v[48:51], v[136:139], v[24:27], v[48:51]
    ds_read_b128 v[24:27], v8 offset:26624
    s_waitcnt lgkmcnt(7)
    v_mfma_f32_16x16x32_bf16 v[48:51], v[140:143], v[28:31], v[48:51]
    ds_read_b128 v[28:31], v8 offset:27648
    s_waitcnt lgkmcnt(7)
    v_mfma_f32_16x16x32_bf16 v[48:51], v[144:147], v[32:35], v[48:51]
    ds_read_b128 v[32:35], v8 offset:28672
    s_waitcnt lgkmcnt(7)
    v_mfma_f32_16x16x32_bf16 v[48:51], v[148:151], v[36:39], v[48:51]
    ds_read_b128 v[36:39], v8 offset:29696
    s_waitcnt lgkmcnt(7)
    v_mfma_f32_16x16x32_bf16 v[48:51], v[152:155], v[40:43], v[48:51]
    ds_read_b128 v[40:43], v8 offset:30720
    s_waitcnt lgkmcnt(7)
    v_mfma_f32_16x16x32_bf16 v[48:51], v[156:159], v[44:47], v[48:51]
    ds_read_b128 v[44:47], v8 offset:31744
    s_mov_b32 m0, s71
    s_add_u32 s71, s71, 8192
    buffer_load_dwordx4 v7, s[44:47], s70 offen sc1 lds
    s_add_u32 s70, s70, 8192
    s_waitcnt lgkmcnt(7)
    v_mfma_f32_16x16x32_bf16 v[48:51], v[160:163], v[16:19], v[48:51]
    ds_read_b128 v[16:19], v8 offset:32768
    s_waitcnt lgkmcnt(7)
    v_mfma_f32_16x16x32_bf16 v[48:51], v[164:167], v[20:23], v[48:51]
    ds_read_b128 v[20:23], v8 offset:33792
    s_waitcnt lgkmcnt(7)
    v_mfma_f32_16x16x32_bf16 v[48:51], v[168:171], v[24:27], v[48:51]
    ds_read_b128 v[24:27], v8 offset:34816
    s_waitcnt lgkmcnt(7)
    v_mfma_f32_16x16x32_bf16 v[48:51], v[172:175], v[28:31], v[48:51]
    ds_read_b128 v[28:31], v8 offset:35840
    s_waitcnt lgkmcnt(7)
    v_mfma_f32_16x16x32_bf16 v[48:51], v[176:179], v[32:35], v[48:51]
    ds_read_b128 v[32:35], v8 offset:36864
    s_waitcnt lgkmcnt(7)
    v_mfma_f32_16x16x32_bf16 v[48:51], v[180:183], v[36:39], v[48:51]
    ds_read_b128 v[36:39], v8 offset:37888
    s_waitcnt lgkmcnt(7)
    v_mfma_f32_16x16x32_bf16 v[48:51], v[184:187], v[40:43], v[48:51]
    ds_read_b128 v[40:43], v8 offset:38912
    s_mov_b32 m0, s71
    s_add_u32 s71, s71, 8192
    buffer_load_dwordx4 v7, s[44:47], s70 offen sc1 lds
    s_add_u32 s70, s70, 8192
    s_waitcnt lgkmcnt(7)
    v_mfma_f32_16x16x32_bf16 v[48:51], v[188:191], v[44:47], v[48:51]
    ds_read_b128 v[44:47], v8 offset:39936
    s_waitcnt lgkmcnt(7)
    v_mfma_f32_16x16x32_bf16 v[48:51], v[192:195], v[16:19], v[48:51]
    ds_read_b128 v[16:19], v8 offset:40960
    s_waitcnt lgkmcnt(7)
    v_mfma_f32_16x16x32_bf16 v[48:51], v[196:199], v[20:23], v[48:51]
    ds_read_b128 v[20:23], v8 offset:41984
    s_waitcnt lgkmcnt(7)
    v_mfma_f32_16x16x32_bf16 v[48:51], v[200:203], v[24:27], v[48:51]
    ds_read_b128 v[24:27], v8 offset:43008
    s_waitcnt lgkmcnt(7)
    v_mfma_f32_16x16x32_bf16 v[48:51], v[204:207], v[28:31], v[48:51]
    ds_read_b128 v[28:31], v8 offset:44032
    s_waitcnt lgkmcnt(7)
    v_mfma_f32_16x16x32_bf16 v[48:51], v[208:211], v[32:35], v[48:51]
    ds_read_b128 v[32:35], v8 offset:45056
    s_waitcnt lgkmcnt(7)
    v_mfma_f32_16x16x32_bf16 v[48:51], v[212:215], v[36:39], v[48:51]
    ds_read_b128 v[36:39], v8 offset:46080
    s_mov_b32 m0, s71
    s_add_u32 s71, s71, 8192
    buffer_load_dwordx4 v7, s[44:47], s70 offen sc1 lds
    s_add_u32 s70, s70, 8192
    s_waitcnt lgkmcnt(7)
    v_mfma_f32_16x16x32_bf16 v[48:51], v[216:219], v[40:43], v[48:51]
    ds_read_b128 v[40:43], v8 offset:47104
    s_waitcnt lgkmcnt(7)
    v_mfma_f32_16x16x32_bf16 v[48:51], v[220:223], v[44:47], v[48:51]
    ds_read_b128 v[44:47], v8 offset:48128
    s_waitcnt lgkmcnt(7)
    v_mfma_f32_16x16x32_bf16 v[48:51], v[224:227], v[16:19], v[48:51]
    s_waitcnt lgkmcnt(6)
    v_mfma_f32_16x16x32_bf16 v[48:51], v[228:231], v[20:23], v[48:51]
    s_waitcnt lgkmcnt(5)
    v_mfma_f32_16x16x32_bf16 v[48:51], v[232:235], v[24:27], v[48:51]
    s_waitcnt lgkmcnt(4)
    v_mfma_f32_16x16x32_bf16 v[48:51], v[236:239], v[28:31], v[48:51]
    s_waitcnt lgkmcnt(3)
    v_mfma_f32_16x16x32_bf16 v[48:51], v[240:243], v[32:35], v[48:51]
    s_waitcnt lgkmcnt(2)
    v_mfma_f32_16x16x32_bf16 v[48:51], v[244:247], v[36:39], v[48:51]
    s_waitcnt lgkmcnt(1)
    v_mfma_f32_16x16x32_bf16 v[48:51], v[248:251], v[40:43], v[48:51]
    s_waitcnt lgkmcnt(0)
    v_mfma_f32_16x16x32_bf16 v[48:51], v[252:255], v[44:47], v[48:51]
    s_nop 7
    v_cvt_pk_bf16_f32 v48, v48, v48
    v_and_b32 v48, 0xffff0000, v48
    v_mul_f32 v52, 0xbfb8aa3b, v48
    v_exp_f32 v52, v52
    s_nop 0
    v_add_f32 v52, 1.0, v52
    v_rcp_f32 v52, v52
    s_nop 0
    v_mul_f32 v48, v48, v52
    v_cvt_pk_bf16_f32 v49, v49, v49
    v_and_b32 v49, 0xffff0000, v49
    v_mul_f32 v53, 0xbfb8aa3b, v49
    v_exp_f32 v53, v53
    s_nop 0
    v_add_f32 v53, 1.0, v53
    v_rcp_f32 v53, v53
    s_nop 0
    v_mul_f32 v49, v49, v53
    v_cvt_pk_bf16_f32 v50, v50, v50
    v_and_b32 v50, 0xffff0000, v50
    v_mul_f32 v54, 0xbfb8aa3b, v50
    v_exp_f32 v54, v54
    s_nop 0
    v_add_f32 v54, 1.0, v54
    v_rcp_f32 v54, v54
    s_nop 0
    v_mul_f32 v50, v50, v54
    v_cvt_pk_bf16_f32 v51, v51, v51
    v_and_b32 v51, 0xffff0000, v51
    v_mul_f32 v55, 0xbfb8aa3b, v51
    v_exp_f32 v55, v55
    s_nop 0
    v_add_f32 v55, 1.0, v55
    v_rcp_f32 v55, v55
    s_nop 0
    v_mul_f32 v51, v51, v55
    s_cmp_ge_u32 s73, 44
    s_cbranch_scc1 f2f_276
    v_cvt_pk_bf16_f32 v56, v48, v49
    v_cvt_pk_bf16_f32 v57, v50, v51
    s_add_u32 s81, s74, 104857600
    buffer_store_dwordx2 v[56:57], v9, s[44:47], s81 offen sc1
    s_branch f2j_277
f2f_276:
    v_cvt_pk_bf16_f32 v48, v48, v48
    v_and_b32 v48, 0xffff0000, v48
    v_cvt_pk_bf16_f32 v49, v49, v49
    v_and_b32 v49, 0xffff0000, v49
    v_cvt_pk_bf16_f32 v50, v50, v50
    v_and_b32 v50, 0xffff0000, v50
    v_cvt_pk_bf16_f32 v51, v51, v51
    v_and_b32 v51, 0xffff0000, v51
    s_waitcnt vmcnt(6)
    v_lshlrev_b32 v54, 16, v12
    v_lshlrev_b32 v58, 16, v14
    v_mul_f32 v48, v48, v54
    v_cvt_pk_bf16_f32 v48, v48, v48
    v_and_b32 v48, 0xffff0000, v48
    v_add_f32 v48, v48, v58
    v_and_b32 v55, 0xffff0000, v12
    v_and_b32 v59, 0xffff0000, v14
    v_mul_f32 v49, v49, v55
    v_cvt_pk_bf16_f32 v49, v49, v49
    v_and_b32 v49, 0xffff0000, v49
    v_add_f32 v49, v49, v59
    v_lshlrev_b32 v56, 16, v13
    v_lshlrev_b32 v60, 16, v15
    v_mul_f32 v50, v50, v56
    v_cvt_pk_bf16_f32 v50, v50, v50
    v_and_b32 v50, 0xffff0000, v50
    v_add_f32 v50, v50, v60
    v_and_b32 v57, 0xffff0000, v13
    v_and_b32 v61, 0xffff0000, v15
    v_mul_f32 v51, v51, v57
    v_cvt_pk_bf16_f32 v51, v51, v51
    v_and_b32 v51, 0xffff0000, v51
    v_add_f32 v51, v51, v61
    v_cvt_pk_bf16_f32 v52, v48, v49
    v_cvt_pk_bf16_f32 v53, v50, v51
    buffer_store_dwordx2 v[52:53], v10, s[48:51], s74 offen
f2j_277:
    s_lshr_b32 s78, s73, 1
    s_mov_b32 s73, s72
    s_waitcnt vmcnt(7)
    s_cmp_lt_u32 s73, 128
    s_cbranch_scc1 f2_270
    s_waitcnt vmcnt(0)
    s_lshr_b32 s78, s73, 1
    s_branch f2_270
L_ph3:
    s_endpgm
L_chain:
    s_mul_i32 s60, s5, 86
    s_lshr_b32 s60, s60, 8
    s_mul_i32 s61, s60, 3
    s_sub_u32 s61, s5, s61
    s_lshl_b32 s62, s4, 2
    s_add_u32 s62, s62, s60
    s_mov_b32 s6, 1
    s_cmp_lt_u32 s3, 4
    s_cbranch_scc0 cvo_278
    v_lshlrev_b32 v7, 4, v1
    s_lshl_b32 s63, s3, 10
    v_add_u32 v5, s63, v7
    s_and_b32 s63, s3, 1
    s_add_u32 s63, s63, 8
    s_lshl_b32 s63, s63, 10
    v_add_u32 v6, s63, v7
    s_lshr_b32 s63, s4, 1
    s_lshl_b32 s63, s63, 17
    s_add_u32 s63, s63, 156237824
    v_add_u32 v2, s63, v5
    v_add_u32 v3, 0x1000, v2
    v_add_u32 v4, s63, v6
    v_lshrrev_b32 v12, 4, v1
    v_mul_u32_u24 v8, 288, v12
    v_and_b32 v13, 15, v1
    v_lshlrev_b32 v14, 1, v13
    v_add_u32 v8, v8, v14
    s_lshl_b32 s63, s3, 5
    s_add_u32 s63, s63, 10240
    v_add_u32 v8, s63, v8
    v_and_b32 v14, 7, v1
    v_mul_u32_u24 v9, 144, v14
    v_lshlrev_b32 v15, 4, v12
    v_add_u32 v9, v9, v15
    v_add_u32 v9, 10240, v9
    v_bfe_u32 v10, v1, 2, 2
    v_lshlrev_b32 v10, 1, v10
    v_and_b32 v16, 1, v1
    v_add_u32 v10, v10, v16
    v_mul_u32_u24 v10, 144, v10
    v_add_u32 v10, v10, v15
    v_add_u32 v10, 11392, v10
    v_mov_b32 v52, 0x4444
    v_mov_b32 v17, 0xeeee
    v_cmp_eq_u32 vcc, 1, v16
    s_nop 1
    v_cndmask_b32 v52, v52, v17, vcc
    s_lshl_b32 s63, s4, 16
    s_lshl_b32 s67, s60, 12
    s_add_u32 s63, s63, s67
    s_add_u32 s63, s63, 155189248
    s_cmp_eq_u32 s3, 0
    s_cbranch_scc0 qs_280
    s_lshl_b32 s67, s61, 8
    s_add_u32 s63, s63, s67
    s_add_u32 s63, s63, 3072
    v_lshlrev_b32 v11, 2, v1
    v_add_u32 v11, s63, v11
    s_branch qs_281
    .p2align 6
qs_280:
    s_lshl_b32 s67, s61, 10
    s_add_u32 s63, s63, s67
    s_sub_u32 s67, s3, 1
    s_lshl_b32 s67, s67, 9
    s_add_u32 s63, s63, s67
    v_lshlrev_b32 v11, 3, v12
    v_add_u32 v11, v11, v14
    v_lshlrev_b32 v11, 4, v11
    v_add_u32 v11, s63, v11
    v_mov_b32 v17, 1073741824
    v_cmp_gt_u32 vcc, 8, v13
    s_nop 1
    v_cndmask_b32 v11, v17, v11, vcc
    .p2align 6
qs_281:
    v_cmp_le_u32 s[68:69], 8, v13
    s_mul_i32 s63, s62, 6
    s_lshl_b32 s67, s61, 1
    s_add_u32 s63, s63, s67
    s_lshl_b32 s63, s63, 10
    s_add_u32 s63, s63, 79691776
    v_add_u32 v0, s63, v7
    v_mov_b32 v40, -1
    v_mov_b32 v41, -1
    v_mov_b32 v42, -1
    v_mov_b32 v43, -1
    s_mov_b32 s72, 0
    s_cmp_eq_u32 s3, 3
    s_cbranch_scc1 qr_283
    s_cmp_eq_u32 s3, 0
    s_cbranch_scc0 qr_282
    s_cmp_lg_u32 s6, 0
    s_cbranch_scc1 sf_284
    buffer_store_dword v40, v11, s[44:47], s72 offen
    s_branch sd_285
sf_284:
    buffer_store_dword v40, v11, s[44:47], s72 offen sc1
sd_285:
    s_branch qr_283
qr_282:
    s_cmp_lg_u32 s6, 0
    s_cbranch_scc1 sf_286
    buffer_store_dwordx4 v[40:43], v11, s[44:47], s72 offen
    s_branch sd_287
sf_286:
    buffer_store_dwordx4 v[40:43], v11, s[44:47], s72 offen sc1
sd_287:
qr_283:
    s_mov_b32 s72, 16384
    s_cmp_eq_u32 s3, 3
    s_cbranch_scc1 qr_289
    s_cmp_eq_u32 s3, 0
    s_cbranch_scc0 qr_288
    s_cmp_lg_u32 s6, 0
    s_cbranch_scc1 sf_290
    buffer_store_dword v40, v11, s[44:47], s72 offen
    s_branch sd_291
sf_290:
    buffer_store_dword v40, v11, s[44:47], s72 offen sc1
sd_291:
    s_branch qr_289
qr_288:
    s_cmp_lg_u32 s6, 0
    s_cbranch_scc1 sf_292
    buffer_store_dwordx4 v[40:43], v11, s[44:47], s72 offen
    s_branch sd_293
sf_292:
    buffer_store_dwordx4 v[40:43], v11, s[44:47], s72 offen sc1
sd_293:
qr_289:
    s_mov_b32 s72, 32768
    s_cmp_eq_u32 s3, 3
    s_cbranch_scc1 qr_295
    s_cmp_eq_u32 s3, 0
    s_cbranch_scc0 qr_294
    s_cmp_lg_u32 s6, 0
    s_cbranch_scc1 sf_296
    buffer_store_dword v40, v11, s[44:47], s72 offen
    s_branch sd_297
sf_296:
    buffer_store_dword v40, v11, s[44:47], s72 offen sc1
sd_297:
    s_branch qr_295
qr_294:
    s_cmp_lg_u32 s6, 0
    s_cbranch_scc1 sf_298
    buffer_store_dwordx4 v[40:43], v11, s[44:47], s72 offen
    s_branch sd_299
sf_298:
    buffer_store_dwordx4 v[40:43], v11, s[44:47], s72 offen sc1
sd_299:
qr_295:
    s_mov_b32 s72, 49152
    s_cmp_eq_u32 s3, 3
    s_cbranch_scc1 qr_301
    s_cmp_eq_u32 s3, 0
    s_cbranch_scc0 qr_300
    s_cmp_lg_u32 s6, 0
    s_cbranch_scc1 sf_302
    buffer_store_dword v40, v11, s[44:47], s72 offen
    s_branch sd_303
sf_302:
    buffer_store_dword v40, v11, s[44:47], s72 offen sc1
sd_303:
    s_branch qr_301
qr_300:
    s_cmp_lg_u32 s6, 0
    s_cbranch_scc1 sf_304
    buffer_store_dwordx4 v[40:43], v11, s[44:47], s72 offen
    s_branch sd_305
sf_304:
    buffer_store_dwordx4 v[40:43], v11, s[44:47], s72 offen sc1
sd_305:
qr_301:
    s_branch cd_279
cvo_278:
    s_and_b32 s66, s3, 3
    v_lshlrev_b32 v7, 4, v1
    v_lshrrev_b32 v20, 4, v1
    v_and_b32 v21, 15, v1
    v_and_b32 v22, 7, v1
    v_bfe_u32 v23, v1, 3, 1
    s_lshl_b32 s63, s4, 16
    s_lshl_b32 s67, s60, 12
    s_add_u32 s67, s63, s67
    s_add_u32 s67, s67, 155189248
    v_lshlrev_b32 v2, 3, v20
    v_add_u32 v2, v2, v22
    v_lshlrev_b32 v2, 4, v2
    v_lshlrev_b32 v24, 9, v23
    v_add_u32 v2, v2, v24
    v_add_u32 v2, s67, v2
    s_add_u32 s67, s67, 3072
    v_lshlrev_b32 v3, 2, v1
    v_add_u32 v3, s67, v3
    v_lshlrev_b32 v24, 5, v22
    v_lshlrev_b32 v25, 3, v20
    v_add_u32 v24, v24, v25
    s_lshl_b32 s67, s5, 10
    s_lshl_b32 s70, s66, 8
    s_add_u32 s67, s67, s70
    s_add_u32 s67, s67, s63
    s_add_u32 s70, s67, 155713536
    v_add_u32 v4, s70, v24
    v_mov_b32 v26, 1073741824
    v_cmp_gt_u32 vcc, 8, v21
    s_nop 1
    v_cndmask_b32 v4, v26, v4, vcc
    s_mul_i32 s70, s66, 3072
    s_add_u32 s70, s70, s63
    s_add_u32 s70, s70, 155713536
    v_add_u32 v5, s70, v7
    v_lshlrev_b32 v6, 7, v20
    v_lshlrev_b32 v24, 2, v21
    v_add_u32 v6, v6, v24
    s_lshl_b32 s70, s66, 9
    s_add_u32 s70, s70, 29184
    v_add_u32 v6, s70, v6
    s_lshl_b32 s70, s66, 11
    s_add_u32 s70, s70, 29184
    v_add_u32 v8, s70, v7
    s_lshl_b32 s70, s5, 1
    s_lshr_b32 s71, s66, 1
    s_add_u32 s70, s70, s71
    s_lshl_b32 s70, s70, 14
    s_and_b32 s71, s66, 1
    s_lshl_b32 s71, s71, 12
    s_add_u32 s70, s70, s71
    s_add_u32 s70, s70, 153092096
    s_lshl_b32 s71, s5, 1
    s_and_b32 s64, s4, 1
    s_add_u32 s71, s71, s64
    s_lshl_b32 s71, s71, 14
    s_and_b32 s64, s66, 1
    s_lshl_b32 s64, s64, 12
    s_add_u32 s71, s71, s64
    s_add_u32 s71, s71, 153092096
    v_add_u32 v10, s71, v7
    s_lshl_b32 s71, s4, 8
    s_add_u32 s70, s70, s71
    v_and_b32 v24, 31, v1
    v_lshlrev_b32 v24, 4, v24
    v_lshrrev_b32 v25, 5, v1
    v_lshlrev_b32 v25, 3, v25
    v_add3_u32 v9, v24, v25, s70
    v_add_u32 v24, v24, v25
    v_lshrrev_b32 v24, 1, v24
    v_lshlrev_b32 v24, 2, v1
    v_add_u32 v9, s70, v24
    v_lshrrev_b32 v24, 2, v21
    v_lshlrev_b32 v24, 6, v24
    v_lshlrev_b32 v25, 5, v20
    v_add_u32 v24, v24, v25
    v_and_b32 v25, 3, v1
    v_lshlrev_b32 v25, 3, v25
    v_add_u32 v24, v24, v25
    s_mul_i32 s71, s66, 3072
    s_add_u32 s71, s71, 29184
    v_add_u32 v6, s71, v7
    v_cmp_gt_u32 vcc, 32, v1
    s_nop 1
    v_cndmask_b32 v24, v26, v24, vcc
    s_lshr_b32 s70, s4, 1
    s_lshl_b32 s70, s70, 17
    s_lshl_b32 s71, s5, 10
    s_add_u32 s70, s70, s71
    s_and_b32 s71, s4, 1
    s_lshl_b32 s71, s71, 9
    s_add_u32 s70, s70, s71
    s_and_b32 s71, s66, 1
    s_lshl_b32 s71, s71, 8
    s_add_u32 s70, s70, s71
    s_add_u32 s70, s70, 156237824
    s_cmp_lt_u32 s66, 2
    s_cselect_b32 s70, s70, 1073741824
    v_add_u32 v11, s70, v24
    v_and_b32 v24, 1, v1
    v_mov_b32 v12, 0x4444
    v_mov_b32 v25, 0xeeee
    v_cmp_eq_u32 vcc, 1, v24
    s_nop 1
    v_cndmask_b32 v12, v12, v25, vcc
    s_mul_i32 s70, s62, 12
    s_lshl_b32 s71, s61, 2
    s_add_u32 s70, s70, s71
    s_add_u32 s70, s70, s66
    s_lshl_b32 s70, s70, 8
    s_add_u32 s70, s70, 92274688
    v_lshlrev_b32 v24, 2, v1
    v_add_u32 v13, s70, v24
    v_mov_b32 v40, -1
    v_mov_b32 v41, -1
    v_mov_b32 v42, -1
    v_mov_b32 v43, -1
    s_mov_b32 s72, 0
    buffer_store_dwordx2 v[40:41], v4, s[44:47], s72 offen sc1
    s_mov_b32 s72, 16384
    buffer_store_dwordx2 v[40:41], v4, s[44:47], s72 offen sc1
    s_mov_b32 s72, 32768
    buffer_store_dwordx2 v[40:41], v4, s[44:47], s72 offen sc1
    s_mov_b32 s72, 49152
    buffer_store_dwordx2 v[40:41], v4, s[44:47], s72 offen sc1
    s_cmp_lt_u32 s5, 10
    s_cbranch_scc0 cnb_306
    s_mov_b32 s72, 0
    buffer_store_dword v40, v9, s[44:47], s72 offen sc1
    s_mov_b32 s72, 8192
    buffer_store_dword v40, v9, s[44:47], s72 offen sc1
    s_mov_b32 s72, 327680
    buffer_store_dword v40, v9, s[44:47], s72 offen sc1
    s_mov_b32 s72, 335872
    buffer_store_dword v40, v9, s[44:47], s72 offen sc1
    s_mov_b32 s72, 16384
    buffer_store_dwordx2 v[40:41], v11, s[44:47], s72 offen sc1
    s_mov_b32 s72, 32768
    buffer_store_dwordx2 v[40:41], v11, s[44:47], s72 offen sc1
    s_mov_b32 s72, 49152
    buffer_store_dwordx2 v[40:41], v11, s[44:47], s72 offen sc1
cnb_306:
cd_279:
    v_and_b32 v4, 7, v1
    v_lshrrev_b32 v5, 5, v1
    s_and_b32 s63, s3, 1
    s_lshl_b32 s63, s63, 1
    v_add_u32 v5, s63, v5
    v_lshlrev_b32 v5, 1, v5
    v_xor_b32 v4, v4, v5
    v_lshlrev_b32 v4, 4, v4
    v_lshrrev_b32 v5, 3, v1
    s_lshl_b32 s63, s3, 3
    v_add_u32 v5, s63, v5
    v_mul_u32_u24 v2, 12288, v5
    v_add_u32 v2, v2, v4
    v_mul_u32_u24 v3, 1280, v5
    v_add_u32 v3, v3, v4
    s_mul_i32 s64, s62, 384
    s_lshl_b32 s63, s61, 7
    s_add_u32 s64, s64, s63
    s_mul_i32 s65, s4, 983040
    s_lshl_b32 s63, s5, 7
    s_add_u32 s65, s65, s63
    v_lshrrev_b32 v4, 5, v1
    v_lshlrev_b32 v6, 11, v4
    v_bfe_u32 v4, v1, 4, 1
    v_mul_u32_u24 v4, 544, v4
    v_add_u32 v6, v6, v4
    v_bfe_u32 v4, v1, 2, 1
    v_lshlrev_b32 v4, 7, v4
    v_add_u32 v6, v6, v4
    v_bfe_u32 v4, v1, 3, 1
    v_mul_u32_u24 v4, 1088, v4
    v_add_u32 v6, v6, v4
    v_and_b32 v4, 3, v1
    v_lshlrev_b32 v4, 3, v4
    v_add_u32 v6, v6, v4
    s_and_b32 s66, s3, 3
    s_mov_b32 s48, s22
    s_and_b32 s49, s23, 0xffff
    s_mov_b32 s50, 0x780000
    s_mov_b32 s51, 0x00020000
    s_lshl_b32 s63, s3, 10
    s_add_u32 s63, s63, 0
    s_add_u32 s67, s64, 0
    s_mov_b32 m0, s63
    s_add_u32 s63, s63, 8192
    buffer_load_dwordx4 v2, s[48:51], s67 offen lds
    s_add_u32 s67, s67, 786432
    s_mov_b32 m0, s63
    s_add_u32 s63, s63, 8192
    buffer_load_dwordx4 v2, s[48:51], s67 offen lds
    s_add_u32 s67, s67, 786432
    s_mov_b32 m0, s63
    s_add_u32 s63, s63, 8192
    buffer_load_dwordx4 v2, s[48:51], s67 offen lds
    s_add_u32 s67, s67, 786432
    s_mov_b32 m0, s63
    s_add_u32 s63, s63, 8192
    buffer_load_dwordx4 v2, s[48:51], s67 offen lds
    s_add_u32 s67, s67, 786432
    s_waitcnt vmcnt(4)
    s_barrier
    s_cmp_eq_u32 s3, 0
    s_cbranch_scc0 arr_307
    s_getreg_b32 s12, hwreg(HW_REG_XCC_ID)
    s_and_b32 s12, s12, 15
    s_cmp_gt_u32 s12, 7
    s_cselect_b32 s13, s14, 0
    s_lshr_b32 s13, s13, 3
    s_add_u32 s12, s12, s13
    s_sub_u32 s12, s12, s14
    s_and_b32 s12, s12, 7
    s_mul_i32 s13, s12, s12
    s_lshl_b32 s12, s12, 9
    s_or_b32 s12, s12, 1
    v_mov_b32 v12, s12
    v_mov_b32 v13, s13
    v_mov_b32 v14, 1073741824
    v_cmp_eq_u32 vcc, 0, v1
    s_nop 1
    v_cndmask_b32 v14, v14, v1, vcc
    buffer_atomic_add_x2 v[12:13], v14, s[56:59], s10 offen sc1
arr_307:
    s_mov_b32 s48, s22
    s_and_b32 s49, s23, 0xffff
    s_mov_b32 s50, 0x780000
    s_mov_b32 s51, 0x00020000
    s_lshl_b32 s63, s3, 10
    s_add_u32 s63, s63, 32768
    s_add_u32 s67, s64, 3145728
    s_mov_b32 m0, s63
    s_add_u32 s63, s63, 8192
    buffer_load_dwordx4 v2, s[48:51], s67 offen lds
    s_add_u32 s67, s67, 786432
    s_mov_b32 m0, s63
    s_add_u32 s63, s63, 8192
    buffer_load_dwordx4 v2, s[48:51], s67 offen lds
    s_add_u32 s67, s67, 786432
    s_mov_b32 m0, s63
    s_add_u32 s63, s63, 8192
    buffer_load_dwordx4 v2, s[48:51], s67 offen lds
    s_add_u32 s67, s67, 786432
    s_mov_b32 m0, s63
    s_add_u32 s63, s63, 8192
    buffer_load_dwordx4 v2, s[48:51], s67 offen lds
    s_add_u32 s67, s67, 786432
    s_mov_b32 m0, s63
    s_add_u32 s63, s63, 8192
    buffer_load_dwordx4 v2, s[48:51], s67 offen lds
    s_add_u32 s67, s67, 786432
    s_mov_b32 m0, s63
    s_add_u32 s63, s63, 8192
    buffer_load_dwordx4 v2, s[48:51], s67 offen lds
    s_add_u32 s67, s67, 786432
    s_mov_b32 s48, s24
    s_and_b32 s49, s25, 0xffff
    s_mov_b32 s50, 0x780000
    s_mov_b32 s51, 0x00020000
    s_lshl_b32 s63, s3, 10
    s_add_u32 s63, s63, 81920
    s_add_u32 s67, s64, 0
    s_mov_b32 m0, s63
    s_add_u32 s63, s63, 8192
    buffer_load_dwordx4 v2, s[48:51], s67 offen lds
    s_add_u32 s67, s67, 786432
    s_mov_b32 m0, s63
    s_add_u32 s63, s63, 8192
    buffer_load_dwordx4 v2, s[48:51], s67 offen lds
    s_add_u32 s67, s67, 786432
    s_mov_b32 m0, s63
    s_add_u32 s63, s63, 8192
    buffer_load_dwordx4 v2, s[48:51], s67 offen lds
    s_add_u32 s67, s67, 786432
    s_mov_b32 m0, s63
    s_add_u32 s63, s63, 8192
    buffer_load_dwordx4 v2, s[48:51], s67 offen lds
    s_add_u32 s67, s67, 786432
    s_mov_b32 m0, s63
    s_add_u32 s63, s63, 8192
    buffer_load_dwordx4 v2, s[48:51], s67 offen lds
    s_add_u32 s67, s67, 786432
    s_mov_b32 m0, s63
    s_add_u32 s63, s63, 8192
    buffer_load_dwordx4 v2, s[48:51], s67 offen lds
    s_add_u32 s67, s67, 786432
    s_mov_b32 m0, s63
    s_add_u32 s63, s63, 8192
    buffer_load_dwordx4 v2, s[48:51], s67 offen lds
    s_add_u32 s67, s67, 786432
    s_mov_b32 m0, s63
    s_add_u32 s63, s63, 8192
    buffer_load_dwordx4 v2, s[48:51], s67 offen lds
    s_add_u32 s67, s67, 786432
    s_mov_b32 m0, s63
    s_add_u32 s63, s63, 8192
    buffer_load_dwordx4 v2, s[48:51], s67 offen lds
    s_add_u32 s67, s67, 786432
    s_mov_b32 m0, s63
    s_add_u32 s63, s63, 8192
    buffer_load_dwordx4 v2, s[48:51], s67 offen lds
    s_add_u32 s67, s67, 786432
    s_waitcnt vmcnt(10)
    s_barrier
    s_cmp_lt_u32 s3, 4
    s_cbranch_scc0 wl_308
    s_lshl_b32 s63, s66, 5
    v_xor_b32 v4, s63, v6
    v_add_u32 v4, 0, v4
    v_add_u32 v5, 0x8000, v4
    v_add_u32 v5, 0x8000, v5
    ds_read_b64_tr_b16 v[176:177], v4 offset:0
    ds_read_b64_tr_b16 v[178:179], v4 offset:256
    ds_read_b64_tr_b16 v[180:181], v4 offset:4096
    ds_read_b64_tr_b16 v[182:183], v4 offset:4352
    ds_read_b64_tr_b16 v[184:185], v4 offset:8192
    ds_read_b64_tr_b16 v[186:187], v4 offset:8448
    ds_read_b64_tr_b16 v[188:189], v4 offset:12288
    ds_read_b64_tr_b16 v[190:191], v4 offset:12544
    ds_read_b64_tr_b16 v[192:193], v4 offset:16384
    ds_read_b64_tr_b16 v[194:195], v4 offset:16640
    ds_read_b64_tr_b16 v[196:197], v4 offset:20480
    ds_read_b64_tr_b16 v[198:199], v4 offset:20736
    s_waitcnt lgkmcnt(4)
    ds_read_b64_tr_b16 v[200:201], v4 offset:24576
    ds_read_b64_tr_b16 v[202:203], v4 offset:24832
    ds_read_b64_tr_b16 v[204:205], v4 offset:28672
    ds_read_b64_tr_b16 v[206:207], v4 offset:28928
    ds_read_b64_tr_b16 v[208:209], v4 offset:32768
    ds_read_b64_tr_b16 v[210:211], v4 offset:33024
    ds_read_b64_tr_b16 v[212:213], v4 offset:36864
    ds_read_b64_tr_b16 v[214:215], v4 offset:37120
    ds_read_b64_tr_b16 v[216:217], v4 offset:40960
    ds_read_b64_tr_b16 v[218:219], v4 offset:41216
    ds_read_b64_tr_b16 v[220:221], v4 offset:45056
    ds_read_b64_tr_b16 v[222:223], v4 offset:45312
    s_waitcnt lgkmcnt(4)
    ds_read_b64_tr_b16 v[224:225], v4 offset:49152
    ds_read_b64_tr_b16 v[226:227], v4 offset:49408
    ds_read_b64_tr_b16 v[228:229], v4 offset:53248
    ds_read_b64_tr_b16 v[230:231], v4 offset:53504
    ds_read_b64_tr_b16 v[232:233], v4 offset:57344
    ds_read_b64_tr_b16 v[234:235], v4 offset:57600
    ds_read_b64_tr_b16 v[236:237], v4 offset:61440
    ds_read_b64_tr_b16 v[238:239], v4 offset:61696
    ds_read_b64_tr_b16 v[240:241], v5 offset:0
    ds_read_b64_tr_b16 v[242:243], v5 offset:256
    ds_read_b64_tr_b16 v[244:245], v5 offset:4096
    ds_read_b64_tr_b16 v[246:247], v5 offset:4352
    s_waitcnt lgkmcnt(4)
    ds_read_b64_tr_b16 v[248:249], v5 offset:8192
    ds_read_b64_tr_b16 v[250:251], v5 offset:8448
    ds_read_b64_tr_b16 v[252:253], v5 offset:12288
    ds_read_b64_tr_b16 v[254:255], v5 offset:12544
    s_waitcnt lgkmcnt(0)
wl_308:
    s_barrier
    s_mov_b32 s48, s20
    s_and_b32 s49, s21, 0xffff
    s_mov_b32 s50, 0x780000
    s_mov_b32 s51, 0x00020000
    s_lshl_b32 s63, s3, 10
    s_add_u32 s63, s63, 0
    s_add_u32 s67, s64, 0
    s_mov_b32 m0, s63
    s_add_u32 s63, s63, 8192
    buffer_load_dwordx4 v2, s[48:51], s67 offen lds
    s_add_u32 s67, s67, 786432
    s_mov_b32 m0, s63
    s_add_u32 s63, s63, 8192
    buffer_load_dwordx4 v2, s[48:51], s67 offen lds
    s_add_u32 s67, s67, 786432
    s_mov_b32 m0, s63
    s_add_u32 s63, s63, 8192
    buffer_load_dwordx4 v2, s[48:51], s67 offen lds
    s_add_u32 s67, s67, 786432
    s_mov_b32 m0, s63
    s_add_u32 s63, s63, 8192
    buffer_load_dwordx4 v2, s[48:51], s67 offen lds
    s_add_u32 s67, s67, 786432
    s_mov_b32 m0, s63
    s_add_u32 s63, s63, 8192
    buffer_load_dwordx4 v2, s[48:51], s67 offen lds
    s_add_u32 s67, s67, 786432
    s_mov_b32 m0, s63
    s_add_u32 s63, s63, 8192
    buffer_load_dwordx4 v2, s[48:51], s67 offen lds
    s_add_u32 s67, s67, 786432
    s_mov_b32 m0, s63
    s_add_u32 s63, s63, 8192
    buffer_load_dwordx4 v2, s[48:51], s67 offen lds
    s_add_u32 s67, s67, 786432
    s_mov_b32 m0, s63
    s_add_u32 s63, s63, 8192
    buffer_load_dwordx4 v2, s[48:51], s67 offen lds
    s_add_u32 s67, s67, 786432
    s_mov_b32 m0, s63
    s_add_u32 s63, s63, 8192
    buffer_load_dwordx4 v2, s[48:51], s67 offen lds
    s_add_u32 s67, s67, 786432
    s_mov_b32 m0, s63
    s_add_u32 s63, s63, 8192
    buffer_load_dwordx4 v2, s[48:51], s67 offen lds
    s_add_u32 s67, s67, 786432
    s_waitcnt vmcnt(10)
    s_barrier
    s_cmp_lt_u32 s3, 4
    s_cbranch_scc1 wl_309
    s_lshl_b32 s63, s66, 5
    v_xor_b32 v4, s63, v6
    v_add_u32 v4, 81920, v4
    v_add_u32 v5, 0x8000, v4
    v_add_u32 v5, 0x8000, v5
    ds_read_b64_tr_b16 v[176:177], v4 offset:0
    ds_read_b64_tr_b16 v[178:179], v4 offset:256
    ds_read_b64_tr_b16 v[180:181], v4 offset:4096
    ds_read_b64_tr_b16 v[182:183], v4 offset:4352
    ds_read_b64_tr_b16 v[184:185], v4 offset:8192
    ds_read_b64_tr_b16 v[186:187], v4 offset:8448
    ds_read_b64_tr_b16 v[188:189], v4 offset:12288
    ds_read_b64_tr_b16 v[190:191], v4 offset:12544
    ds_read_b64_tr_b16 v[192:193], v4 offset:16384
    ds_read_b64_tr_b16 v[194:195], v4 offset:16640
    ds_read_b64_tr_b16 v[196:197], v4 offset:20480
    ds_read_b64_tr_b16 v[198:199], v4 offset:20736
    s_waitcnt lgkmcnt(4)
    ds_read_b64_tr_b16 v[200:201], v4 offset:24576
    ds_read_b64_tr_b16 v[202:203], v4 offset:24832
    ds_read_b64_tr_b16 v[204:205], v4 offset:28672
    ds_read_b64_tr_b16 v[206:207], v4 offset:28928
    ds_read_b64_tr_b16 v[208:209], v4 offset:32768
    ds_read_b64_tr_b16 v[210:211], v4 offset:33024
    ds_read_b64_tr_b16 v[212:213], v4 offset:36864
    ds_read_b64_tr_b16 v[214:215], v4 offset:37120
    ds_read_b64_tr_b16 v[216:217], v4 offset:40960
    ds_read_b64_tr_b16 v[218:219], v4 offset:41216
    ds_read_b64_tr_b16 v[220:221], v4 offset:45056
    ds_read_b64_tr_b16 v[222:223], v4 offset:45312
    s_waitcnt lgkmcnt(4)
    ds_read_b64_tr_b16 v[224:225], v4 offset:49152
    ds_read_b64_tr_b16 v[226:227], v4 offset:49408
    ds_read_b64_tr_b16 v[228:229], v4 offset:53248
    ds_read_b64_tr_b16 v[230:231], v4 offset:53504
    ds_read_b64_tr_b16 v[232:233], v4 offset:57344
    ds_read_b64_tr_b16 v[234:235], v4 offset:57600
    ds_read_b64_tr_b16 v[236:237], v4 offset:61440
    ds_read_b64_tr_b16 v[238:239], v4 offset:61696
    ds_read_b64_tr_b16 v[240:241], v5 offset:0
    ds_read_b64_tr_b16 v[242:243], v5 offset:256
    ds_read_b64_tr_b16 v[244:245], v5 offset:4096
    ds_read_b64_tr_b16 v[246:247], v5 offset:4352
    s_waitcnt lgkmcnt(4)
    ds_read_b64_tr_b16 v[248:249], v5 offset:8192
    ds_read_b64_tr_b16 v[250:251], v5 offset:8448
    ds_read_b64_tr_b16 v[252:253], v5 offset:12288
    ds_read_b64_tr_b16 v[254:255], v5 offset:12544
    s_waitcnt lgkmcnt(0)
wl_309:
    s_barrier
    v_mov_b32 v58, 0
    buffer_load_dword v63, v58, s[56:59], s10 offen offset:128 sc1
    s_cmp_lt_u32 s5, 10
    s_cbranch_scc0 wsk_310
    s_mov_b32 s48, s26
    s_and_b32 s49, s27, 0xffff
    s_mov_b32 s50, 0x780000
    s_mov_b32 s51, 0x00020000
    s_lshl_b32 s63, s3, 10
    s_add_u32 s63, s63, 81920
    s_add_u32 s67, s65, 0
    s_mov_b32 m0, s63
    s_add_u32 s63, s63, 8192
    buffer_load_dwordx4 v3, s[48:51], s67 offen lds
    s_add_u32 s67, s67, 81920
    s_mov_b32 m0, s63
    s_add_u32 s63, s63, 8192
    buffer_load_dwordx4 v3, s[48:51], s67 offen lds
    s_add_u32 s67, s67, 81920
    s_mov_b32 m0, s63
    s_add_u32 s63, s63, 8192
    buffer_load_dwordx4 v3, s[48:51], s67 offen lds
    s_add_u32 s67, s67, 81920
    s_mov_b32 m0, s63
    s_add_u32 s63, s63, 8192
    buffer_load_dwordx4 v3, s[48:51], s67 offen lds
    s_add_u32 s67, s67, 81920
    s_mov_b32 m0, s63
    s_add_u32 s63, s63, 8192
    buffer_load_dwordx4 v3, s[48:51], s67 offen lds
    s_add_u32 s67, s67, 81920
    s_mov_b32 m0, s63
    s_add_u32 s63, s63, 8192
    buffer_load_dwordx4 v3, s[48:51], s67 offen lds
    s_add_u32 s67, s67, 81920
    s_mov_b32 m0, s63
    s_add_u32 s63, s63, 8192
    buffer_load_dwordx4 v3, s[48:51], s67 offen lds
    s_add_u32 s67, s67, 81920
    s_mov_b32 m0, s63
    s_add_u32 s63, s63, 8192
    buffer_load_dwordx4 v3, s[48:51], s67 offen lds
    s_add_u32 s67, s67, 81920
    s_mov_b32 m0, s63
    s_add_u32 s63, s63, 8192
    buffer_load_dwordx4 v3, s[48:51], s67 offen lds
    s_add_u32 s67, s67, 81920
    s_mov_b32 m0, s63
    s_add_u32 s63, s63, 8192
    buffer_load_dwordx4 v3, s[48:51], s67 offen lds
    s_add_u32 s67, s67, 81920
    s_waitcnt vmcnt(10)
    s_branch wsk_311
wsk_310:
    s_waitcnt vmcnt(0)
wsk_311:
    s_barrier
    s_cmp_lt_u32 s3, 4
    s_cbranch_scc0 wl_312
    s_lshl_b32 s63, s66, 5
    v_xor_b32 v4, s63, v6
    v_add_u32 v4, 0, v4
    v_add_u32 v5, 0x8000, v4
    v_add_u32 v5, 0x8000, v5
    ds_read_b64_tr_b16 v[96:97], v4 offset:0
    ds_read_b64_tr_b16 v[98:99], v4 offset:256
    ds_read_b64_tr_b16 v[100:101], v4 offset:4096
    ds_read_b64_tr_b16 v[102:103], v4 offset:4352
    ds_read_b64_tr_b16 v[104:105], v4 offset:8192
    ds_read_b64_tr_b16 v[106:107], v4 offset:8448
    ds_read_b64_tr_b16 v[108:109], v4 offset:12288
    ds_read_b64_tr_b16 v[110:111], v4 offset:12544
    ds_read_b64_tr_b16 v[112:113], v4 offset:16384
    ds_read_b64_tr_b16 v[114:115], v4 offset:16640
    ds_read_b64_tr_b16 v[116:117], v4 offset:20480
    ds_read_b64_tr_b16 v[118:119], v4 offset:20736
    s_waitcnt lgkmcnt(4)
    ds_read_b64_tr_b16 v[120:121], v4 offset:24576
    ds_read_b64_tr_b16 v[122:123], v4 offset:24832
    ds_read_b64_tr_b16 v[124:125], v4 offset:28672
    ds_read_b64_tr_b16 v[126:127], v4 offset:28928
    ds_read_b64_tr_b16 v[128:129], v4 offset:32768
    ds_read_b64_tr_b16 v[130:131], v4 offset:33024
    ds_read_b64_tr_b16 v[132:133], v4 offset:36864
    ds_read_b64_tr_b16 v[134:135], v4 offset:37120
    ds_read_b64_tr_b16 v[136:137], v4 offset:40960
    ds_read_b64_tr_b16 v[138:139], v4 offset:41216
    ds_read_b64_tr_b16 v[140:141], v4 offset:45056
    ds_read_b64_tr_b16 v[142:143], v4 offset:45312
    s_waitcnt lgkmcnt(4)
    ds_read_b64_tr_b16 v[144:145], v4 offset:49152
    ds_read_b64_tr_b16 v[146:147], v4 offset:49408
    ds_read_b64_tr_b16 v[148:149], v4 offset:53248
    ds_read_b64_tr_b16 v[150:151], v4 offset:53504
    ds_read_b64_tr_b16 v[152:153], v4 offset:57344
    ds_read_b64_tr_b16 v[154:155], v4 offset:57600
    ds_read_b64_tr_b16 v[156:157], v4 offset:61440
    ds_read_b64_tr_b16 v[158:159], v4 offset:61696
    ds_read_b64_tr_b16 v[160:161], v5 offset:0
    ds_read_b64_tr_b16 v[162:163], v5 offset:256
    ds_read_b64_tr_b16 v[164:165], v5 offset:4096
    ds_read_b64_tr_b16 v[166:167], v5 offset:4352
    s_waitcnt lgkmcnt(4)
    ds_read_b64_tr_b16 v[168:169], v5 offset:8192
    ds_read_b64_tr_b16 v[170:171], v5 offset:8448
    ds_read_b64_tr_b16 v[172:173], v5 offset:12288
    ds_read_b64_tr_b16 v[174:175], v5 offset:12544
    s_waitcnt lgkmcnt(0)
wl_312:
    s_barrier
    s_cmp_lt_u32 s5, 10
    s_cbranch_scc0 wsk_313
    s_mov_b32 s48, s26
    s_and_b32 s49, s27, 0xffff
    s_mov_b32 s50, 0x780000
    s_mov_b32 s51, 0x00020000
    s_lshl_b32 s63, s3, 10
    s_add_u32 s63, s63, 0
    s_add_u32 s67, s65, 819200
    s_mov_b32 m0, s63
    s_add_u32 s63, s63, 8192
    buffer_load_dwordx4 v3, s[48:51], s67 offen lds
    s_add_u32 s67, s67, 81920
    s_mov_b32 m0, s63
    s_add_u32 s63, s63, 8192
    buffer_load_dwordx4 v3, s[48:51], s67 offen lds
    s_add_u32 s67, s67, 81920
wsk_313:
    v_mov_b32 v58, 0
    buffer_load_dwordx2 v[60:61], v58, s[56:59], s10 offen offset:128 sc1
    s_lshl_b32 s63, s60, 3
    s_add_u32 s63, s63, s4
    s_lshl_b32 s63, s63, 7
    s_add_u32 s63, s63, 156807168
    v_min_u32 v59, 1, v1
    v_lshlrev_b32 v59, 12, v59
    v_add_u32 v59, s63, v59
    buffer_load_dword v62, v59, s[44:47], 0 offen sc1
    s_waitcnt vmcnt(0)
    s_barrier
    s_cmp_lt_u32 s3, 4
    s_cbranch_scc1 wl_314
    s_lshl_b32 s63, s66, 5
    v_xor_b32 v7, s63, v6
    s_mul_i32 s67, s66, 3
    s_add_u32 s63, s67, 0
    s_cmp_ge_u32 s63, 12
    s_cselect_b32 s70, 12, 0
    s_sub_u32 s63, s63, s70
    s_cmp_ge_u32 s63, 10
    s_cselect_b32 s70, 0, 20
    s_add_u32 s63, s63, s70
    s_sub_u32 s63, s63, 10
    s_lshl_b32 s63, s63, 13
    v_add_u32 v5, s63, v7
    ds_read_b64_tr_b16 v[80:81], v5 offset:0
    ds_read_b64_tr_b16 v[82:83], v5 offset:256
    ds_read_b64_tr_b16 v[84:85], v5 offset:4096
    ds_read_b64_tr_b16 v[86:87], v5 offset:4352
    s_waitcnt lgkmcnt(4)
    s_add_u32 s63, s67, 1
    s_cmp_ge_u32 s63, 12
    s_cselect_b32 s70, 12, 0
    s_sub_u32 s63, s63, s70
    s_cmp_ge_u32 s63, 10
    s_cselect_b32 s70, 0, 20
    s_add_u32 s63, s63, s70
    s_sub_u32 s63, s63, 10
    s_lshl_b32 s63, s63, 13
    v_add_u32 v5, s63, v7
    ds_read_b64_tr_b16 v[88:89], v5 offset:0
    ds_read_b64_tr_b16 v[90:91], v5 offset:256
    ds_read_b64_tr_b16 v[92:93], v5 offset:4096
    ds_read_b64_tr_b16 v[94:95], v5 offset:4352
    s_waitcnt lgkmcnt(4)
    s_add_u32 s63, s67, 2
    s_cmp_ge_u32 s63, 12
    s_cselect_b32 s70, 12, 0
    s_sub_u32 s63, s63, s70
    s_cmp_ge_u32 s63, 10
    s_cselect_b32 s70, 0, 20
    s_add_u32 s63, s63, s70
    s_sub_u32 s63, s63, 10
    s_lshl_b32 s63, s63, 13
    v_add_u32 v5, s63, v7
    ds_read_b64_tr_b16 v[96:97], v5 offset:0
    ds_read_b64_tr_b16 v[98:99], v5 offset:256
    ds_read_b64_tr_b16 v[100:101], v5 offset:4096
    ds_read_b64_tr_b16 v[102:103], v5 offset:4352
    s_waitcnt lgkmcnt(4)
    s_add_u32 s63, s67, 3
    s_cmp_ge_u32 s63, 12
    s_cselect_b32 s70, 12, 0
    s_sub_u32 s63, s63, s70
    s_cmp_ge_u32 s63, 10
    s_cselect_b32 s70, 0, 20
    s_add_u32 s63, s63, s70
    s_sub_u32 s63, s63, 10
    s_lshl_b32 s63, s63, 13
    v_add_u32 v5, s63, v7
    ds_read_b64_tr_b16 v[104:105], v5 offset:0
    ds_read_b64_tr_b16 v[106:107], v5 offset:256
    ds_read_b64_tr_b16 v[108:109], v5 offset:4096
    ds_read_b64_tr_b16 v[110:111], v5 offset:4352
    s_waitcnt lgkmcnt(4)
    s_add_u32 s63, s67, 4
    s_cmp_ge_u32 s63, 12
    s_cselect_b32 s70, 12, 0
    s_sub_u32 s63, s63, s70
    s_cmp_ge_u32 s63, 10
    s_cselect_b32 s70, 0, 20
    s_add_u32 s63, s63, s70
    s_sub_u32 s63, s63, 10
    s_lshl_b32 s63, s63, 13
    v_add_u32 v5, s63, v7
    ds_read_b64_tr_b16 v[112:113], v5 offset:0
    ds_read_b64_tr_b16 v[114:115], v5 offset:256
    ds_read_b64_tr_b16 v[116:117], v5 offset:4096
    ds_read_b64_tr_b16 v[118:119], v5 offset:4352
    s_waitcnt lgkmcnt(4)
    s_add_u32 s63, s67, 5
    s_cmp_ge_u32 s63, 12
    s_cselect_b32 s70, 12, 0
    s_sub_u32 s63, s63, s70
    s_cmp_ge_u32 s63, 10
    s_cselect_b32 s70, 0, 20
    s_add_u32 s63, s63, s70
    s_sub_u32 s63, s63, 10
    s_lshl_b32 s63, s63, 13
    v_add_u32 v5, s63, v7
    ds_read_b64_tr_b16 v[120:121], v5 offset:0
    ds_read_b64_tr_b16 v[122:123], v5 offset:256
    ds_read_b64_tr_b16 v[124:125], v5 offset:4096
    ds_read_b64_tr_b16 v[126:127], v5 offset:4352
    s_waitcnt lgkmcnt(4)
    s_add_u32 s63, s67, 6
    s_cmp_ge_u32 s63, 12
    s_cselect_b32 s70, 12, 0
    s_sub_u32 s63, s63, s70
    s_cmp_ge_u32 s63, 10
    s_cselect_b32 s70, 0, 20
    s_add_u32 s63, s63, s70
    s_sub_u32 s63, s63, 10
    s_lshl_b32 s63, s63, 13
    v_add_u32 v5, s63, v7
    ds_read_b64_tr_b16 v[128:129], v5 offset:0
    ds_read_b64_tr_b16 v[130:131], v5 offset:256
    ds_read_b64_tr_b16 v[132:133], v5 offset:4096
    ds_read_b64_tr_b16 v[134:135], v5 offset:4352
    s_waitcnt lgkmcnt(4)
    s_add_u32 s63, s67, 7
    s_cmp_ge_u32 s63, 12
    s_cselect_b32 s70, 12, 0
    s_sub_u32 s63, s63, s70
    s_cmp_ge_u32 s63, 10
    s_cselect_b32 s70, 0, 20
    s_add_u32 s63, s63, s70
    s_sub_u32 s63, s63, 10
    s_lshl_b32 s63, s63, 13
    v_add_u32 v5, s63, v7
    ds_read_b64_tr_b16 v[136:137], v5 offset:0
    ds_read_b64_tr_b16 v[138:139], v5 offset:256
    ds_read_b64_tr_b16 v[140:141], v5 offset:4096
    ds_read_b64_tr_b16 v[142:143], v5 offset:4352
    s_waitcnt lgkmcnt(4)
    s_add_u32 s63, s67, 8
    s_cmp_ge_u32 s63, 12
    s_cselect_b32 s70, 12, 0
    s_sub_u32 s63, s63, s70
    s_cmp_ge_u32 s63, 10
    s_cselect_b32 s70, 0, 20
    s_add_u32 s63, s63, s70
    s_sub_u32 s63, s63, 10
    s_lshl_b32 s63, s63, 13
    v_add_u32 v5, s63, v7
    ds_read_b64_tr_b16 v[144:145], v5 offset:0
    ds_read_b64_tr_b16 v[146:147], v5 offset:256
    ds_read_b64_tr_b16 v[148:149], v5 offset:4096
    ds_read_b64_tr_b16 v[150:151], v5 offset:4352
    s_waitcnt lgkmcnt(4)
    s_add_u32 s63, s67, 9
    s_cmp_ge_u32 s63, 12
    s_cselect_b32 s70, 12, 0
    s_sub_u32 s63, s63, s70
    s_cmp_ge_u32 s63, 10
    s_cselect_b32 s70, 0, 20
    s_add_u32 s63, s63, s70
    s_sub_u32 s63, s63, 10
    s_lshl_b32 s63, s63, 13
    v_add_u32 v5, s63, v7
    ds_read_b64_tr_b16 v[152:153], v5 offset:0
    ds_read_b64_tr_b16 v[154:155], v5 offset:256
    ds_read_b64_tr_b16 v[156:157], v5 offset:4096
    ds_read_b64_tr_b16 v[158:159], v5 offset:4352
    s_waitcnt lgkmcnt(4)
    s_add_u32 s63, s67, 10
    s_cmp_ge_u32 s63, 12
    s_cselect_b32 s70, 12, 0
    s_sub_u32 s63, s63, s70
    s_cmp_ge_u32 s63, 10
    s_cselect_b32 s70, 0, 20
    s_add_u32 s63, s63, s70
    s_sub_u32 s63, s63, 10
    s_lshl_b32 s63, s63, 13
    v_add_u32 v5, s63, v7
    ds_read_b64_tr_b16 v[160:161], v5 offset:0
    ds_read_b64_tr_b16 v[162:163], v5 offset:256
    ds_read_b64_tr_b16 v[164:165], v5 offset:4096
    ds_read_b64_tr_b16 v[166:167], v5 offset:4352
    s_waitcnt lgkmcnt(4)
    s_add_u32 s63, s67, 11
    s_cmp_ge_u32 s63, 12
    s_cselect_b32 s70, 12, 0
    s_sub_u32 s63, s63, s70
    s_cmp_ge_u32 s63, 10
    s_cselect_b32 s70, 0, 20
    s_add_u32 s63, s63, s70
    s_sub_u32 s63, s63, 10
    s_lshl_b32 s63, s63, 13
    v_add_u32 v5, s63, v7
    ds_read_b64_tr_b16 v[168:169], v5 offset:0
    ds_read_b64_tr_b16 v[170:171], v5 offset:256
    ds_read_b64_tr_b16 v[172:173], v5 offset:4096
    ds_read_b64_tr_b16 v[174:175], v5 offset:4352
    s_waitcnt lgkmcnt(4)
    s_waitcnt lgkmcnt(0)
wl_314:
    s_barrier
    v_mov_b32 v8, 0
    s_cmp_eq_u32 s3, 0
    s_cbranch_scc0 wao_317
    v_mov_b32 v9, v60
    v_readfirstlane_b32 s63, v60
    s_cmp_lg_u32 s63, 0
    s_cbranch_scc1 wad_316
    s_mov_b32 s76, 1000000
wa_315:
    buffer_load_dword v9, v8, s[56:59], s10 offen offset:128 sc1
    s_sub_u32 s76, s76, 1
    s_cbranch_scc1 wad_316
    s_waitcnt vmcnt(0)
    v_readfirstlane_b32 s63, v9
    s_cmp_lg_u32 s63, 0
    s_cbranch_scc1 wad_316
    s_sleep 2
    s_branch wa_315
wad_316:
    s_waitcnt vmcnt(0)
    ds_write_b32 v8, v9
    s_waitcnt lgkmcnt(0)
wao_317:
    s_barrier
    ds_read_b32 v9, v8
    s_waitcnt lgkmcnt(0)
    v_readfirstlane_b32 s63, v9
    s_cmp_lg_u32 s63, 1
    s_cselect_b32 s6, 1, 0
    s_waitcnt vmcnt(0)
    s_barrier
    s_cbranch_scc0 wak_318
    s_cmp_eq_u32 s10, 0
    s_mov_b32 s10, 16
    s_cbranch_scc1 L_restart
wak_318:
L_chain_code:
    s_cmp_lt_u32 s3, 4
    s_cbranch_scc0 chvo_319
    v_lshlrev_b32 v7, 4, v1
    s_lshl_b32 s63, s3, 10
    v_add_u32 v5, s63, v7
    s_and_b32 s63, s3, 1
    s_add_u32 s63, s63, 8
    s_lshl_b32 s63, s63, 10
    v_add_u32 v6, s63, v7
    s_lshr_b32 s63, s4, 1
    s_lshl_b32 s63, s63, 17
    s_add_u32 s63, s63, 156237824
    v_add_u32 v2, s63, v5
    v_add_u32 v3, 0x1000, v2
    v_add_u32 v4, s63, v6
    v_lshrrev_b32 v12, 4, v1
    v_mul_u32_u24 v8, 288, v12
    v_and_b32 v13, 15, v1
    v_lshlrev_b32 v14, 1, v13
    v_add_u32 v8, v8, v14
    s_lshl_b32 s63, s3, 5
    s_add_u32 s63, s63, 10240
    v_add_u32 v8, s63, v8
    v_and_b32 v14, 7, v1
    v_mul_u32_u24 v9, 144, v14
    v_lshlrev_b32 v15, 4, v12
    v_add_u32 v9, v9, v15
    v_add_u32 v9, 10240, v9
    v_bfe_u32 v10, v1, 2, 2
    v_lshlrev_b32 v10, 1, v10
    v_and_b32 v16, 1, v1
    v_add_u32 v10, v10, v16
    v_mul_u32_u24 v10, 144, v10
    v_add_u32 v10, v10, v15
    v_add_u32 v10, 11392, v10
    v_mov_b32 v52, 0x4444
    v_mov_b32 v17, 0xeeee
    v_cmp_eq_u32 vcc, 1, v16
    s_nop 1
    v_cndmask_b32 v52, v52, v17, vcc
    s_lshl_b32 s63, s4, 16
    s_lshl_b32 s67, s60, 12
    s_add_u32 s63, s63, s67
    s_add_u32 s63, s63, 155189248
    s_cmp_eq_u32 s3, 0
    s_cbranch_scc0 qs_320
    s_lshl_b32 s67, s61, 8
    s_add_u32 s63, s63, s67
    s_add_u32 s63, s63, 3072
    v_lshlrev_b32 v11, 2, v1
    v_add_u32 v11, s63, v11
    s_branch qs_321
    .p2align 6
qs_320:
    s_lshl_b32 s67, s61, 10
    s_add_u32 s63, s63, s67
    s_sub_u32 s67, s3, 1
    s_lshl_b32 s67, s67, 9
    s_add_u32 s63, s63, s67
    v_lshlrev_b32 v11, 3, v12
    v_add_u32 v11, v11, v14
    v_lshlrev_b32 v11, 4, v11
    v_add_u32 v11, s63, v11
    v_mov_b32 v17, 1073741824
    v_cmp_gt_u32 vcc, 8, v13
    s_nop 1
    v_cndmask_b32 v11, v17, v11, vcc
    .p2align 6
qs_321:
    v_cmp_le_u32 s[68:69], 8, v13
    s_mul_i32 s63, s62, 6
    s_lshl_b32 s67, s61, 1
    s_add_u32 s63, s63, s67
    s_lshl_b32 s63, s63, 10
    s_add_u32 s63, s63, 79691776
    v_add_u32 v0, s63, v7
    s_lshl_b32 s63, s3, 11
    s_add_u32 s63, s63, 14848
    v_add_u32 v53, s63, v7
    v_and_b32 v5, 0xfff, v11
    v_lshrrev_b32 v6, 18, v11
    v_and_b32 v6, 0x1000, v6
    v_add3_u32 v5, v5, v6, s63
    v_subrev_u32 v5, s63, v5
    v_add_u32 v5, 41472, v5
    s_mov_b32 s73, 0
    v_mov_b32 v32, 0
    v_mov_b32 v33, 0
    v_mov_b32 v34, 0
    v_mov_b32 v35, 0
    v_mov_b32 v36, 0
    v_mov_b32 v37, 0
    v_mov_b32 v38, 0
    v_mov_b32 v39, 0
    s_cmp_eq_u32 s3, 3
    s_cbranch_scc0 q3_322
    s_lshl_b32 s63, s4, 7
    s_add_u32 s63, s63, 156764160
    s_lshl_b32 s64, s60, 3
    v_lshlrev_b32 v0, 2, v1
    v_add_u32 v0, s64, v0
    s_lshl_b32 s64, s5, 2
    s_add_u32 s64, s64, 32
    v_mov_b32 v40, s64
    v_cmp_gt_u32 vcc, 2, v1
    s_nop 1
    v_cndmask_b32 v0, v40, v0, vcc
    v_add_u32 v0, s63, v0
    s_mov_b32 s86, 0
    s_mov_b32 s87, 2
    v_readfirstlane_b32 s86, v63
    s_cmp_eq_u32 s86, 0
    s_cbranch_scc1 k0_324
    v_cmp_gt_u32 vcc, s87, v62
    s_cbranch_vccz k0_323
k0_324:
    s_lshl_b32 s63, s60, 3
    s_add_u32 s63, s63, s4
    s_lshl_b32 s63, s63, 7
    s_add_u32 s63, s63, 156807168
    v_min_u32 v42, 1, v1
    v_lshlrev_b32 v42, 12, v42
    v_add_u32 v42, s63, v42
    s_mov_b32 s86, 0
    s_cmp_ge_u32 s86, s87
    s_cbranch_scc1 fwd_326
    s_mov_b32 s76, 4000000
fw_325:
    buffer_load_dword v40, v42, s[44:47], 0 offen sc1
    s_sub_u32 s76, s76, 1
    s_cbranch_scc1 fwd_326
    s_waitcnt vmcnt(0)
    v_cmp_gt_u32 vcc, s87, v40
    s_cbranch_vccz fwo_327
    s_sleep 2
    s_branch fw_325
fwo_327:
    s_mov_b32 s86, s87
fwd_326:
k0_323:
    s_mov_b32 s86, 0
q3_322:
    v_mov_b32 v40, -1
    v_mov_b32 v41, -1
    v_mov_b32 v42, -1
    v_mov_b32 v43, -1
    v_mov_b32 v44, -1
    v_mov_b32 v45, -1
    v_mov_b32 v46, -1
    v_mov_b32 v47, -1
    v_mov_b32 v48, -1
    v_mov_b32 v49, -1
    v_mov_b32 v50, -1
    v_mov_b32 v51, -1
    s_barrier
    s_setprio 3
    s_lshl_b32 s63, s6, 2
    s_add_u32 s63, s63, s3
    s_cmp_eq_u32 s63, 1
    s_cbranch_scc1 qk01_329
    s_cmp_eq_u32 s63, 2
    s_cbranch_scc1 qk02_330
    s_cmp_eq_u32 s63, 3
    s_cbranch_scc1 qk03_331
    s_cmp_eq_u32 s63, 4
    s_cbranch_scc1 qk10_332
    s_cmp_eq_u32 s63, 5
    s_cbranch_scc1 qk11_333
    s_cmp_eq_u32 s63, 6
    s_cbranch_scc1 qk12_334
    s_cmp_eq_u32 s63, 7
    s_cbranch_scc1 qk13_335
qk00_328:
qkloop_336:
    s_and_b32 s72, s73, 3
    s_lshl_b32 s72, s72, 14
    s_sleep 2
    s_mov_b32 s76, 30000
    buffer_load_dwordx4 v[40:43], v2, s[44:47], s72 offen sc1
    buffer_load_dwordx4 v[44:47], v3, s[44:47], s72 offen sc1
    buffer_load_dwordx4 v[48:51], v4, s[44:47], s72 offen sc1
    s_sleep 3
poll_338:
    buffer_load_dwordx4 v[40:43], v2, s[44:47], s72 offen sc1
    buffer_load_dwordx4 v[44:47], v3, s[44:47], s72 offen sc1
    buffer_load_dwordx4 v[48:51], v4, s[44:47], s72 offen sc1
    s_sub_u32 s76, s76, 1
    s_cbranch_scc1 pd_339
    s_waitcnt vmcnt(3)
    v_max3_u32 v54, v40, v41, v42
    v_max3_u32 v54, v54, v43, v44
    v_max3_u32 v54, v54, v45, v46
    v_max3_u32 v54, v54, v47, v48
    v_max3_u32 v54, v54, v49, v50
    v_max_u32 v54, v54, v51
    v_cmp_eq_u32 vcc, -1, v54
    s_cbranch_vccnz poll_338
pd_339:
    ds_write_b128 v7, v[40:43] offset:0
    ds_write_b128 v7, v[44:47] offset:4096
    ds_write_b128 v7, v[48:51] offset:8192
    s_waitcnt lgkmcnt(0)
    s_barrier
    ds_read_b128 v[56:59], v7 offset:1024
    ds_read_b128 v[60:63], v7 offset:2048
    ds_read_b128 v[64:67], v7 offset:3072
    ds_read_b128 v[68:71], v7 offset:5120
    ds_read_b128 v[72:75], v7 offset:6144
    ds_read_b128 v[76:79], v7 offset:7168
    ds_read_b128 v[80:83], v7 offset:9216
    v_smfmac_f32_16x16x64_bf16 v[32:35], v[40:43], v[96:103], v52
    v_smfmac_f32_16x16x64_bf16 v[36:39], v[40:43], v[176:183], v52
    v_smfmac_f32_16x16x64_bf16 v[32:35], v[44:47], v[128:135], v52
    v_smfmac_f32_16x16x64_bf16 v[36:39], v[44:47], v[208:215], v52
    v_smfmac_f32_16x16x64_bf16 v[32:35], v[48:51], v[160:167], v52
    v_smfmac_f32_16x16x64_bf16 v[36:39], v[48:51], v[240:247], v52
    s_waitcnt lgkmcnt(6)
    v_smfmac_f32_16x16x64_bf16 v[32:35], v[56:59], v[104:111], v52
    s_waitcnt lgkmcnt(5)
    v_smfmac_f32_16x16x64_bf16 v[32:35], v[60:63], v[112:119], v52
    s_waitcnt lgkmcnt(4)
    v_smfmac_f32_16x16x64_bf16 v[32:35], v[64:67], v[120:127], v52
    s_waitcnt lgkmcnt(3)
    v_smfmac_f32_16x16x64_bf16 v[32:35], v[68:71], v[136:143], v52
    s_waitcnt lgkmcnt(2)
    v_smfmac_f32_16x16x64_bf16 v[32:35], v[72:75], v[144:151], v52
    s_waitcnt lgkmcnt(1)
    v_smfmac_f32_16x16x64_bf16 v[32:35], v[76:79], v[152:159], v52
    s_waitcnt lgkmcnt(0)
    v_smfmac_f32_16x16x64_bf16 v[32:35], v[80:83], v[168:175], v52
    v_smfmac_f32_16x16x64_bf16 v[36:39], v[56:59], v[184:191], v52
    s_nop 0
    v_smfmac_f32_16x16x64_bf16 v[36:39], v[60:63], v[192:199], v52
    s_nop 0
    v_smfmac_f32_16x16x64_bf16 v[36:39], v[64:67], v[200:207], v52
    s_nop 0
    v_smfmac_f32_16x16x64_bf16 v[36:39], v[68:71], v[216:223], v52
    s_nop 0
    v_smfmac_f32_16x16x64_bf16 v[36:39], v[72:75], v[224:231], v52
    v_add_f32 v32, v32, v33
    v_add_f32 v34, v34, v35
    v_smfmac_f32_16x16x64_bf16 v[36:39], v[76:79], v[232:239], v52
    v_cvt_pk_bf16_f32 v54, v32, v34
    v_smfmac_f32_16x16x64_bf16 v[36:39], v[80:83], v[248:255], v52
    ds_write_b16 v8, v54
    ds_write_b16_d16_hi v8, v54 offset:144
    s_nop 5
    v_add_f32 v36, v36, v37
    v_add_f32 v38, v38, v39
    v_cvt_pk_bf16_f32 v55, v36, v38
    ds_write_b16 v8, v55 offset:1152
    ds_write_b16_d16_hi v8, v55 offset:1296
    s_waitcnt lgkmcnt(0)
    s_barrier
    ds_read_b128 v[16:19], v9
    ds_read_b128 v[24:27], v10
    ds_read_b128 v[20:23], v9 offset:64
    ds_read_b128 v[28:31], v10 offset:64
    s_waitcnt lgkmcnt(2)
    v_mfma_f32_16x16x32_bf16 v[12:15], v[24:27], v[16:19], 0
    s_waitcnt lgkmcnt(0)
    v_mfma_f32_16x16x32_bf16 v[12:15], v[28:31], v[20:23], v[12:15]
    s_nop 7
    v_cndmask_b32 v54, v12, v13, s[68:69]
    buffer_store_dword v54, v11, s[44:47], s72 offen
    ds_write_b32 v5, v54
    s_waitcnt lgkmcnt(0)
    s_barrier
    s_cmp_eq_u32 s73, 63
    s_cbranch_scc1 qkdone_337
    s_cmp_ge_u32 s73, 52
    s_cbranch_scc0 ks_340
    s_and_b32 s74, s73, 7
    s_mul_i32 s74, s74, 196608
    buffer_store_dwordx4 v[24:27], v0, s[44:47], s74 offen
    buffer_store_dwordx4 v[28:31], v0, s[44:47], s74 offen offset:1024
ks_340:
    v_mov_b32 v32, 0
    v_mov_b32 v33, 0
    v_mov_b32 v34, 0
    v_mov_b32 v35, 0
    v_mov_b32 v36, 0
    v_mov_b32 v37, 0
    v_mov_b32 v38, 0
    v_mov_b32 v39, 0
    s_add_u32 s72, s73, 2
    s_and_b32 s72, s72, 3
    s_lshl_b32 s72, s72, 14
    v_mov_b32 v12, -1
    v_mov_b32 v13, -1
    v_mov_b32 v14, -1
    v_mov_b32 v15, -1
    s_waitcnt vmcnt(0)
    v_mov_b32 v40, -1
    v_mov_b32 v41, -1
    v_mov_b32 v42, -1
    v_mov_b32 v43, -1
    v_mov_b32 v44, -1
    v_mov_b32 v45, -1
    v_mov_b32 v46, -1
    v_mov_b32 v47, -1
    v_mov_b32 v48, -1
    v_mov_b32 v49, -1
    v_mov_b32 v50, -1
    v_mov_b32 v51, -1
    s_barrier
    s_cmp_ge_u32 s73, 52
    s_cbranch_scc1 ks_341
    s_and_b32 s74, s73, 7
    s_mul_i32 s74, s74, 196608
    buffer_store_dwordx4 v[24:27], v0, s[44:47], s74 offen
    buffer_store_dwordx4 v[28:31], v0, s[44:47], s74 offen offset:1024
ks_341:
    buffer_store_dword v12, v11, s[44:47], s72 offen
    s_add_u32 s73, s73, 1
    s_waitcnt vmcnt(0)
    s_barrier
    s_branch qkloop_336
qkdone_337:
    s_mov_b32 s74, s73
    s_mul_i32 s74, s74, 196608
    v_lshrrev_b32 v56, 2, v1
    v_lshlrev_b32 v56, 5, v56
    v_and_b32 v57, 1, v1
    v_lshlrev_b32 v57, 4, v57
    v_add_u32 v56, v56, v57
    v_and_b32 v57, 2, v1
    v_lshlrev_b32 v57, 29, v57
    v_add_u32 v56, v56, v57
    s_mul_i32 s75, s62, 6144
    s_add_u32 s74, s74, s75
    s_lshl_b32 s75, s61, 10
    s_add_u32 s74, s74, s75
    s_add_u32 s74, s74, 167772160
    v_min_u32 v24, -2, v24
    v_min_u32 v25, -2, v25
    v_min_u32 v26, -2, v26
    v_min_u32 v27, -2, v27
    v_min_u32 v28, -2, v28
    v_min_u32 v29, -2, v29
    v_min_u32 v30, -2, v30
    v_min_u32 v31, -2, v31
    buffer_store_dwordx4 v[24:27], v56, s[44:47], s74 offen sc1
    buffer_store_dwordx4 v[28:31], v56, s[44:47], s74 offen offset:512 sc1
    s_waitcnt vmcnt(0)
    s_barrier
    s_endpgm
qk01_329:
qkloop_342:
    s_and_b32 s72, s73, 3
    s_lshl_b32 s72, s72, 14
    s_and_b32 s75, s73, 1
    s_lshl_b32 s75, s75, 13
    v_add_u32 v54, s75, v53
    ds_read_b128 v[24:27], v54
    ds_read_b128 v[28:31], v54 offset:1024
    s_sleep 2
    s_mov_b32 s76, 30000
    buffer_load_dwordx4 v[40:43], v2, s[44:47], s72 offen sc1
    buffer_load_dwordx4 v[44:47], v3, s[44:47], s72 offen sc1
    buffer_load_dwordx4 v[48:51], v4, s[44:47], s72 offen sc1
    s_sleep 3
poll_344:
    buffer_load_dwordx4 v[40:43], v2, s[44:47], s72 offen sc1
    buffer_load_dwordx4 v[44:47], v3, s[44:47], s72 offen sc1
    buffer_load_dwordx4 v[48:51], v4, s[44:47], s72 offen sc1
    s_sub_u32 s76, s76, 1
    s_cbranch_scc1 pd_345
    s_waitcnt vmcnt(3)
    v_max3_u32 v54, v40, v41, v42
    v_max3_u32 v54, v54, v43, v44
    v_max3_u32 v54, v54, v45, v46
    v_max3_u32 v54, v54, v47, v48
    v_max3_u32 v54, v54, v49, v50
    v_max_u32 v54, v54, v51
    v_cmp_eq_u32 vcc, -1, v54
    s_cbranch_vccnz poll_344
pd_345:
    ds_write_b128 v7, v[40:43] offset:1024
    ds_write_b128 v7, v[44:47] offset:5120
    ds_write_b128 v7, v[48:51] offset:9216
    s_waitcnt lgkmcnt(0)
    s_barrier
    ds_read_b128 v[56:59], v7 offset:0
    ds_read_b128 v[60:63], v7 offset:2048
    ds_read_b128 v[64:67], v7 offset:3072
    ds_read_b128 v[68:71], v7 offset:4096
    ds_read_b128 v[72:75], v7 offset:6144
    ds_read_b128 v[76:79], v7 offset:7168
    ds_read_b128 v[80:83], v7 offset:8192
    v_smfmac_f32_16x16x64_bf16 v[32:35], v[40:43], v[104:111], v52
    v_smfmac_f32_16x16x64_bf16 v[36:39], v[40:43], v[184:191], v52
    v_smfmac_f32_16x16x64_bf16 v[32:35], v[44:47], v[136:143], v52
    v_smfmac_f32_16x16x64_bf16 v[36:39], v[44:47], v[216:223], v52
    v_smfmac_f32_16x16x64_bf16 v[32:35], v[48:51], v[168:175], v52
    v_smfmac_f32_16x16x64_bf16 v[36:39], v[48:51], v[248:255], v52
    s_waitcnt lgkmcnt(6)
    v_smfmac_f32_16x16x64_bf16 v[32:35], v[56:59], v[96:103], v52
    s_waitcnt lgkmcnt(5)
    v_smfmac_f32_16x16x64_bf16 v[32:35], v[60:63], v[112:119], v52
    s_waitcnt lgkmcnt(4)
    v_smfmac_f32_16x16x64_bf16 v[32:35], v[64:67], v[120:127], v52
    s_waitcnt lgkmcnt(3)
    v_smfmac_f32_16x16x64_bf16 v[32:35], v[68:71], v[128:135], v52
    s_waitcnt lgkmcnt(2)
    v_smfmac_f32_16x16x64_bf16 v[32:35], v[72:75], v[144:151], v52
    s_waitcnt lgkmcnt(1)
    v_smfmac_f32_16x16x64_bf16 v[32:35], v[76:79], v[152:159], v52
    s_waitcnt lgkmcnt(0)
    v_smfmac_f32_16x16x64_bf16 v[32:35], v[80:83], v[160:167], v52
    v_smfmac_f32_16x16x64_bf16 v[36:39], v[56:59], v[176:183], v52
    s_nop 0
    v_smfmac_f32_16x16x64_bf16 v[36:39], v[60:63], v[192:199], v52
    s_nop 0
    v_smfmac_f32_16x16x64_bf16 v[36:39], v[64:67], v[200:207], v52
    s_nop 0
    v_smfmac_f32_16x16x64_bf16 v[36:39], v[68:71], v[208:215], v52
    s_nop 0
    v_smfmac_f32_16x16x64_bf16 v[36:39], v[72:75], v[224:231], v52
    v_add_f32 v32, v32, v33
    v_add_f32 v34, v34, v35
    v_smfmac_f32_16x16x64_bf16 v[36:39], v[76:79], v[232:239], v52
    v_cvt_pk_bf16_f32 v54, v32, v34
    v_smfmac_f32_16x16x64_bf16 v[36:39], v[80:83], v[240:247], v52
    ds_write_b16 v8, v54
    ds_write_b16_d16_hi v8, v54 offset:144
    s_nop 5
    v_add_f32 v36, v36, v37
    v_add_f32 v38, v38, v39
    v_cvt_pk_bf16_f32 v55, v36, v38
    ds_write_b16 v8, v55 offset:1152
    ds_write_b16_d16_hi v8, v55 offset:1296
    s_waitcnt lgkmcnt(0)
    s_barrier
    ds_read_b128 v[16:19], v9
    ds_read_b128 v[20:23], v9 offset:64
    s_waitcnt lgkmcnt(1)
    v_mfma_f32_16x16x32_bf16 v[12:15], v[24:27], v[16:19], 0
    s_waitcnt lgkmcnt(0)
    v_mfma_f32_16x16x32_bf16 v[12:15], v[28:31], v[20:23], v[12:15]
    s_nop 7
    buffer_store_dwordx4 v[12:15], v11, s[44:47], s72 offen
    ds_write_b128 v5, v[12:15]
    s_waitcnt lgkmcnt(0)
    s_barrier
    s_cmp_eq_u32 s73, 63
    s_cbranch_scc1 qkdone_343
    v_mov_b32 v32, 0
    v_mov_b32 v33, 0
    v_mov_b32 v34, 0
    v_mov_b32 v35, 0
    v_mov_b32 v36, 0
    v_mov_b32 v37, 0
    v_mov_b32 v38, 0
    v_mov_b32 v39, 0
    s_add_u32 s72, s73, 2
    s_and_b32 s72, s72, 3
    s_lshl_b32 s72, s72, 14
    v_mov_b32 v12, -1
    v_mov_b32 v13, -1
    v_mov_b32 v14, -1
    v_mov_b32 v15, -1
    s_waitcnt vmcnt(0)
    v_mov_b32 v40, -1
    v_mov_b32 v41, -1
    v_mov_b32 v42, -1
    v_mov_b32 v43, -1
    v_mov_b32 v44, -1
    v_mov_b32 v45, -1
    v_mov_b32 v46, -1
    v_mov_b32 v47, -1
    v_mov_b32 v48, -1
    v_mov_b32 v49, -1
    v_mov_b32 v50, -1
    v_mov_b32 v51, -1
    s_barrier
    buffer_store_dwordx4 v[12:15], v11, s[44:47], s72 offen
    s_add_u32 s73, s73, 1
    s_waitcnt vmcnt(0)
    s_barrier
    s_branch qkloop_342
qkdone_343:
    s_waitcnt vmcnt(0)
    s_barrier
    s_endpgm
qk02_330:
qkloop_346:
    s_and_b32 s72, s73, 3
    s_lshl_b32 s72, s72, 14
    s_and_b32 s75, s73, 1
    s_lshl_b32 s75, s75, 13
    v_add_u32 v54, s75, v53
    ds_read_b128 v[24:27], v54
    ds_read_b128 v[28:31], v54 offset:1024
    s_sleep 2
    s_mov_b32 s76, 30000
    buffer_load_dwordx4 v[40:43], v2, s[44:47], s72 offen sc1
    buffer_load_dwordx4 v[44:47], v3, s[44:47], s72 offen sc1
    s_sleep 3
poll_348:
    buffer_load_dwordx4 v[40:43], v2, s[44:47], s72 offen sc1
    buffer_load_dwordx4 v[44:47], v3, s[44:47], s72 offen sc1
    s_sub_u32 s76, s76, 1
    s_cbranch_scc1 pd_349
    s_waitcnt vmcnt(2)
    v_max3_u32 v54, v40, v41, v42
    v_max3_u32 v54, v54, v43, v44
    v_max3_u32 v54, v54, v45, v46
    v_max_u32 v54, v54, v47
    v_cmp_eq_u32 vcc, -1, v54
    s_cbranch_vccnz poll_348
pd_349:
    ds_write_b128 v7, v[40:43] offset:2048
    ds_write_b128 v7, v[44:47] offset:6144
    s_waitcnt lgkmcnt(0)
    s_barrier
    ds_read_b128 v[56:59], v7 offset:0
    ds_read_b128 v[60:63], v7 offset:1024
    ds_read_b128 v[64:67], v7 offset:3072
    ds_read_b128 v[68:71], v7 offset:4096
    ds_read_b128 v[72:75], v7 offset:5120
    ds_read_b128 v[76:79], v7 offset:7168
    ds_read_b128 v[80:83], v7 offset:8192
    ds_read_b128 v[84:87], v7 offset:9216
    v_smfmac_f32_16x16x64_bf16 v[32:35], v[40:43], v[112:119], v52
    v_smfmac_f32_16x16x64_bf16 v[36:39], v[40:43], v[192:199], v52
    v_smfmac_f32_16x16x64_bf16 v[32:35], v[44:47], v[144:151], v52
    v_smfmac_f32_16x16x64_bf16 v[36:39], v[44:47], v[224:231], v52
    s_waitcnt lgkmcnt(7)
    v_smfmac_f32_16x16x64_bf16 v[32:35], v[56:59], v[96:103], v52
    s_waitcnt lgkmcnt(6)
    v_smfmac_f32_16x16x64_bf16 v[32:35], v[60:63], v[104:111], v52
    s_waitcnt lgkmcnt(5)
    v_smfmac_f32_16x16x64_bf16 v[32:35], v[64:67], v[120:127], v52
    s_waitcnt lgkmcnt(4)
    v_smfmac_f32_16x16x64_bf16 v[32:35], v[68:71], v[128:135], v52
    s_waitcnt lgkmcnt(3)
    v_smfmac_f32_16x16x64_bf16 v[32:35], v[72:75], v[136:143], v52
    s_waitcnt lgkmcnt(2)
    v_smfmac_f32_16x16x64_bf16 v[32:35], v[76:79], v[152:159], v52
    s_waitcnt lgkmcnt(1)
    v_smfmac_f32_16x16x64_bf16 v[32:35], v[80:83], v[160:167], v52
    s_waitcnt lgkmcnt(0)
    v_smfmac_f32_16x16x64_bf16 v[32:35], v[84:87], v[168:175], v52
    v_smfmac_f32_16x16x64_bf16 v[36:39], v[56:59], v[176:183], v52
    s_nop 0
    v_smfmac_f32_16x16x64_bf16 v[36:39], v[60:63], v[184:191], v52
    s_nop 0
    v_smfmac_f32_16x16x64_bf16 v[36:39], v[64:67], v[200:207], v52
    s_nop 0
    v_smfmac_f32_16x16x64_bf16 v[36:39], v[68:71], v[208:215], v52
    s_nop 0
    v_smfmac_f32_16x16x64_bf16 v[36:39], v[72:75], v[216:223], v52
    v_add_f32 v32, v32, v33
    v_add_f32 v34, v34, v35
    v_smfmac_f32_16x16x64_bf16 v[36:39], v[76:79], v[232:239], v52
    v_cvt_pk_bf16_f32 v54, v32, v34
    v_smfmac_f32_16x16x64_bf16 v[36:39], v[80:83], v[240:247], v52
    ds_write_b16 v8, v54
    ds_write_b16_d16_hi v8, v54 offset:144
    v_smfmac_f32_16x16x64_bf16 v[36:39], v[84:87], v[248:255], v52
    s_nop 7
    v_add_f32 v36, v36, v37
    v_add_f32 v38, v38, v39
    v_cvt_pk_bf16_f32 v55, v36, v38
    ds_write_b16 v8, v55 offset:1152
    ds_write_b16_d16_hi v8, v55 offset:1296
    s_waitcnt lgkmcnt(0)
    s_barrier
    ds_read_b128 v[16:19], v9
    ds_read_b128 v[20:23], v9 offset:64
    s_waitcnt lgkmcnt(1)
    v_mfma_f32_16x16x32_bf16 v[12:15], v[24:27], v[16:19], 0
    s_waitcnt lgkmcnt(0)
    v_mfma_f32_16x16x32_bf16 v[12:15], v[28:31], v[20:23], v[12:15]
    s_nop 7
    buffer_store_dwordx4 v[12:15], v11, s[44:47], s72 offen
    ds_write_b128 v5, v[12:15]
    s_waitcnt lgkmcnt(0)
    s_barrier
    s_cmp_eq_u32 s73, 63
    s_cbranch_scc1 qkdone_347
    v_mov_b32 v32, 0
    v_mov_b32 v33, 0
    v_mov_b32 v34, 0
    v_mov_b32 v35, 0
    v_mov_b32 v36, 0
    v_mov_b32 v37, 0
    v_mov_b32 v38, 0
    v_mov_b32 v39, 0
    s_add_u32 s72, s73, 2
    s_and_b32 s72, s72, 3
    s_lshl_b32 s72, s72, 14
    v_mov_b32 v12, -1
    v_mov_b32 v13, -1
    v_mov_b32 v14, -1
    v_mov_b32 v15, -1
    s_waitcnt vmcnt(0)
    v_mov_b32 v40, -1
    v_mov_b32 v41, -1
    v_mov_b32 v42, -1
    v_mov_b32 v43, -1
    v_mov_b32 v44, -1
    v_mov_b32 v45, -1
    v_mov_b32 v46, -1
    v_mov_b32 v47, -1
    s_barrier
    buffer_store_dwordx4 v[12:15], v11, s[44:47], s72 offen
    s_add_u32 s73, s73, 1
    s_waitcnt vmcnt(0)
    s_barrier
    s_branch qkloop_346
qkdone_347:
    s_waitcnt vmcnt(0)
    s_barrier
    s_endpgm
qk03_331:
qkloop_350:
    s_and_b32 s72, s73, 3
    s_lshl_b32 s72, s72, 14
    s_sleep 2
    s_mov_b32 s76, 30000
    buffer_load_dwordx4 v[40:43], v2, s[44:47], s72 offen sc1
    buffer_load_dwordx4 v[44:47], v3, s[44:47], s72 offen sc1
    s_sleep 3
poll_352:
    buffer_load_dwordx4 v[40:43], v2, s[44:47], s72 offen sc1
    buffer_load_dwordx4 v[44:47], v3, s[44:47], s72 offen sc1
    s_sub_u32 s76, s76, 1
    s_cbranch_scc1 pd_353
    s_waitcnt vmcnt(2)
    v_max3_u32 v54, v40, v41, v42
    v_max3_u32 v54, v54, v43, v44
    v_max3_u32 v54, v54, v45, v46
    v_max_u32 v54, v54, v47
    v_cmp_eq_u32 vcc, -1, v54
    s_cbranch_vccnz poll_352
pd_353:
    ds_write_b128 v7, v[40:43] offset:3072
    ds_write_b128 v7, v[44:47] offset:7168
    s_waitcnt lgkmcnt(0)
    s_barrier
    ds_read_b128 v[56:59], v7 offset:0
    ds_read_b128 v[60:63], v7 offset:1024
    ds_read_b128 v[64:67], v7 offset:2048
    ds_read_b128 v[68:71], v7 offset:4096
    ds_read_b128 v[72:75], v7 offset:5120
    ds_read_b128 v[76:79], v7 offset:6144
    ds_read_b128 v[80:83], v7 offset:8192
    ds_read_b128 v[84:87], v7 offset:9216
    v_smfmac_f32_16x16x64_bf16 v[32:35], v[40:43], v[120:127], v52
    v_smfmac_f32_16x16x64_bf16 v[36:39], v[40:43], v[200:207], v52
    v_smfmac_f32_16x16x64_bf16 v[32:35], v[44:47], v[152:159], v52
    v_smfmac_f32_16x16x64_bf16 v[36:39], v[44:47], v[232:239], v52
    s_waitcnt lgkmcnt(7)
    v_smfmac_f32_16x16x64_bf16 v[32:35], v[56:59], v[96:103], v52
    s_waitcnt lgkmcnt(6)
    v_smfmac_f32_16x16x64_bf16 v[32:35], v[60:63], v[104:111], v52
    s_waitcnt lgkmcnt(5)
    v_smfmac_f32_16x16x64_bf16 v[32:35], v[64:67], v[112:119], v52
    s_waitcnt lgkmcnt(4)
    v_smfmac_f32_16x16x64_bf16 v[32:35], v[68:71], v[128:135], v52
    s_waitcnt lgkmcnt(3)
    v_smfmac_f32_16x16x64_bf16 v[32:35], v[72:75], v[136:143], v52
    s_waitcnt lgkmcnt(2)
    v_smfmac_f32_16x16x64_bf16 v[32:35], v[76:79], v[144:151], v52
    s_waitcnt lgkmcnt(1)
    v_smfmac_f32_16x16x64_bf16 v[32:35], v[80:83], v[160:167], v52
    s_waitcnt lgkmcnt(0)
    v_smfmac_f32_16x16x64_bf16 v[32:35], v[84:87], v[168:175], v52
    v_smfmac_f32_16x16x64_bf16 v[36:39], v[56:59], v[176:183], v52
    s_nop 0
    v_smfmac_f32_16x16x64_bf16 v[36:39], v[60:63], v[184:191], v52
    s_nop 0
    v_smfmac_f32_16x16x64_bf16 v[36:39], v[64:67], v[192:199], v52
    s_nop 0
    v_smfmac_f32_16x16x64_bf16 v[36:39], v[68:71], v[208:215], v52
    s_nop 0
    v_smfmac_f32_16x16x64_bf16 v[36:39], v[72:75], v[216:223], v52
    v_add_f32 v32, v32, v33
    v_add_f32 v34, v34, v35
    v_smfmac_f32_16x16x64_bf16 v[36:39], v[76:79], v[224:231], v52
    v_cvt_pk_bf16_f32 v54, v32, v34
    v_smfmac_f32_16x16x64_bf16 v[36:39], v[80:83], v[240:247], v52
    ds_write_b16 v8, v54
    ds_write_b16_d16_hi v8, v54 offset:144
    v_smfmac_f32_16x16x64_bf16 v[36:39], v[84:87], v[248:255], v52
    s_nop 7
    v_add_f32 v36, v36, v37
    v_add_f32 v38, v38, v39
    v_cvt_pk_bf16_f32 v55, v36, v38
    ds_write_b16 v8, v55 offset:1152
    ds_write_b16_d16_hi v8, v55 offset:1296
    s_waitcnt lgkmcnt(0)
    s_barrier
    s_waitcnt lgkmcnt(0)
    s_barrier
    s_cmp_eq_u32 s73, 63
    s_cbranch_scc1 qkdone_351
    v_mov_b32 v32, 0
    v_mov_b32 v33, 0
    v_mov_b32 v34, 0
    v_mov_b32 v35, 0
    v_mov_b32 v36, 0
    v_mov_b32 v37, 0
    v_mov_b32 v38, 0
    v_mov_b32 v39, 0
    s_add_u32 s72, s73, 2
    s_and_b32 s72, s72, 3
    s_lshl_b32 s72, s72, 14
    v_mov_b32 v12, -1
    v_mov_b32 v13, -1
    v_mov_b32 v14, -1
    v_mov_b32 v15, -1
    s_waitcnt vmcnt(0)
    v_mov_b32 v40, -1
    v_mov_b32 v41, -1
    v_mov_b32 v42, -1
    v_mov_b32 v43, -1
    v_mov_b32 v44, -1
    v_mov_b32 v45, -1
    v_mov_b32 v46, -1
    v_mov_b32 v47, -1
    s_barrier
    s_cmp_ge_u32 s73, 52
    s_cbranch_scc0 ks_354
    s_add_u32 s74, s73, 1
    v_mov_b32 v54, 0
    v_mov_b32 v55, s74
    buffer_store_dword v55, v54, s[44:47], s8 offen
ks_354:
    s_add_u32 s73, s73, 1
    s_add_u32 s74, s73, 1
    s_min_u32 s74, s74, 63
    s_cmp_lt_u32 s74, 6
    s_cbranch_scc1 kd_355
    s_add_u32 s87, s74, 1
    s_cmp_ge_u32 s86, s87
    s_cbranch_scc1 fwd_358
    s_mov_b32 s76, 4000000
fw_357:
    buffer_load_dword v56, v0, s[44:47], 0 offen sc1
    s_sub_u32 s76, s76, 1
    s_cbranch_scc1 fwd_358
    s_waitcnt vmcnt(0)
    v_lshrrev_b32 v57, 1, v1
    v_min_u32 v57, 1, v57
    v_mul_u32_u24 v57, 9, v57
    v_add_u32 v56, v56, v57
    v_cmp_gt_u32 vcc, s87, v56
    s_cbranch_vccz fwo_359
    s_sleep 1
    s_branch fw_357
fwo_359:
    s_add_u32 s76, s87, 3
    v_cmp_gt_u32 vcc, s76, v56
    s_cmp_eq_u64 vcc, 0
    s_cselect_b32 s86, s76, s87
fwd_358:
    s_branch kj_356
kd_355:
    s_lshl_b32 s63, s60, 3
    s_add_u32 s63, s63, s4
    s_lshl_b32 s63, s63, 7
    s_add_u32 s63, s63, 156807168
    v_min_u32 v58, 1, v1
    v_lshlrev_b32 v58, 12, v58
    v_add_u32 v58, s63, v58
    s_add_u32 s87, s74, 1
    s_cmp_ge_u32 s86, s87
    s_cbranch_scc1 fwd_361
    s_mov_b32 s76, 4000000
fw_360:
    buffer_load_dword v56, v58, s[44:47], 0 offen sc1
    s_sub_u32 s76, s76, 1
    s_cbranch_scc1 fwd_361
    s_waitcnt vmcnt(0)
    v_cmp_gt_u32 vcc, s87, v56
    s_cbranch_vccz fwo_362
    s_sleep 2
    s_branch fw_360
fwo_362:
    s_mov_b32 s86, s87
fwd_361:
    s_mov_b32 s86, 0
kj_356:
    s_waitcnt vmcnt(0)
    s_barrier
    s_branch qkloop_350
qkdone_351:
    s_waitcnt vmcnt(0)
    s_barrier
    s_lshl_b32 s74, s62, 7
    s_lshl_b32 s75, s61, 2
    s_add_u32 s74, s74, s75
    s_add_u32 s74, s74, 156835856
    v_mov_b32 v54, 0
    v_mov_b32 v55, 64
    buffer_store_dword v55, v54, s[44:47], s74 offen sc1
    s_endpgm
qk10_332:
qkloop_363:
    s_and_b32 s72, s73, 3
    s_lshl_b32 s72, s72, 14
    s_sleep 2
    s_mov_b32 s76, 30000
    buffer_load_dwordx4 v[40:43], v2, s[44:47], s72 offen sc1
    buffer_load_dwordx4 v[44:47], v3, s[44:47], s72 offen sc1
    buffer_load_dwordx4 v[48:51], v4, s[44:47], s72 offen sc1
    s_sleep 3
poll_365:
    buffer_load_dwordx4 v[40:43], v2, s[44:47], s72 offen sc1
    buffer_load_dwordx4 v[44:47], v3, s[44:47], s72 offen sc1
    buffer_load_dwordx4 v[48:51], v4, s[44:47], s72 offen sc1
    s_sub_u32 s76, s76, 1
    s_cbranch_scc1 pd_366
    s_waitcnt vmcnt(3)
    v_max3_u32 v54, v40, v41, v42
    v_max3_u32 v54, v54, v43, v44
    v_max3_u32 v54, v54, v45, v46
    v_max3_u32 v54, v54, v47, v48
    v_max3_u32 v54, v54, v49, v50
    v_max_u32 v54, v54, v51
    v_cmp_eq_u32 vcc, -1, v54
    s_cbranch_vccnz poll_365
pd_366:
    ds_write_b128 v7, v[40:43] offset:0
    ds_write_b128 v7, v[44:47] offset:4096
    ds_write_b128 v7, v[48:51] offset:8192
    s_waitcnt lgkmcnt(0)
    s_barrier
    ds_read_b128 v[56:59], v7 offset:1024
    ds_read_b128 v[60:63], v7 offset:2048
    ds_read_b128 v[64:67], v7 offset:3072
    ds_read_b128 v[68:71], v7 offset:5120
    ds_read_b128 v[72:75], v7 offset:6144
    ds_read_b128 v[76:79], v7 offset:7168
    ds_read_b128 v[80:83], v7 offset:9216
    v_smfmac_f32_16x16x64_bf16 v[32:35], v[40:43], v[96:103], v52
    v_smfmac_f32_16x16x64_bf16 v[36:39], v[40:43], v[176:183], v52
    v_smfmac_f32_16x16x64_bf16 v[32:35], v[44:47], v[128:135], v52
    v_smfmac_f32_16x16x64_bf16 v[36:39], v[44:47], v[208:215], v52
    v_smfmac_f32_16x16x64_bf16 v[32:35], v[48:51], v[160:167], v52
    v_smfmac_f32_16x16x64_bf16 v[36:39], v[48:51], v[240:247], v52
    s_waitcnt lgkmcnt(6)
    v_smfmac_f32_16x16x64_bf16 v[32:35], v[56:59], v[104:111], v52
    s_waitcnt lgkmcnt(5)
    v_smfmac_f32_16x16x64_bf16 v[32:35], v[60:63], v[112:119], v52
    s_waitcnt lgkmcnt(4)
    v_smfmac_f32_16x16x64_bf16 v[32:35], v[64:67], v[120:127], v52
    s_waitcnt lgkmcnt(3)
    v_smfmac_f32_16x16x64_bf16 v[32:35], v[68:71], v[136:143], v52
    s_waitcnt lgkmcnt(2)
    v_smfmac_f32_16x16x64_bf16 v[32:35], v[72:75], v[144:151], v52
    s_waitcnt lgkmcnt(1)
    v_smfmac_f32_16x16x64_bf16 v[32:35], v[76:79], v[152:159], v52
    s_waitcnt lgkmcnt(0)
    v_smfmac_f32_16x16x64_bf16 v[32:35], v[80:83], v[168:175], v52
    v_smfmac_f32_16x16x64_bf16 v[36:39], v[56:59], v[184:191], v52
    s_nop 0
    v_smfmac_f32_16x16x64_bf16 v[36:39], v[60:63], v[192:199], v52
    s_nop 0
    v_smfmac_f32_16x16x64_bf16 v[36:39], v[64:67], v[200:207], v52
    s_nop 0
    v_smfmac_f32_16x16x64_bf16 v[36:39], v[68:71], v[216:223], v52
    s_nop 0
    v_smfmac_f32_16x16x64_bf16 v[36:39], v[72:75], v[224:231], v52
    v_add_f32 v32, v32, v33
    v_add_f32 v34, v34, v35
    v_smfmac_f32_16x16x64_bf16 v[36:39], v[76:79], v[232:239], v52
    v_cvt_pk_bf16_f32 v54, v32, v34
    v_smfmac_f32_16x16x64_bf16 v[36:39], v[80:83], v[248:255], v52
    ds_write_b16 v8, v54
    ds_write_b16_d16_hi v8, v54 offset:144
    s_nop 5
    v_add_f32 v36, v36, v37
    v_add_f32 v38, v38, v39
    v_cvt_pk_bf16_f32 v55, v36, v38
    ds_write_b16 v8, v55 offset:1152
    ds_write_b16_d16_hi v8, v55 offset:1296
    s_waitcnt lgkmcnt(0)
    s_barrier
    ds_read_b128 v[16:19], v9
    ds_read_b128 v[24:27], v10
    ds_read_b128 v[20:23], v9 offset:64
    ds_read_b128 v[28:31], v10 offset:64
    s_waitcnt lgkmcnt(2)
    v_mfma_f32_16x16x32_bf16 v[12:15], v[24:27], v[16:19], 0
    s_waitcnt lgkmcnt(0)
    v_mfma_f32_16x16x32_bf16 v[12:15], v[28:31], v[20:23], v[12:15]
    s_nop 7
    v_cndmask_b32 v54, v12, v13, s[68:69]
    buffer_store_dword v54, v11, s[44:47], s72 offen sc1
    ds_write_b32 v5, v54
    s_waitcnt lgkmcnt(0)
    s_barrier
    s_cmp_eq_u32 s73, 63
    s_cbranch_scc1 qkdone_364
    s_cmp_ge_u32 s73, 52
    s_cbranch_scc0 ks_367
    s_and_b32 s74, s73, 7
    s_mul_i32 s74, s74, 196608
    buffer_store_dwordx4 v[24:27], v0, s[44:47], s74 offen sc1
    buffer_store_dwordx4 v[28:31], v0, s[44:47], s74 offen offset:1024 sc1
ks_367:
    v_mov_b32 v32, 0
    v_mov_b32 v33, 0
    v_mov_b32 v34, 0
    v_mov_b32 v35, 0
    v_mov_b32 v36, 0
    v_mov_b32 v37, 0
    v_mov_b32 v38, 0
    v_mov_b32 v39, 0
    s_add_u32 s72, s73, 2
    s_and_b32 s72, s72, 3
    s_lshl_b32 s72, s72, 14
    v_mov_b32 v12, -1
    v_mov_b32 v13, -1
    v_mov_b32 v14, -1
    v_mov_b32 v15, -1
    s_waitcnt vmcnt(0)
    v_mov_b32 v40, -1
    v_mov_b32 v41, -1
    v_mov_b32 v42, -1
    v_mov_b32 v43, -1
    v_mov_b32 v44, -1
    v_mov_b32 v45, -1
    v_mov_b32 v46, -1
    v_mov_b32 v47, -1
    v_mov_b32 v48, -1
    v_mov_b32 v49, -1
    v_mov_b32 v50, -1
    v_mov_b32 v51, -1
    s_barrier
    s_cmp_ge_u32 s73, 52
    s_cbranch_scc1 ks_368
    s_and_b32 s74, s73, 7
    s_mul_i32 s74, s74, 196608
    buffer_store_dwordx4 v[24:27], v0, s[44:47], s74 offen sc1
    buffer_store_dwordx4 v[28:31], v0, s[44:47], s74 offen offset:1024 sc1
ks_368:
    buffer_store_dword v12, v11, s[44:47], s72 offen sc1
    s_add_u32 s73, s73, 1
    s_waitcnt vmcnt(0)
    s_barrier
    s_branch qkloop_363
qkdone_364:
    s_mov_b32 s74, s73
    s_mul_i32 s74, s74, 196608
    v_lshrrev_b32 v56, 2, v1
    v_lshlrev_b32 v56, 5, v56
    v_and_b32 v57, 1, v1
    v_lshlrev_b32 v57, 4, v57
    v_add_u32 v56, v56, v57
    v_and_b32 v57, 2, v1
    v_lshlrev_b32 v57, 29, v57
    v_add_u32 v56, v56, v57
    s_mul_i32 s75, s62, 6144
    s_add_u32 s74, s74, s75
    s_lshl_b32 s75, s61, 10
    s_add_u32 s74, s74, s75
    s_add_u32 s74, s74, 167772160
    v_min_u32 v24, -2, v24
    v_min_u32 v25, -2, v25
    v_min_u32 v26, -2, v26
    v_min_u32 v27, -2, v27
    v_min_u32 v28, -2, v28
    v_min_u32 v29, -2, v29
    v_min_u32 v30, -2, v30
    v_min_u32 v31, -2, v31
    buffer_store_dwordx4 v[24:27], v56, s[44:47], s74 offen sc1
    buffer_store_dwordx4 v[28:31], v56, s[44:47], s74 offen offset:512 sc1
    s_waitcnt vmcnt(0)
    s_barrier
    s_endpgm
qk11_333:
qkloop_369:
    s_and_b32 s72, s73, 3
    s_lshl_b32 s72, s72, 14
    s_and_b32 s75, s73, 1
    s_lshl_b32 s75, s75, 13
    v_add_u32 v54, s75, v53
    ds_read_b128 v[24:27], v54
    ds_read_b128 v[28:31], v54 offset:1024
    s_sleep 2
    s_mov_b32 s76, 30000
    buffer_load_dwordx4 v[40:43], v2, s[44:47], s72 offen sc1
    buffer_load_dwordx4 v[44:47], v3, s[44:47], s72 offen sc1
    buffer_load_dwordx4 v[48:51], v4, s[44:47], s72 offen sc1
    s_sleep 3
poll_371:
    buffer_load_dwordx4 v[40:43], v2, s[44:47], s72 offen sc1
    buffer_load_dwordx4 v[44:47], v3, s[44:47], s72 offen sc1
    buffer_load_dwordx4 v[48:51], v4, s[44:47], s72 offen sc1
    s_sub_u32 s76, s76, 1
    s_cbranch_scc1 pd_372
    s_waitcnt vmcnt(3)
    v_max3_u32 v54, v40, v41, v42
    v_max3_u32 v54, v54, v43, v44
    v_max3_u32 v54, v54, v45, v46
    v_max3_u32 v54, v54, v47, v48
    v_max3_u32 v54, v54, v49, v50
    v_max_u32 v54, v54, v51
    v_cmp_eq_u32 vcc, -1, v54
    s_cbranch_vccnz poll_371
pd_372:
    ds_write_b128 v7, v[40:43] offset:1024
    ds_write_b128 v7, v[44:47] offset:5120
    ds_write_b128 v7, v[48:51] offset:9216
    s_waitcnt lgkmcnt(0)
    s_barrier
    ds_read_b128 v[56:59], v7 offset:0
    ds_read_b128 v[60:63], v7 offset:2048
    ds_read_b128 v[64:67], v7 offset:3072
    ds_read_b128 v[68:71], v7 offset:4096
    ds_read_b128 v[72:75], v7 offset:6144
    ds_read_b128 v[76:79], v7 offset:7168
    ds_read_b128 v[80:83], v7 offset:8192
    v_smfmac_f32_16x16x64_bf16 v[32:35], v[40:43], v[104:111], v52
    v_smfmac_f32_16x16x64_bf16 v[36:39], v[40:43], v[184:191], v52
    v_smfmac_f32_16x16x64_bf16 v[32:35], v[44:47], v[136:143], v52
    v_smfmac_f32_16x16x64_bf16 v[36:39], v[44:47], v[216:223], v52
    v_smfmac_f32_16x16x64_bf16 v[32:35], v[48:51], v[168:175], v52
    v_smfmac_f32_16x16x64_bf16 v[36:39], v[48:51], v[248:255], v52
    s_waitcnt lgkmcnt(6)
    v_smfmac_f32_16x16x64_bf16 v[32:35], v[56:59], v[96:103], v52
    s_waitcnt lgkmcnt(5)
    v_smfmac_f32_16x16x64_bf16 v[32:35], v[60:63], v[112:119], v52
    s_waitcnt lgkmcnt(4)
    v_smfmac_f32_16x16x64_bf16 v[32:35], v[64:67], v[120:127], v52
    s_waitcnt lgkmcnt(3)
    v_smfmac_f32_16x16x64_bf16 v[32:35], v[68:71], v[128:135], v52
    s_waitcnt lgkmcnt(2)
    v_smfmac_f32_16x16x64_bf16 v[32:35], v[72:75], v[144:151], v52
    s_waitcnt lgkmcnt(1)
    v_smfmac_f32_16x16x64_bf16 v[32:35], v[76:79], v[152:159], v52
    s_waitcnt lgkmcnt(0)
    v_smfmac_f32_16x16x64_bf16 v[32:35], v[80:83], v[160:167], v52
    v_smfmac_f32_16x16x64_bf16 v[36:39], v[56:59], v[176:183], v52
    s_nop 0
    v_smfmac_f32_16x16x64_bf16 v[36:39], v[60:63], v[192:199], v52
    s_nop 0
    v_smfmac_f32_16x16x64_bf16 v[36:39], v[64:67], v[200:207], v52
    s_nop 0
    v_smfmac_f32_16x16x64_bf16 v[36:39], v[68:71], v[208:215], v52
    s_nop 0
    v_smfmac_f32_16x16x64_bf16 v[36:39], v[72:75], v[224:231], v52
    v_add_f32 v32, v32, v33
    v_add_f32 v34, v34, v35
    v_smfmac_f32_16x16x64_bf16 v[36:39], v[76:79], v[232:239], v52
    v_cvt_pk_bf16_f32 v54, v32, v34
    v_smfmac_f32_16x16x64_bf16 v[36:39], v[80:83], v[240:247], v52
    ds_write_b16 v8, v54
    ds_write_b16_d16_hi v8, v54 offset:144
    s_nop 5
    v_add_f32 v36, v36, v37
    v_add_f32 v38, v38, v39
    v_cvt_pk_bf16_f32 v55, v36, v38
    ds_write_b16 v8, v55 offset:1152
    ds_write_b16_d16_hi v8, v55 offset:1296
    s_waitcnt lgkmcnt(0)
    s_barrier
    ds_read_b128 v[16:19], v9
    ds_read_b128 v[20:23], v9 offset:64
    s_waitcnt lgkmcnt(1)
    v_mfma_f32_16x16x32_bf16 v[12:15], v[24:27], v[16:19], 0
    s_waitcnt lgkmcnt(0)
    v_mfma_f32_16x16x32_bf16 v[12:15], v[28:31], v[20:23], v[12:15]
    s_nop 7
    buffer_store_dwordx4 v[12:15], v11, s[44:47], s72 offen sc1
    ds_write_b128 v5, v[12:15]
    s_waitcnt lgkmcnt(0)
    s_barrier
    s_cmp_eq_u32 s73, 63
    s_cbranch_scc1 qkdone_370
    v_mov_b32 v32, 0
    v_mov_b32 v33, 0
    v_mov_b32 v34, 0
    v_mov_b32 v35, 0
    v_mov_b32 v36, 0
    v_mov_b32 v37, 0
    v_mov_b32 v38, 0
    v_mov_b32 v39, 0
    s_add_u32 s72, s73, 2
    s_and_b32 s72, s72, 3
    s_lshl_b32 s72, s72, 14
    v_mov_b32 v12, -1
    v_mov_b32 v13, -1
    v_mov_b32 v14, -1
    v_mov_b32 v15, -1
    s_waitcnt vmcnt(0)
    v_mov_b32 v40, -1
    v_mov_b32 v41, -1
    v_mov_b32 v42, -1
    v_mov_b32 v43, -1
    v_mov_b32 v44, -1
    v_mov_b32 v45, -1
    v_mov_b32 v46, -1
    v_mov_b32 v47, -1
    v_mov_b32 v48, -1
    v_mov_b32 v49, -1
    v_mov_b32 v50, -1
    v_mov_b32 v51, -1
    s_barrier
    buffer_store_dwordx4 v[12:15], v11, s[44:47], s72 offen sc1
    s_add_u32 s73, s73, 1
    s_waitcnt vmcnt(0)
    s_barrier
    s_branch qkloop_369
qkdone_370:
    s_waitcnt vmcnt(0)
    s_barrier
    s_endpgm
qk12_334:
qkloop_373:
    s_and_b32 s72, s73, 3
    s_lshl_b32 s72, s72, 14
    s_and_b32 s75, s73, 1
    s_lshl_b32 s75, s75, 13
    v_add_u32 v54, s75, v53
    ds_read_b128 v[24:27], v54
    ds_read_b128 v[28:31], v54 offset:1024
    s_sleep 2
    s_mov_b32 s76, 30000
    buffer_load_dwordx4 v[40:43], v2, s[44:47], s72 offen sc1
    buffer_load_dwordx4 v[44:47], v3, s[44:47], s72 offen sc1
    s_sleep 3
poll_375:
    buffer_load_dwordx4 v[40:43], v2, s[44:47], s72 offen sc1
    buffer_load_dwordx4 v[44:47], v3, s[44:47], s72 offen sc1
    s_sub_u32 s76, s76, 1
    s_cbranch_scc1 pd_376
    s_waitcnt vmcnt(2)
    v_max3_u32 v54, v40, v41, v42
    v_max3_u32 v54, v54, v43, v44
    v_max3_u32 v54, v54, v45, v46
    v_max_u32 v54, v54, v47
    v_cmp_eq_u32 vcc, -1, v54
    s_cbranch_vccnz poll_375
pd_376:
    ds_write_b128 v7, v[40:43] offset:2048
    ds_write_b128 v7, v[44:47] offset:6144
    s_waitcnt lgkmcnt(0)
    s_barrier
    ds_read_b128 v[56:59], v7 offset:0
    ds_read_b128 v[60:63], v7 offset:1024
    ds_read_b128 v[64:67], v7 offset:3072
    ds_read_b128 v[68:71], v7 offset:4096
    ds_read_b128 v[72:75], v7 offset:5120
    ds_read_b128 v[76:79], v7 offset:7168
    ds_read_b128 v[80:83], v7 offset:8192
    ds_read_b128 v[84:87], v7 offset:9216
    v_smfmac_f32_16x16x64_bf16 v[32:35], v[40:43], v[112:119], v52
    v_smfmac_f32_16x16x64_bf16 v[36:39], v[40:43], v[192:199], v52
    v_smfmac_f32_16x16x64_bf16 v[32:35], v[44:47], v[144:151], v52
    v_smfmac_f32_16x16x64_bf16 v[36:39], v[44:47], v[224:231], v52
    s_waitcnt lgkmcnt(7)
    v_smfmac_f32_16x16x64_bf16 v[32:35], v[56:59], v[96:103], v52
    s_waitcnt lgkmcnt(6)
    v_smfmac_f32_16x16x64_bf16 v[32:35], v[60:63], v[104:111], v52
    s_waitcnt lgkmcnt(5)
    v_smfmac_f32_16x16x64_bf16 v[32:35], v[64:67], v[120:127], v52
    s_waitcnt lgkmcnt(4)
    v_smfmac_f32_16x16x64_bf16 v[32:35], v[68:71], v[128:135], v52
    s_waitcnt lgkmcnt(3)
    v_smfmac_f32_16x16x64_bf16 v[32:35], v[72:75], v[136:143], v52
    s_waitcnt lgkmcnt(2)
    v_smfmac_f32_16x16x64_bf16 v[32:35], v[76:79], v[152:159], v52
    s_waitcnt lgkmcnt(1)
    v_smfmac_f32_16x16x64_bf16 v[32:35], v[80:83], v[160:167], v52
    s_waitcnt lgkmcnt(0)
    v_smfmac_f32_16x16x64_bf16 v[32:35], v[84:87], v[168:175], v52
    v_smfmac_f32_16x16x64_bf16 v[36:39], v[56:59], v[176:183], v52
    s_nop 0
    v_smfmac_f32_16x16x64_bf16 v[36:39], v[60:63], v[184:191], v52
    s_nop 0
    v_smfmac_f32_16x16x64_bf16 v[36:39], v[64:67], v[200:207], v52
    s_nop 0
    v_smfmac_f32_16x16x64_bf16 v[36:39], v[68:71], v[208:215], v52
    s_nop 0
    v_smfmac_f32_16x16x64_bf16 v[36:39], v[72:75], v[216:223], v52
    v_add_f32 v32, v32, v33
    v_add_f32 v34, v34, v35
    v_smfmac_f32_16x16x64_bf16 v[36:39], v[76:79], v[232:239], v52
    v_cvt_pk_bf16_f32 v54, v32, v34
    v_smfmac_f32_16x16x64_bf16 v[36:39], v[80:83], v[240:247], v52
    ds_write_b16 v8, v54
    ds_write_b16_d16_hi v8, v54 offset:144
    v_smfmac_f32_16x16x64_bf16 v[36:39], v[84:87], v[248:255], v52
    s_nop 7
    v_add_f32 v36, v36, v37
    v_add_f32 v38, v38, v39
    v_cvt_pk_bf16_f32 v55, v36, v38
    ds_write_b16 v8, v55 offset:1152
    ds_write_b16_d16_hi v8, v55 offset:1296
    s_waitcnt lgkmcnt(0)
    s_barrier
    ds_read_b128 v[16:19], v9
    ds_read_b128 v[20:23], v9 offset:64
    s_waitcnt lgkmcnt(1)
    v_mfma_f32_16x16x32_bf16 v[12:15], v[24:27], v[16:19], 0
    s_waitcnt lgkmcnt(0)
    v_mfma_f32_16x16x32_bf16 v[12:15], v[28:31], v[20:23], v[12:15]
    s_nop 7
    buffer_store_dwordx4 v[12:15], v11, s[44:47], s72 offen sc1
    ds_write_b128 v5, v[12:15]
    s_waitcnt lgkmcnt(0)
    s_barrier
    s_cmp_eq_u32 s73, 63
    s_cbranch_scc1 qkdone_374
    v_mov_b32 v32, 0
    v_mov_b32 v33, 0
    v_mov_b32 v34, 0
    v_mov_b32 v35, 0
    v_mov_b32 v36, 0
    v_mov_b32 v37, 0
    v_mov_b32 v38, 0
    v_mov_b32 v39, 0
    s_add_u32 s72, s73, 2
    s_and_b32 s72, s72, 3
    s_lshl_b32 s72, s72, 14
    v_mov_b32 v12, -1
    v_mov_b32 v13, -1
    v_mov_b32 v14, -1
    v_mov_b32 v15, -1
    s_waitcnt vmcnt(0)
    v_mov_b32 v40, -1
    v_mov_b32 v41, -1
    v_mov_b32 v42, -1
    v_mov_b32 v43, -1
    v_mov_b32 v44, -1
    v_mov_b32 v45, -1
    v_mov_b32 v46, -1
    v_mov_b32 v47, -1
    s_barrier
    buffer_store_dwordx4 v[12:15], v11, s[44:47], s72 offen sc1
    s_add_u32 s73, s73, 1
    s_waitcnt vmcnt(0)
    s_barrier
    s_branch qkloop_373
qkdone_374:
    s_waitcnt vmcnt(0)
    s_barrier
    s_endpgm
qk13_335:
qkloop_377:
    s_and_b32 s72, s73, 3
    s_lshl_b32 s72, s72, 14
    s_sleep 2
    s_mov_b32 s76, 30000
    buffer_load_dwordx4 v[40:43], v2, s[44:47], s72 offen sc1
    buffer_load_dwordx4 v[44:47], v3, s[44:47], s72 offen sc1
    s_sleep 3
poll_379:
    buffer_load_dwordx4 v[40:43], v2, s[44:47], s72 offen sc1
    buffer_load_dwordx4 v[44:47], v3, s[44:47], s72 offen sc1
    s_sub_u32 s76, s76, 1
    s_cbranch_scc1 pd_380
    s_waitcnt vmcnt(2)
    v_max3_u32 v54, v40, v41, v42
    v_max3_u32 v54, v54, v43, v44
    v_max3_u32 v54, v54, v45, v46
    v_max_u32 v54, v54, v47
    v_cmp_eq_u32 vcc, -1, v54
    s_cbranch_vccnz poll_379
pd_380:
    ds_write_b128 v7, v[40:43] offset:3072
    ds_write_b128 v7, v[44:47] offset:7168
    s_waitcnt lgkmcnt(0)
    s_barrier
    ds_read_b128 v[56:59], v7 offset:0
    ds_read_b128 v[60:63], v7 offset:1024
    ds_read_b128 v[64:67], v7 offset:2048
    ds_read_b128 v[68:71], v7 offset:4096
    ds_read_b128 v[72:75], v7 offset:5120
    ds_read_b128 v[76:79], v7 offset:6144
    ds_read_b128 v[80:83], v7 offset:8192
    ds_read_b128 v[84:87], v7 offset:9216
    v_smfmac_f32_16x16x64_bf16 v[32:35], v[40:43], v[120:127], v52
    v_smfmac_f32_16x16x64_bf16 v[36:39], v[40:43], v[200:207], v52
    v_smfmac_f32_16x16x64_bf16 v[32:35], v[44:47], v[152:159], v52
    v_smfmac_f32_16x16x64_bf16 v[36:39], v[44:47], v[232:239], v52
    s_waitcnt lgkmcnt(7)
    v_smfmac_f32_16x16x64_bf16 v[32:35], v[56:59], v[96:103], v52
    s_waitcnt lgkmcnt(6)
    v_smfmac_f32_16x16x64_bf16 v[32:35], v[60:63], v[104:111], v52
    s_waitcnt lgkmcnt(5)
    v_smfmac_f32_16x16x64_bf16 v[32:35], v[64:67], v[112:119], v52
    s_waitcnt lgkmcnt(4)
    v_smfmac_f32_16x16x64_bf16 v[32:35], v[68:71], v[128:135], v52
    s_waitcnt lgkmcnt(3)
    v_smfmac_f32_16x16x64_bf16 v[32:35], v[72:75], v[136:143], v52
    s_waitcnt lgkmcnt(2)
    v_smfmac_f32_16x16x64_bf16 v[32:35], v[76:79], v[144:151], v52
    s_waitcnt lgkmcnt(1)
    v_smfmac_f32_16x16x64_bf16 v[32:35], v[80:83], v[160:167], v52
    s_waitcnt lgkmcnt(0)
    v_smfmac_f32_16x16x64_bf16 v[32:35], v[84:87], v[168:175], v52
    v_smfmac_f32_16x16x64_bf16 v[36:39], v[56:59], v[176:183], v52
    s_nop 0
    v_smfmac_f32_16x16x64_bf16 v[36:39], v[60:63], v[184:191], v52
    s_nop 0
    v_smfmac_f32_16x16x64_bf16 v[36:39], v[64:67], v[192:199], v52
    s_nop 0
    v_smfmac_f32_16x16x64_bf16 v[36:39], v[68:71], v[208:215], v52
    s_nop 0
    v_smfmac_f32_16x16x64_bf16 v[36:39], v[72:75], v[216:223], v52
    v_add_f32 v32, v32, v33
    v_add_f32 v34, v34, v35
    v_smfmac_f32_16x16x64_bf16 v[36:39], v[76:79], v[224:231], v52
    v_cvt_pk_bf16_f32 v54, v32, v34
    v_smfmac_f32_16x16x64_bf16 v[36:39], v[80:83], v[240:247], v52
    ds_write_b16 v8, v54
    ds_write_b16_d16_hi v8, v54 offset:144
    v_smfmac_f32_16x16x64_bf16 v[36:39], v[84:87], v[248:255], v52
    s_nop 7
    v_add_f32 v36, v36, v37
    v_add_f32 v38, v38, v39
    v_cvt_pk_bf16_f32 v55, v36, v38
    ds_write_b16 v8, v55 offset:1152
    ds_write_b16_d16_hi v8, v55 offset:1296
    s_waitcnt lgkmcnt(0)
    s_barrier
    s_waitcnt lgkmcnt(0)
    s_barrier
    s_cmp_eq_u32 s73, 63
    s_cbranch_scc1 qkdone_378
    v_mov_b32 v32, 0
    v_mov_b32 v33, 0
    v_mov_b32 v34, 0
    v_mov_b32 v35, 0
    v_mov_b32 v36, 0
    v_mov_b32 v37, 0
    v_mov_b32 v38, 0
    v_mov_b32 v39, 0
    s_add_u32 s72, s73, 2
    s_and_b32 s72, s72, 3
    s_lshl_b32 s72, s72, 14
    v_mov_b32 v12, -1
    v_mov_b32 v13, -1
    v_mov_b32 v14, -1
    v_mov_b32 v15, -1
    s_waitcnt vmcnt(0)
    v_mov_b32 v40, -1
    v_mov_b32 v41, -1
    v_mov_b32 v42, -1
    v_mov_b32 v43, -1
    v_mov_b32 v44, -1
    v_mov_b32 v45, -1
    v_mov_b32 v46, -1
    v_mov_b32 v47, -1
    s_barrier
    s_cmp_ge_u32 s73, 52
    s_cbranch_scc0 ks_381
    s_add_u32 s74, s73, 1
    v_mov_b32 v54, 0
    v_mov_b32 v55, s74
    buffer_store_dword v55, v54, s[44:47], s8 offen sc1
ks_381:
    s_add_u32 s73, s73, 1
    s_add_u32 s74, s73, 1
    s_min_u32 s74, s74, 63
    s_cmp_lt_u32 s74, 6
    s_cbranch_scc1 kd_382
    s_add_u32 s87, s74, 1
    s_cmp_ge_u32 s86, s87
    s_cbranch_scc1 fwd_385
    s_mov_b32 s76, 4000000
fw_384:
    buffer_load_dword v56, v0, s[44:47], 0 offen sc1
    s_sub_u32 s76, s76, 1
    s_cbranch_scc1 fwd_385
    s_waitcnt vmcnt(0)
    v_lshrrev_b32 v57, 1, v1
    v_min_u32 v57, 1, v57
    v_mul_u32_u24 v57, 9, v57
    v_add_u32 v56, v56, v57
    v_cmp_gt_u32 vcc, s87, v56
    s_cbranch_vccz fwo_386
    s_sleep 1
    s_branch fw_384
fwo_386:
    s_add_u32 s76, s87, 3
    v_cmp_gt_u32 vcc, s76, v56
    s_cmp_eq_u64 vcc, 0
    s_cselect_b32 s86, s76, s87
fwd_385:
    s_branch kj_383
kd_382:
    s_lshl_b32 s63, s60, 3
    s_add_u32 s63, s63, s4
    s_lshl_b32 s63, s63, 7
    s_add_u32 s63, s63, 156807168
    v_min_u32 v58, 1, v1
    v_lshlrev_b32 v58, 12, v58
    v_add_u32 v58, s63, v58
    s_add_u32 s87, s74, 1
    s_cmp_ge_u32 s86, s87
    s_cbranch_scc1 fwd_388
    s_mov_b32 s76, 4000000
fw_387:
    buffer_load_dword v56, v58, s[44:47], 0 offen sc1
    s_sub_u32 s76, s76, 1
    s_cbranch_scc1 fwd_388
    s_waitcnt vmcnt(0)
    v_cmp_gt_u32 vcc, s87, v56
    s_cbranch_vccz fwo_389
    s_sleep 2
    s_branch fw_387
fwo_389:
    s_mov_b32 s86, s87
fwd_388:
    s_mov_b32 s86, 0
kj_383:
    s_waitcnt vmcnt(0)
    s_barrier
    s_branch qkloop_377
qkdone_378:
    s_waitcnt vmcnt(0)
    s_barrier
    s_lshl_b32 s74, s62, 7
    s_lshl_b32 s75, s61, 2
    s_add_u32 s74, s74, s75
    s_add_u32 s74, s74, 156835856
    v_mov_b32 v54, 0
    v_mov_b32 v55, 64
    buffer_store_dword v55, v54, s[44:47], s74 offen sc1
    s_endpgm
chvo_319:
    v_mov_b32 v40, 0
    s_mov_b32 s76, 1000000
    s_mov_b32 s74, 0
    v_readfirstlane_b32 s74, v61
    s_cmp_lg_u32 s74, 0
    s_cbranch_scc1 cald_391
call_390:
    buffer_load_dword v41, v40, s[56:59], s10 offen offset:132 sc1
    s_sub_u32 s76, s76, 1
    s_cbranch_scc1 cald_391
    s_waitcnt vmcnt(0)
    v_readfirstlane_b32 s74, v41
    s_cmp_lg_u32 s74, 0
    s_cbranch_scc1 cald_391
    s_sleep 32
    s_branch call_390
cald_391:
    s_lshr_b32 s74, s74, 1
    s_lshl_b32 s7, s74, 13
    s_and_b32 s66, s3, 3
    v_lshlrev_b32 v7, 4, v1
    v_lshrrev_b32 v20, 4, v1
    v_and_b32 v21, 15, v1
    v_and_b32 v22, 7, v1
    v_bfe_u32 v23, v1, 3, 1
    s_lshl_b32 s63, s4, 16
    s_lshl_b32 s67, s60, 12
    s_add_u32 s67, s63, s67
    s_add_u32 s67, s67, 155189248
    v_lshlrev_b32 v2, 3, v20
    v_add_u32 v2, v2, v22
    v_lshlrev_b32 v2, 4, v2
    v_lshlrev_b32 v24, 9, v23
    v_add_u32 v2, v2, v24
    v_add_u32 v2, s67, v2
    s_add_u32 s67, s67, 3072
    v_lshlrev_b32 v3, 2, v1
    v_add_u32 v3, s67, v3
    v_lshlrev_b32 v24, 5, v22
    v_lshlrev_b32 v25, 3, v20
    v_add_u32 v24, v24, v25
    s_lshl_b32 s67, s5, 10
    s_lshl_b32 s70, s66, 8
    s_add_u32 s67, s67, s70
    s_add_u32 s67, s67, s63
    s_add_u32 s70, s67, 155713536
    v_add_u32 v4, s70, v24
    v_mov_b32 v26, 1073741824
    v_cmp_gt_u32 vcc, 8, v21
    s_nop 1
    v_cndmask_b32 v4, v26, v4, vcc
    s_mul_i32 s70, s66, 3072
    s_add_u32 s70, s70, s63
    s_add_u32 s70, s70, 155713536
    v_add_u32 v5, s70, v7
    v_lshlrev_b32 v6, 7, v20
    v_lshlrev_b32 v24, 2, v21
    v_add_u32 v6, v6, v24
    s_lshl_b32 s70, s66, 9
    s_add_u32 s70, s70, 29184
    v_add_u32 v6, s70, v6
    s_lshl_b32 s70, s66, 11
    s_add_u32 s70, s70, 29184
    v_add_u32 v8, s70, v7
    s_lshl_b32 s70, s5, 1
    s_lshr_b32 s71, s66, 1
    s_add_u32 s70, s70, s71
    s_lshl_b32 s70, s70, 14
    s_and_b32 s71, s66, 1
    s_lshl_b32 s71, s71, 12
    s_add_u32 s70, s70, s71
    s_add_u32 s70, s70, 153092096
    s_lshl_b32 s71, s5, 1
    s_and_b32 s64, s4, 1
    s_add_u32 s71, s71, s64
    s_lshl_b32 s71, s71, 14
    s_and_b32 s64, s66, 1
    s_lshl_b32 s64, s64, 12
    s_add_u32 s71, s71, s64
    s_add_u32 s71, s71, 153092096
    v_add_u32 v10, s71, v7
    s_lshl_b32 s71, s4, 8
    s_add_u32 s70, s70, s71
    v_and_b32 v24, 31, v1
    v_lshlrev_b32 v24, 4, v24
    v_lshrrev_b32 v25, 5, v1
    v_lshlrev_b32 v25, 3, v25
    v_add3_u32 v9, v24, v25, s70
    v_add_u32 v24, v24, v25
    v_lshrrev_b32 v24, 1, v24
    v_lshlrev_b32 v24, 2, v1
    v_add_u32 v9, s70, v24
    v_lshrrev_b32 v24, 2, v21
    v_lshlrev_b32 v24, 6, v24
    v_lshlrev_b32 v25, 5, v20
    v_add_u32 v24, v24, v25
    v_and_b32 v25, 3, v1
    v_lshlrev_b32 v25, 3, v25
    v_add_u32 v24, v24, v25
    s_mul_i32 s71, s66, 3072
    s_add_u32 s71, s71, 29184
    v_add_u32 v6, s71, v7
    v_cmp_gt_u32 vcc, 32, v1
    s_nop 1
    v_cndmask_b32 v24, v26, v24, vcc
    s_lshr_b32 s70, s4, 1
    s_lshl_b32 s70, s70, 17
    s_lshl_b32 s71, s5, 10
    s_add_u32 s70, s70, s71
    s_and_b32 s71, s4, 1
    s_lshl_b32 s71, s71, 9
    s_add_u32 s70, s70, s71
    s_and_b32 s71, s66, 1
    s_lshl_b32 s71, s71, 8
    s_add_u32 s70, s70, s71
    s_add_u32 s70, s70, 156237824
    s_cmp_lt_u32 s66, 2
    s_cselect_b32 s70, s70, 1073741824
    v_add_u32 v11, s70, v24
    v_and_b32 v24, 1, v1
    v_mov_b32 v12, 0x4444
    v_mov_b32 v25, 0xeeee
    v_cmp_eq_u32 vcc, 1, v24
    s_nop 1
    v_cndmask_b32 v12, v12, v25, vcc
    s_mul_i32 s70, s62, 12
    s_lshl_b32 s71, s61, 2
    s_add_u32 s70, s70, s71
    s_add_u32 s70, s70, s66
    s_lshl_b32 s70, s70, 8
    s_add_u32 s70, s70, 92274688
    v_lshlrev_b32 v24, 2, v1
    v_add_u32 v13, s70, v24
    s_mov_b32 s73, 0
    s_mov_b32 s77, 0x3dd53b95
    s_add_u32 s28, s61, 1
    s_cmp_eq_u32 s28, 3
    s_cselect_b32 s28, 0, s28
    s_add_u32 s29, s28, 1
    s_cmp_eq_u32 s29, 3
    s_cselect_b32 s29, 0, s29
    s_lshl_b32 s28, s28, 10
    s_lshl_b32 s29, s29, 10
    s_lshl_b32 s74, s61, 10
    s_add_u32 s74, s74, 41472
    v_and_b32 v8, 0xfff, v2
    v_add_u32 v8, s74, v8
    s_lshl_b32 s74, s61, 8
    s_add_u32 s74, s74, 41472
    v_and_b32 v0, 0xfff, v3
    v_add_u32 v0, s74, v0
    s_mov_b32 s36, s77
    s_mov_b32 s37, s77
    v_mov_b32 v15, 0
    s_mul_i32 s82, s62, 12
    s_lshr_b32 s74, s66, 1
    s_mul_i32 s74, s74, 6
    s_add_u32 s83, s82, s74
    s_lshl_b32 s74, s61, 1
    s_add_u32 s83, s83, s74
    s_and_b32 s74, s66, 1
    s_add_u32 s83, s83, s74
    s_lshl_b32 s83, s83, 10
    s_add_u32 s83, s83, 4194304
    s_lshl_b32 s74, s61, 2
    s_add_u32 s82, s82, s74
    s_add_u32 s82, s82, s66
    s_lshl_b32 s82, s82, 10
    s_add_u32 s82, s82, 29360128
    v_and_b32 v40, 11, v1
    v_cmp_eq_u32 s[64:65], 0, v40
    v_cmp_eq_u32 s[68:69], 1, v40
    v_cmp_eq_u32 s[70:71], 2, v40
    v_cmp_eq_u32 s[12:13], 3, v40
    v_and_b32 v40, 4, v1
    v_lshlrev_b32 v40, 2, v40
    s_add_u32 s74, s66, 1
    s_and_b32 s74, s74, 3
    s_mul_i32 s74, s74, 3072
    s_add_u32 s33, s74, 29184
    s_add_u32 s74, s66, 2
    s_and_b32 s74, s74, 3
    s_mul_i32 s74, s74, 3072
    s_add_u32 s34, s74, 29184
    s_add_u32 s74, s66, 3
    s_and_b32 s74, s74, 3
    s_mul_i32 s74, s74, 3072
    s_add_u32 s35, s74, 29184
    v_mov_b32 v31, 0x3f80
    v_lshlrev_b32 v31, v40, v31
    s_mov_b32 s87, 1
    v_readfirstlane_b32 s86, v63
    s_cmp_eq_u32 s86, 0
    s_cbranch_scc1 k0_393
    v_cmp_gt_u32 vcc, s87, v62
    s_cbranch_vccz k0_392
k0_393:
    s_lshl_b32 s63, s60, 3
    s_add_u32 s63, s63, s4
    s_lshl_b32 s63, s63, 7
    s_add_u32 s63, s63, 156807168
    v_min_u32 v42, 1, v1
    v_lshlrev_b32 v42, 12, v42
    v_add_u32 v42, s63, v42
    s_mov_b32 s86, 0
    s_cmp_ge_u32 s86, s87
    s_cbranch_scc1 fwd_395
    s_mov_b32 s76, 4000000
fw_394:
    buffer_load_dword v40, v42, s[44:47], 0 offen sc1
    s_sub_u32 s76, s76, 1
    s_cbranch_scc1 fwd_395
    s_waitcnt vmcnt(0)
    v_cmp_gt_u32 vcc, s87, v40
    s_cbranch_vccz fwo_396
    s_sleep 2
    s_branch fw_394
fwo_396:
    s_mov_b32 s86, s87
fwd_395:
k0_392:
    s_mov_b32 s86, 0
    s_mul_i32 s74, s73, 393216
    s_and_b32 s75, s73, 1
    s_lshl_b32 s75, s75, 13
    s_lshl_b32 s79, s66, 10
    s_add_u32 s75, s75, s79
    s_add_u32 s75, s75, 12800
    s_mov_b32 m0, s75
    s_add_u32 s79, s74, s82
    buffer_load_dwordx4 v7, s[44:47], s79 offen sc1 lds
    s_add_u32 s75, s75, 4096
    s_mov_b32 m0, s75
    s_add_u32 s79, s74, s83
    buffer_load_dwordx4 v7, s[44:47], s79 offen sc1 lds
    s_waitcnt vmcnt(0)
    s_barrier
    s_cmp_lt_u32 s5, 10
    s_cselect_b32 s63, 1, 0
    s_lshl_b32 s74, s6, 1
    s_add_u32 s63, s63, s74
    s_cmp_eq_u32 s63, 0
    s_cbranch_scc1 vo00_398
    s_cmp_eq_u32 s63, 3
    s_cbranch_scc1 vo11_399
    s_cmp_eq_u32 s63, 2
    s_cbranch_scc1 vo10_400
vo01_397:
voloop_401:
    v_mov_b32 v36, 0
    v_mov_b32 v37, 0
    v_mov_b32 v38, 0
    v_mov_b32 v39, 0
    s_and_b32 s72, s73, 3
    s_lshr_b32 s85, s72, 1
    s_lshl_b32 s72, s72, 14
    s_and_b32 s75, s73, 1
    s_mul_i32 s78, s75, 327680
    s_lshl_b32 s75, s75, 13
    s_lshl_b32 s74, s66, 10
    s_add_u32 s75, s75, s74
    v_add_u32 v32, s75, v7
    ds_read_b128 v[32:35], v32 offset:12800
    s_add_u32 s84, s73, 1
    s_add_u32 s38, s72, s28
    s_add_u32 s39, s72, s29
    s_lshr_b32 s74, s28, 2
    s_add_u32 s30, s72, s74
    s_lshr_b32 s74, s29, 2
    s_add_u32 s31, s72, s74
    s_waitcnt vmcnt(0)
    v_mov_b32 v16, -1
    v_mov_b32 v17, -1
    v_mov_b32 v18, -1
    v_mov_b32 v19, -1
    v_mov_b32 v20, -1
    v_mov_b32 v21, -1
    v_mov_b32 v22, -1
    v_mov_b32 v23, -1
    v_mov_b32 v24, -1
    v_mov_b32 v25, -1
    v_mov_b32 v26, -1
    v_mov_b32 v27, -1
    v_mov_b32 v28, -1
    v_mov_b32 v29, -1
    v_mov_b32 v30, -1
    s_barrier
    s_cmp_eq_u32 s73, 63
    s_cbranch_scc1 nopf_403
    s_mul_i32 s74, s84, 393216
    s_and_b32 s75, s84, 1
    s_lshl_b32 s75, s75, 13
    s_lshl_b32 s79, s66, 10
    s_add_u32 s75, s75, s79
    s_add_u32 s75, s75, 12800
    s_mov_b32 m0, s75
    s_add_u32 s79, s74, s82
    buffer_load_dwordx4 v7, s[44:47], s79 offen sc1 lds
    s_add_u32 s75, s75, 4096
    s_mov_b32 m0, s75
    s_add_u32 s79, s74, s83
    buffer_load_dwordx4 v7, s[44:47], s79 offen sc1 lds
    s_cmp_eq_u32 s73, 12
    s_cbranch_scc0 cal_404
    v_mov_b32 v40, 0
    s_mov_b32 s76, 1000000
    s_mov_b32 s74, 0
call_405:
    buffer_load_dword v41, v40, s[56:59], s10 offen offset:136 sc1
    s_sub_u32 s76, s76, 1
    s_cbranch_scc1 cald_406
    s_waitcnt vmcnt(0)
    v_readfirstlane_b32 s74, v41
    s_cmp_lg_u32 s74, 0
    s_cbranch_scc1 cald_406
    s_sleep 32
    s_branch call_405
cald_406:
    s_lshr_b32 s74, s74, 1
    s_lshl_b32 s7, s74, 13
cal_404:
nopf_403:
    ds_read_b128 v[40:43], v7 offset:0
    ds_read_b128 v[44:47], v7 offset:1024
    ds_read_b128 v[48:51], v7 offset:2048
    ds_read_b128 v[52:55], v7 offset:3072
    ds_read_b128 v[56:59], v7 offset:4096
    ds_read_b128 v[60:63], v7 offset:5120
    ds_read_b128 v[64:67], v7 offset:6144
    ds_read_b128 v[68:71], v7 offset:7168
    ds_read_b128 v[72:75], v7 offset:8192
    ds_read_b128 v[76:79], v7 offset:9216
    s_waitcnt lgkmcnt(0)
    s_barrier
    v_smfmac_f32_16x16x64_bf16 v[36:39], v[40:43], v[176:183], v12
    v_smfmac_f32_16x16x64_bf16 v[36:39], v[44:47], v[184:191], v12
    v_smfmac_f32_16x16x64_bf16 v[36:39], v[48:51], v[192:199], v12
    v_smfmac_f32_16x16x64_bf16 v[36:39], v[52:55], v[200:207], v12
    v_smfmac_f32_16x16x64_bf16 v[36:39], v[56:59], v[208:215], v12
    v_smfmac_f32_16x16x64_bf16 v[36:39], v[60:63], v[216:223], v12
    v_smfmac_f32_16x16x64_bf16 v[36:39], v[64:67], v[224:231], v12
    v_smfmac_f32_16x16x64_bf16 v[36:39], v[68:71], v[232:239], v12
    v_smfmac_f32_16x16x64_bf16 v[36:39], v[72:75], v[240:247], v12
    v_smfmac_f32_16x16x64_bf16 v[36:39], v[76:79], v[248:255], v12
    s_nop 7
    v_add_f32 v36, v36, v37
    v_add_f32 v38, v38, v39
    v_cvt_pk_bf16_f32 v14, v36, v38
    v_mov_b32 v64, 0x3f803f80
    v_mov_b32 v65, 0x3f803f80
    v_mov_b32 v66, 0x3f803f80
    v_mov_b32 v67, 0x3f803f80
    v_mov_b32 v53, 0
    s_cmp_eq_u32 s73, 63
    s_cbranch_scc1 vodone_402
    s_cmp_ge_u32 s73, 52
    s_cbranch_scc0 ks_407
    s_and_b32 s74, s73, 7
    s_mul_i32 s74, s74, 98304
    buffer_store_dword v14, v13, s[44:47], s74 offen
ks_407:
    s_mov_b32 s76, 30000
    buffer_load_dwordx4 v[16:19], v2, s[44:47], s38 offen sc1
    buffer_load_dwordx4 v[20:23], v2, s[44:47], s39 offen sc1
    buffer_load_dword v28, v3, s[44:47], s30 offen sc1
    buffer_load_dword v29, v3, s[44:47], s31 offen sc1
    s_barrier
    ds_read_b128 v[24:27], v8
    ds_read_b32 v30, v0
sp_408:
    buffer_load_dwordx4 v[16:19], v2, s[44:47], s38 offen sc1
    buffer_load_dwordx4 v[20:23], v2, s[44:47], s39 offen sc1
    buffer_load_dword v28, v3, s[44:47], s30 offen sc1
    buffer_load_dword v29, v3, s[44:47], s31 offen sc1
    s_sub_u32 s76, s76, 1
    s_cbranch_scc1 spd_409
    s_waitcnt vmcnt(4)
    v_max3_u32 v46, v16, v17, v18
    v_max3_u32 v46, v46, v19, v20
    v_max3_u32 v46, v46, v21, v22
    v_max3_u32 v46, v46, v23, v28
    v_max_u32 v46, v46, v29
    v_pk_add_f32 v[40:41], v[16:17], v[20:21]
    v_pk_add_f32 v[42:43], v[18:19], v[22:23]
    v_cmp_eq_u32 vcc, -1, v46
    s_cbranch_vccnz sp_408
spd_409:
    s_waitcnt lgkmcnt(0)
    v_add_f32 v44, v28, v29
    v_pk_add_f32 v[40:41], v[40:41], v[24:25]
    v_pk_add_f32 v[42:43], v[42:43], v[26:27]
    v_add_f32 v44, v44, v30
    v_max3_f32 v45, v40, v41, v42
    v_max3_f32 v45, v45, v43, v44
    s_nop 1
    v_max_f32_dpp v45, v45, v45 row_ror:8 row_mask:0xf bank_mask:0xf
    v_mov_b32 v46, v45
    s_nop 1
    v_permlane16_swap_b32 v45, v46
    v_max_f32 v45, v45, v46
    v_mov_b32 v46, v45
    s_nop 1
    v_permlane32_swap_b32 v45, v46
    v_max_f32 v45, v45, v46
    v_sub_f32 v44, v44, v45
    v_sub_f32 v40, v40, v45
    v_sub_f32 v41, v41, v45
    v_sub_f32 v42, v42, v45
    v_sub_f32 v43, v43, v45
    v_mul_f32 v44, s77, v44
    v_pk_mul_f32 v[40:41], v[40:41], s[36:37]
    v_pk_mul_f32 v[42:43], v[42:43], s[36:37]
    v_exp_f32 v44, v44
    v_exp_f32 v40, v40
    v_exp_f32 v41, v41
    v_exp_f32 v42, v42
    v_exp_f32 v43, v43
    v_mov_b32_dpp v46, v44 row_ror:8 row_mask:0xf bank_mask:0xf
    v_cvt_pk_bf16_f32 v48, v40, v41
    v_cvt_pk_bf16_f32 v49, v42, v43
    v_cvt_pk_bf16_f32 v52, v44, v46
    v_mov_b32_dpp v50, v48 row_ror:8 row_mask:0xf bank_mask:0xf
    v_mov_b32_dpp v51, v49 row_ror:8 row_mask:0xf bank_mask:0xf
    v_mfma_f32_16x16x16_bf16 v[60:63], v[64:65], v[52:53], 0
    v_mfma_f32_16x16x16_bf16 v[56:59], v[14:15], v[52:53], 0
    v_mfma_f32_16x16x32_bf16 v[60:63], v[64:67], v[48:51], v[60:63]
    v_mfma_f32_16x16x32_bf16 v[56:59], v[32:35], v[48:51], v[56:59]
    s_nop 6
    v_rcp_f32 v42, v60
    s_nop 0
    v_mov_b32 v43, v42
    v_pk_mul_f32 v[56:57], v[56:57], v[42:43]
    v_pk_mul_f32 v[58:59], v[58:59], v[42:43]
    v_cvt_pk_bf16_f32 v40, v56, v57
    v_cvt_pk_bf16_f32 v41, v58, v59
    v_min_u32 v40, -2, v40
    v_min_u32 v41, -2, v41
    buffer_store_dwordx2 v[40:41], v4, s[44:47], s72 offen
    v_mov_b32 v44, -1
    v_mov_b32 v45, -1
    v_mov_b32 v46, -1
    v_mov_b32 v47, -1
    v_mov_b32 v48, -1
    v_mov_b32 v49, -1
    v_mov_b32 v50, -1
    v_mov_b32 v51, -1
    v_mov_b32 v52, -1
    v_mov_b32 v53, -1
    v_mov_b32 v54, -1
    v_mov_b32 v55, -1
    v_mov_b32 v76, 0
    v_mov_b32 v77, 0
    v_mov_b32 v78, 0
    v_mov_b32 v79, 0
    v_add_u32 v36, s33, v7
    v_add_u32 v37, s34, v7
    v_add_u32 v38, s35, v7
    s_add_u32 s80, s7, s78
    s_sleep 2
    s_mov_b32 s76, 30000
    buffer_load_dwordx4 v[44:47], v5, s[44:47], s72 offen offset:0 sc1
    buffer_load_dwordx4 v[48:51], v5, s[44:47], s72 offen offset:1024 sc1
    buffer_load_dwordx4 v[52:55], v5, s[44:47], s72 offen offset:2048 sc1
    s_sleep 3
poll_410:
    buffer_load_dwordx4 v[44:47], v5, s[44:47], s72 offen offset:0 sc1
    buffer_load_dwordx4 v[48:51], v5, s[44:47], s72 offen offset:1024 sc1
    buffer_load_dwordx4 v[52:55], v5, s[44:47], s72 offen offset:2048 sc1
    s_sub_u32 s76, s76, 1
    s_cbranch_scc1 pd_411
    s_waitcnt vmcnt(3)
    v_max3_u32 v42, v44, v45, v46
    v_max3_u32 v42, v42, v47, v48
    v_max3_u32 v42, v42, v49, v50
    v_max3_u32 v42, v42, v51, v52
    v_max3_u32 v42, v42, v53, v54
    v_max_u32 v42, v42, v55
    v_cmp_eq_u32 vcc, -1, v42
    s_cbranch_vccnz poll_410
pd_411:
    ds_write_b128 v6, v[44:47] offset:0
    ds_write_b128 v6, v[48:51] offset:1024
    ds_write_b128 v6, v[52:55] offset:2048
    s_waitcnt lgkmcnt(0)
    s_barrier
    ds_read_b128 v[56:59], v36 offset:0
    ds_read_b128 v[60:63], v36 offset:1024
    ds_read_b128 v[64:67], v36 offset:2048
    ds_read_b128 v[68:71], v37 offset:0
    ds_read_b128 v[72:75], v37 offset:1024
    ds_read_b128 v[16:19], v37 offset:2048
    ds_read_b128 v[20:23], v38 offset:0
    ds_read_b128 v[24:27], v38 offset:1024
    ds_read_b128 v[32:35], v38 offset:2048
    v_smfmac_f32_16x16x64_bf16 v[76:79], v[44:47], v[80:87], v12
    v_smfmac_f32_16x16x64_bf16 v[76:79], v[48:51], v[88:95], v12
    v_smfmac_f32_16x16x64_bf16 v[76:79], v[52:55], v[96:103], v12
    s_waitcnt lgkmcnt(8)
    v_smfmac_f32_16x16x64_bf16 v[76:79], v[56:59], v[104:111], v12
    s_waitcnt lgkmcnt(7)
    v_smfmac_f32_16x16x64_bf16 v[76:79], v[60:63], v[112:119], v12
    s_waitcnt lgkmcnt(6)
    v_smfmac_f32_16x16x64_bf16 v[76:79], v[64:67], v[120:127], v12
    s_waitcnt lgkmcnt(5)
    v_smfmac_f32_16x16x64_bf16 v[76:79], v[68:71], v[128:135], v12
    s_waitcnt lgkmcnt(4)
    v_smfmac_f32_16x16x64_bf16 v[76:79], v[72:75], v[136:143], v12
    s_waitcnt lgkmcnt(3)
    v_smfmac_f32_16x16x64_bf16 v[76:79], v[16:19], v[144:151], v12
    s_waitcnt lgkmcnt(2)
    v_smfmac_f32_16x16x64_bf16 v[76:79], v[20:23], v[152:159], v12
    s_waitcnt lgkmcnt(1)
    v_smfmac_f32_16x16x64_bf16 v[76:79], v[24:27], v[160:167], v12
    s_waitcnt lgkmcnt(0)
    v_smfmac_f32_16x16x64_bf16 v[76:79], v[32:35], v[168:175], v12
    s_xor_b32 s87, s85, 1
    s_nop 6
    v_add_f32 v76, v76, v77
    v_add_f32 v78, v78, v79
    v_cvt_pk_bf16_f32 v76, v76, v78
    v_bfi_b32 v76, 1, s85, v76
    buffer_store_dword v76, v9, s[44:47], s80 offen sc1
    v_mov_b32 v16, s87
    v_mov_b32 v17, s87
    v_mov_b32 v18, s87
    v_mov_b32 v19, s87
    v_mov_b32 v20, s87
    v_mov_b32 v21, s87
    v_mov_b32 v22, s87
    v_mov_b32 v23, s87
    v_cndmask_b32 v72, 0, v31, s[64:65]
    v_cndmask_b32 v73, 0, v31, s[68:69]
    v_cndmask_b32 v74, 0, v31, s[70:71]
    v_cndmask_b32 v75, 0, v31, s[12:13]
    s_mul_i32 s74, s73, 98304
    s_add_u32 s79, s73, 2
    s_and_b32 s79, s79, 3
    s_lshl_b32 s79, s79, 14
    s_add_u32 s81, s73, 3
    s_and_b32 s81, s81, 3
    s_lshl_b32 s81, s81, 14
    v_mov_b32 v60, -1
    v_mov_b32 v61, -1
    s_cmp_ge_u32 s73, 52
    s_cbranch_scc1 ks_412
    s_and_b32 s74, s73, 7
    s_mul_i32 s74, s74, 98304
    buffer_store_dword v14, v13, s[44:47], s74 offen
ks_412:
    buffer_store_dwordx2 v[60:61], v4, s[44:47], s79 offen
    buffer_store_dwordx2 v[60:61], v11, s[44:47], s81 offen
    s_add_u32 s81, s73, 1
    s_and_b32 s81, s81, 3
    s_lshl_b32 s81, s81, 14
    s_cmp_lt_u32 s66, 2
    s_cbranch_scc0 xs_413
    s_sleep 4
    s_mov_b32 s76, 30000
    s_cmp_eq_u32 s85, 1
    s_cbranch_scc1 pt1_415
pt_416:
    buffer_load_dwordx4 v[16:19], v10, s[44:47], s80 offen offset:0 sc1
    buffer_load_dwordx4 v[20:23], v10, s[44:47], s80 offen offset:1024 sc1
    s_sub_u32 s76, s76, 1
    s_cbranch_scc1 ptd_414
    s_waitcnt vmcnt(2)
    v_or3_b32 v40, v16, v17, v18
    v_or3_b32 v40, v40, v19, v20
    v_or3_b32 v40, v40, v21, v22
    v_or3_b32 v40, v40, v23, v23
    v_and_b32 v40, 1, v40
    v_cmp_ne_u32 vcc, 0, v40
    s_cbranch_vccnz pt_416
    s_branch ptd_414
pt1_415:
pt_417:
    buffer_load_dwordx4 v[16:19], v10, s[44:47], s80 offen offset:0 sc1
    buffer_load_dwordx4 v[20:23], v10, s[44:47], s80 offen offset:1024 sc1
    s_sub_u32 s76, s76, 1
    s_cbranch_scc1 ptd_414
    s_waitcnt vmcnt(2)
    v_bitop3_b32 v40, v16, v17, v18 bitop3:0x80
    v_bitop3_b32 v40, v40, v19, v20 bitop3:0x80
    v_bitop3_b32 v40, v40, v21, v22 bitop3:0x80
    v_bitop3_b32 v40, v40, v23, v23 bitop3:0x80
    v_and_b32 v40, 1, v40
    v_cmp_ne_u32 vcc, 1, v40
    s_cbranch_vccnz pt_417
ptd_414:
    v_mfma_f32_16x16x32_bf16 v[64:67], v[72:75], v[16:19], 0
    v_mfma_f32_16x16x32_bf16 v[64:67], v[72:75], v[20:23], v[64:67]
    s_nop 7
    v_cvt_pk_bf16_f32 v40, v64, v65
    v_cvt_pk_bf16_f32 v41, v66, v67
    v_min_u32 v40, -2, v40
    v_min_u32 v41, -2, v41
    buffer_store_dwordx2 v[40:41], v11, s[44:47], s81 offen
    s_branch xs2_418
    .p2align 6
xs_413:
    s_waitcnt vmcnt(0)
xs2_418:
    s_barrier
    s_add_u32 s73, s73, 1
    s_cmp_eq_u32 s3, 7
    s_cbranch_scc0 fs_419
    v_mov_b32 v40, 0
    v_mov_b32 v41, s73
    buffer_store_dword v41, v40, s[44:47], s8 offen
fs_419:
    s_branch voloop_401
vodone_402:
    s_barrier
    s_mul_i32 s74, s73, 98304
    s_add_u32 s74, s74, 88080384
    v_min_u32 v14, -2, v14
    buffer_store_dword v14, v13, s[44:47], s74 offen sc1
    s_waitcnt vmcnt(0)
    s_barrier
    s_cmp_eq_u32 s3, 4
    s_cbranch_scc0 fs_420
    v_mov_b32 v40, 0
    v_mov_b32 v41, s84
    buffer_store_dword v41, v40, s[44:47], s8 offen
fs_420:
    s_endpgm
vo00_398:
voloop_421:
    v_mov_b32 v36, 0
    v_mov_b32 v37, 0
    v_mov_b32 v38, 0
    v_mov_b32 v39, 0
    s_and_b32 s72, s73, 3
    s_lshr_b32 s85, s72, 1
    s_lshl_b32 s72, s72, 14
    s_and_b32 s75, s73, 1
    s_mul_i32 s78, s75, 327680
    s_lshl_b32 s75, s75, 13
    s_lshl_b32 s74, s66, 10
    s_add_u32 s75, s75, s74
    v_add_u32 v32, s75, v7
    ds_read_b128 v[32:35], v32 offset:12800
    s_add_u32 s84, s73, 1
    s_add_u32 s38, s72, s28
    s_add_u32 s39, s72, s29
    s_lshr_b32 s74, s28, 2
    s_add_u32 s30, s72, s74
    s_lshr_b32 s74, s29, 2
    s_add_u32 s31, s72, s74
    s_waitcnt vmcnt(0)
    v_mov_b32 v16, -1
    v_mov_b32 v17, -1
    v_mov_b32 v18, -1
    v_mov_b32 v19, -1
    v_mov_b32 v20, -1
    v_mov_b32 v21, -1
    v_mov_b32 v22, -1
    v_mov_b32 v23, -1
    v_mov_b32 v24, -1
    v_mov_b32 v25, -1
    v_mov_b32 v26, -1
    v_mov_b32 v27, -1
    v_mov_b32 v28, -1
    v_mov_b32 v29, -1
    v_mov_b32 v30, -1
    s_barrier
    s_cmp_eq_u32 s73, 63
    s_cbranch_scc1 nopf_423
    s_mul_i32 s74, s84, 393216
    s_and_b32 s75, s84, 1
    s_lshl_b32 s75, s75, 13
    s_lshl_b32 s79, s66, 10
    s_add_u32 s75, s75, s79
    s_add_u32 s75, s75, 12800
    s_mov_b32 m0, s75
    s_add_u32 s79, s74, s82
    buffer_load_dwordx4 v7, s[44:47], s79 offen sc1 lds
    s_add_u32 s75, s75, 4096
    s_mov_b32 m0, s75
    s_add_u32 s79, s74, s83
    buffer_load_dwordx4 v7, s[44:47], s79 offen sc1 lds
nopf_423:
    ds_read_b128 v[40:43], v7 offset:0
    ds_read_b128 v[44:47], v7 offset:1024
    ds_read_b128 v[48:51], v7 offset:2048
    ds_read_b128 v[52:55], v7 offset:3072
    ds_read_b128 v[56:59], v7 offset:4096
    ds_read_b128 v[60:63], v7 offset:5120
    ds_read_b128 v[64:67], v7 offset:6144
    ds_read_b128 v[68:71], v7 offset:7168
    ds_read_b128 v[72:75], v7 offset:8192
    ds_read_b128 v[76:79], v7 offset:9216
    s_waitcnt lgkmcnt(0)
    s_barrier
    v_smfmac_f32_16x16x64_bf16 v[36:39], v[40:43], v[176:183], v12
    v_smfmac_f32_16x16x64_bf16 v[36:39], v[44:47], v[184:191], v12
    v_smfmac_f32_16x16x64_bf16 v[36:39], v[48:51], v[192:199], v12
    v_smfmac_f32_16x16x64_bf16 v[36:39], v[52:55], v[200:207], v12
    v_smfmac_f32_16x16x64_bf16 v[36:39], v[56:59], v[208:215], v12
    v_smfmac_f32_16x16x64_bf16 v[36:39], v[60:63], v[216:223], v12
    v_smfmac_f32_16x16x64_bf16 v[36:39], v[64:67], v[224:231], v12
    v_smfmac_f32_16x16x64_bf16 v[36:39], v[68:71], v[232:239], v12
    v_smfmac_f32_16x16x64_bf16 v[36:39], v[72:75], v[240:247], v12
    v_smfmac_f32_16x16x64_bf16 v[36:39], v[76:79], v[248:255], v12
    s_nop 7
    v_add_f32 v36, v36, v37
    v_add_f32 v38, v38, v39
    v_cvt_pk_bf16_f32 v14, v36, v38
    v_mov_b32 v64, 0x3f803f80
    v_mov_b32 v65, 0x3f803f80
    v_mov_b32 v66, 0x3f803f80
    v_mov_b32 v67, 0x3f803f80
    v_mov_b32 v53, 0
    s_cmp_eq_u32 s73, 63
    s_cbranch_scc1 vodone_422
    s_cmp_ge_u32 s73, 52
    s_cbranch_scc0 ks_424
    s_and_b32 s74, s73, 7
    s_mul_i32 s74, s74, 98304
    buffer_store_dword v14, v13, s[44:47], s74 offen
ks_424:
    s_mov_b32 s76, 30000
    buffer_load_dwordx4 v[16:19], v2, s[44:47], s38 offen sc1
    buffer_load_dwordx4 v[20:23], v2, s[44:47], s39 offen sc1
    buffer_load_dword v28, v3, s[44:47], s30 offen sc1
    buffer_load_dword v29, v3, s[44:47], s31 offen sc1
    s_barrier
    ds_read_b128 v[24:27], v8
    ds_read_b32 v30, v0
sp_425:
    buffer_load_dwordx4 v[16:19], v2, s[44:47], s38 offen sc1
    buffer_load_dwordx4 v[20:23], v2, s[44:47], s39 offen sc1
    buffer_load_dword v28, v3, s[44:47], s30 offen sc1
    buffer_load_dword v29, v3, s[44:47], s31 offen sc1
    s_sub_u32 s76, s76, 1
    s_cbranch_scc1 spd_426
    s_waitcnt vmcnt(4)
    v_max3_u32 v46, v16, v17, v18
    v_max3_u32 v46, v46, v19, v20
    v_max3_u32 v46, v46, v21, v22
    v_max3_u32 v46, v46, v23, v28
    v_max_u32 v46, v46, v29
    v_pk_add_f32 v[40:41], v[16:17], v[20:21]
    v_pk_add_f32 v[42:43], v[18:19], v[22:23]
    v_cmp_eq_u32 vcc, -1, v46
    s_cbranch_vccnz sp_425
spd_426:
    s_waitcnt lgkmcnt(0)
    v_add_f32 v44, v28, v29
    v_pk_add_f32 v[40:41], v[40:41], v[24:25]
    v_pk_add_f32 v[42:43], v[42:43], v[26:27]
    v_add_f32 v44, v44, v30
    v_max3_f32 v45, v40, v41, v42
    v_max3_f32 v45, v45, v43, v44
    s_nop 1
    v_max_f32_dpp v45, v45, v45 row_ror:8 row_mask:0xf bank_mask:0xf
    v_mov_b32 v46, v45
    s_nop 1
    v_permlane16_swap_b32 v45, v46
    v_max_f32 v45, v45, v46
    v_mov_b32 v46, v45
    s_nop 1
    v_permlane32_swap_b32 v45, v46
    v_max_f32 v45, v45, v46
    v_sub_f32 v44, v44, v45
    v_sub_f32 v40, v40, v45
    v_sub_f32 v41, v41, v45
    v_sub_f32 v42, v42, v45
    v_sub_f32 v43, v43, v45
    v_mul_f32 v44, s77, v44
    v_pk_mul_f32 v[40:41], v[40:41], s[36:37]
    v_pk_mul_f32 v[42:43], v[42:43], s[36:37]
    v_exp_f32 v44, v44
    v_exp_f32 v40, v40
    v_exp_f32 v41, v41
    v_exp_f32 v42, v42
    v_exp_f32 v43, v43
    v_mov_b32_dpp v46, v44 row_ror:8 row_mask:0xf bank_mask:0xf
    v_cvt_pk_bf16_f32 v48, v40, v41
    v_cvt_pk_bf16_f32 v49, v42, v43
    v_cvt_pk_bf16_f32 v52, v44, v46
    v_mov_b32_dpp v50, v48 row_ror:8 row_mask:0xf bank_mask:0xf
    v_mov_b32_dpp v51, v49 row_ror:8 row_mask:0xf bank_mask:0xf
    v_mfma_f32_16x16x16_bf16 v[60:63], v[64:65], v[52:53], 0
    v_mfma_f32_16x16x16_bf16 v[56:59], v[14:15], v[52:53], 0
    v_mfma_f32_16x16x32_bf16 v[60:63], v[64:67], v[48:51], v[60:63]
    v_mfma_f32_16x16x32_bf16 v[56:59], v[32:35], v[48:51], v[56:59]
    s_nop 6
    v_rcp_f32 v42, v60
    s_nop 0
    v_mov_b32 v43, v42
    v_pk_mul_f32 v[56:57], v[56:57], v[42:43]
    v_pk_mul_f32 v[58:59], v[58:59], v[42:43]
    v_cvt_pk_bf16_f32 v40, v56, v57
    v_cvt_pk_bf16_f32 v41, v58, v59
    v_min_u32 v40, -2, v40
    v_min_u32 v41, -2, v41
    buffer_store_dwordx2 v[40:41], v4, s[44:47], s72 offen
    s_mul_i32 s74, s73, 98304
    s_add_u32 s79, s73, 2
    s_and_b32 s79, s79, 3
    s_lshl_b32 s79, s79, 14
    s_add_u32 s81, s73, 3
    s_and_b32 s81, s81, 3
    s_lshl_b32 s81, s81, 14
    v_mov_b32 v56, -1
    v_mov_b32 v57, -1
    s_cmp_ge_u32 s73, 52
    s_cbranch_scc1 ks_427
    s_and_b32 s74, s73, 7
    s_mul_i32 s74, s74, 98304
    buffer_store_dword v14, v13, s[44:47], s74 offen
ks_427:
    buffer_store_dwordx2 v[56:57], v4, s[44:47], s79 offen
    s_barrier
    s_sleep 24
    s_waitcnt vmcnt(0)
    s_barrier
    s_add_u32 s73, s73, 1
    s_cmp_eq_u32 s3, 7
    s_cbranch_scc0 fs_428
    v_mov_b32 v40, 0
    v_mov_b32 v41, s73
    buffer_store_dword v41, v40, s[44:47], s8 offen
fs_428:
    s_branch voloop_421
vodone_422:
    s_barrier
    s_mul_i32 s74, s73, 98304
    s_add_u32 s74, s74, 88080384
    v_min_u32 v14, -2, v14
    buffer_store_dword v14, v13, s[44:47], s74 offen sc1
    s_waitcnt vmcnt(0)
    s_barrier
    s_cmp_eq_u32 s3, 4
    s_cbranch_scc0 fs_429
    v_mov_b32 v40, 0
    v_mov_b32 v41, s84
    buffer_store_dword v41, v40, s[44:47], s8 offen
fs_429:
    s_endpgm
vo11_399:
voloop_430:
    v_mov_b32 v36, 0
    v_mov_b32 v37, 0
    v_mov_b32 v38, 0
    v_mov_b32 v39, 0
    s_and_b32 s72, s73, 3
    s_lshr_b32 s85, s72, 1
    s_lshl_b32 s72, s72, 14
    s_and_b32 s75, s73, 1
    s_mul_i32 s78, s75, 327680
    s_lshl_b32 s75, s75, 13
    s_lshl_b32 s74, s66, 10
    s_add_u32 s75, s75, s74
    v_add_u32 v32, s75, v7
    ds_read_b128 v[32:35], v32 offset:12800
    s_add_u32 s84, s73, 1
    s_add_u32 s38, s72, s28
    s_add_u32 s39, s72, s29
    s_lshr_b32 s74, s28, 2
    s_add_u32 s30, s72, s74
    s_lshr_b32 s74, s29, 2
    s_add_u32 s31, s72, s74
    s_waitcnt vmcnt(0)
    v_mov_b32 v16, -1
    v_mov_b32 v17, -1
    v_mov_b32 v18, -1
    v_mov_b32 v19, -1
    v_mov_b32 v20, -1
    v_mov_b32 v21, -1
    v_mov_b32 v22, -1
    v_mov_b32 v23, -1
    v_mov_b32 v24, -1
    v_mov_b32 v25, -1
    v_mov_b32 v26, -1
    v_mov_b32 v27, -1
    v_mov_b32 v28, -1
    v_mov_b32 v29, -1
    v_mov_b32 v30, -1
    s_barrier
    s_cmp_eq_u32 s73, 63
    s_cbranch_scc1 nopf_432
    s_mul_i32 s74, s84, 393216
    s_and_b32 s75, s84, 1
    s_lshl_b32 s75, s75, 13
    s_lshl_b32 s79, s66, 10
    s_add_u32 s75, s75, s79
    s_add_u32 s75, s75, 12800
    s_mov_b32 m0, s75
    s_add_u32 s79, s74, s82
    buffer_load_dwordx4 v7, s[44:47], s79 offen sc1 lds
    s_add_u32 s75, s75, 4096
    s_mov_b32 m0, s75
    s_add_u32 s79, s74, s83
    buffer_load_dwordx4 v7, s[44:47], s79 offen sc1 lds
    s_cmp_eq_u32 s73, 12
    s_cbranch_scc0 cal_433
    v_mov_b32 v40, 0
    s_mov_b32 s76, 1000000
    s_mov_b32 s74, 0
call_434:
    buffer_load_dword v41, v40, s[56:59], s10 offen offset:136 sc1
    s_sub_u32 s76, s76, 1
    s_cbranch_scc1 cald_435
    s_waitcnt vmcnt(0)
    v_readfirstlane_b32 s74, v41
    s_cmp_lg_u32 s74, 0
    s_cbranch_scc1 cald_435
    s_sleep 32
    s_branch call_434
cald_435:
    s_lshr_b32 s74, s74, 1
    s_lshl_b32 s7, s74, 13
cal_433:
nopf_432:
    ds_read_b128 v[40:43], v7 offset:0
    ds_read_b128 v[44:47], v7 offset:1024
    ds_read_b128 v[48:51], v7 offset:2048
    ds_read_b128 v[52:55], v7 offset:3072
    ds_read_b128 v[56:59], v7 offset:4096
    ds_read_b128 v[60:63], v7 offset:5120
    ds_read_b128 v[64:67], v7 offset:6144
    ds_read_b128 v[68:71], v7 offset:7168
    ds_read_b128 v[72:75], v7 offset:8192
    ds_read_b128 v[76:79], v7 offset:9216
    s_waitcnt lgkmcnt(0)
    s_barrier
    v_smfmac_f32_16x16x64_bf16 v[36:39], v[40:43], v[176:183], v12
    v_smfmac_f32_16x16x64_bf16 v[36:39], v[44:47], v[184:191], v12
    v_smfmac_f32_16x16x64_bf16 v[36:39], v[48:51], v[192:199], v12
    v_smfmac_f32_16x16x64_bf16 v[36:39], v[52:55], v[200:207], v12
    v_smfmac_f32_16x16x64_bf16 v[36:39], v[56:59], v[208:215], v12
    v_smfmac_f32_16x16x64_bf16 v[36:39], v[60:63], v[216:223], v12
    v_smfmac_f32_16x16x64_bf16 v[36:39], v[64:67], v[224:231], v12
    v_smfmac_f32_16x16x64_bf16 v[36:39], v[68:71], v[232:239], v12
    v_smfmac_f32_16x16x64_bf16 v[36:39], v[72:75], v[240:247], v12
    v_smfmac_f32_16x16x64_bf16 v[36:39], v[76:79], v[248:255], v12
    s_nop 7
    v_add_f32 v36, v36, v37
    v_add_f32 v38, v38, v39
    v_cvt_pk_bf16_f32 v14, v36, v38
    v_mov_b32 v64, 0x3f803f80
    v_mov_b32 v65, 0x3f803f80
    v_mov_b32 v66, 0x3f803f80
    v_mov_b32 v67, 0x3f803f80
    v_mov_b32 v53, 0
    s_cmp_eq_u32 s73, 63
    s_cbranch_scc1 vodone_431
    s_cmp_ge_u32 s73, 52
    s_cbranch_scc0 ks_436
    s_and_b32 s74, s73, 7
    s_mul_i32 s74, s74, 98304
    buffer_store_dword v14, v13, s[44:47], s74 offen sc1
ks_436:
    s_mov_b32 s76, 30000
    buffer_load_dwordx4 v[16:19], v2, s[44:47], s38 offen sc1
    buffer_load_dwordx4 v[20:23], v2, s[44:47], s39 offen sc1
    buffer_load_dword v28, v3, s[44:47], s30 offen sc1
    buffer_load_dword v29, v3, s[44:47], s31 offen sc1
    s_barrier
    ds_read_b128 v[24:27], v8
    ds_read_b32 v30, v0
sp_437:
    buffer_load_dwordx4 v[16:19], v2, s[44:47], s38 offen sc1
    buffer_load_dwordx4 v[20:23], v2, s[44:47], s39 offen sc1
    buffer_load_dword v28, v3, s[44:47], s30 offen sc1
    buffer_load_dword v29, v3, s[44:47], s31 offen sc1
    s_sub_u32 s76, s76, 1
    s_cbranch_scc1 spd_438
    s_waitcnt vmcnt(4)
    v_max3_u32 v46, v16, v17, v18
    v_max3_u32 v46, v46, v19, v20
    v_max3_u32 v46, v46, v21, v22
    v_max3_u32 v46, v46, v23, v28
    v_max_u32 v46, v46, v29
    v_pk_add_f32 v[40:41], v[16:17], v[20:21]
    v_pk_add_f32 v[42:43], v[18:19], v[22:23]
    v_cmp_eq_u32 vcc, -1, v46
    s_cbranch_vccnz sp_437
spd_438:
    s_waitcnt lgkmcnt(0)
    v_add_f32 v44, v28, v29
    v_pk_add_f32 v[40:41], v[40:41], v[24:25]
    v_pk_add_f32 v[42:43], v[42:43], v[26:27]
    v_add_f32 v44, v44, v30
    v_max3_f32 v45, v40, v41, v42
    v_max3_f32 v45, v45, v43, v44
    s_nop 1
    v_max_f32_dpp v45, v45, v45 row_ror:8 row_mask:0xf bank_mask:0xf
    v_mov_b32 v46, v45
    s_nop 1
    v_permlane16_swap_b32 v45, v46
    v_max_f32 v45, v45, v46
    v_mov_b32 v46, v45
    s_nop 1
    v_permlane32_swap_b32 v45, v46
    v_max_f32 v45, v45, v46
    v_sub_f32 v44, v44, v45
    v_sub_f32 v40, v40, v45
    v_sub_f32 v41, v41, v45
    v_sub_f32 v42, v42, v45
    v_sub_f32 v43, v43, v45
    v_mul_f32 v44, s77, v44
    v_pk_mul_f32 v[40:41], v[40:41], s[36:37]
    v_pk_mul_f32 v[42:43], v[42:43], s[36:37]
    v_exp_f32 v44, v44
    v_exp_f32 v40, v40
    v_exp_f32 v41, v41
    v_exp_f32 v42, v42
    v_exp_f32 v43, v43
    v_mov_b32_dpp v46, v44 row_ror:8 row_mask:0xf bank_mask:0xf
    v_cvt_pk_bf16_f32 v48, v40, v41
    v_cvt_pk_bf16_f32 v49, v42, v43
    v_cvt_pk_bf16_f32 v52, v44, v46
    v_mov_b32_dpp v50, v48 row_ror:8 row_mask:0xf bank_mask:0xf
    v_mov_b32_dpp v51, v49 row_ror:8 row_mask:0xf bank_mask:0xf
    v_mfma_f32_16x16x16_bf16 v[60:63], v[64:65], v[52:53], 0
    v_mfma_f32_16x16x16_bf16 v[56:59], v[14:15], v[52:53], 0
    v_mfma_f32_16x16x32_bf16 v[60:63], v[64:67], v[48:51], v[60:63]
    v_mfma_f32_16x16x32_bf16 v[56:59], v[32:35], v[48:51], v[56:59]
    s_nop 6
    v_rcp_f32 v42, v60
    s_nop 0
    v_mov_b32 v43, v42
    v_pk_mul_f32 v[56:57], v[56:57], v[42:43]
    v_pk_mul_f32 v[58:59], v[58:59], v[42:43]
    v_cvt_pk_bf16_f32 v40, v56, v57
    v_cvt_pk_bf16_f32 v41, v58, v59
    v_min_u32 v40, -2, v40
    v_min_u32 v41, -2, v41
    buffer_store_dwordx2 v[40:41], v4, s[44:47], s72 offen sc1
    v_mov_b32 v44, -1
    v_mov_b32 v45, -1
    v_mov_b32 v46, -1
    v_mov_b32 v47, -1
    v_mov_b32 v48, -1
    v_mov_b32 v49, -1
    v_mov_b32 v50, -1
    v_mov_b32 v51, -1
    v_mov_b32 v52, -1
    v_mov_b32 v53, -1
    v_mov_b32 v54, -1
    v_mov_b32 v55, -1
    v_mov_b32 v76, 0
    v_mov_b32 v77, 0
    v_mov_b32 v78, 0
    v_mov_b32 v79, 0
    v_add_u32 v36, s33, v7
    v_add_u32 v37, s34, v7
    v_add_u32 v38, s35, v7
    s_add_u32 s80, s7, s78
    s_sleep 2
    s_mov_b32 s76, 30000
    buffer_load_dwordx4 v[44:47], v5, s[44:47], s72 offen offset:0 sc1
    buffer_load_dwordx4 v[48:51], v5, s[44:47], s72 offen offset:1024 sc1
    buffer_load_dwordx4 v[52:55], v5, s[44:47], s72 offen offset:2048 sc1
    s_sleep 3
poll_439:
    buffer_load_dwordx4 v[44:47], v5, s[44:47], s72 offen offset:0 sc1
    buffer_load_dwordx4 v[48:51], v5, s[44:47], s72 offen offset:1024 sc1
    buffer_load_dwordx4 v[52:55], v5, s[44:47], s72 offen offset:2048 sc1
    s_sub_u32 s76, s76, 1
    s_cbranch_scc1 pd_440
    s_waitcnt vmcnt(3)
    v_max3_u32 v42, v44, v45, v46
    v_max3_u32 v42, v42, v47, v48
    v_max3_u32 v42, v42, v49, v50
    v_max3_u32 v42, v42, v51, v52
    v_max3_u32 v42, v42, v53, v54
    v_max_u32 v42, v42, v55
    v_cmp_eq_u32 vcc, -1, v42
    s_cbranch_vccnz poll_439
pd_440:
    ds_write_b128 v6, v[44:47] offset:0
    ds_write_b128 v6, v[48:51] offset:1024
    ds_write_b128 v6, v[52:55] offset:2048
    s_waitcnt lgkmcnt(0)
    s_barrier
    ds_read_b128 v[56:59], v36 offset:0
    ds_read_b128 v[60:63], v36 offset:1024
    ds_read_b128 v[64:67], v36 offset:2048
    ds_read_b128 v[68:71], v37 offset:0
    ds_read_b128 v[72:75], v37 offset:1024
    ds_read_b128 v[16:19], v37 offset:2048
    ds_read_b128 v[20:23], v38 offset:0
    ds_read_b128 v[24:27], v38 offset:1024
    ds_read_b128 v[32:35], v38 offset:2048
    v_smfmac_f32_16x16x64_bf16 v[76:79], v[44:47], v[80:87], v12
    v_smfmac_f32_16x16x64_bf16 v[76:79], v[48:51], v[88:95], v12
    v_smfmac_f32_16x16x64_bf16 v[76:79], v[52:55], v[96:103], v12
    s_waitcnt lgkmcnt(8)
    v_smfmac_f32_16x16x64_bf16 v[76:79], v[56:59], v[104:111], v12
    s_waitcnt lgkmcnt(7)
    v_smfmac_f32_16x16x64_bf16 v[76:79], v[60:63], v[112:119], v12
    s_waitcnt lgkmcnt(6)
    v_smfmac_f32_16x16x64_bf16 v[76:79], v[64:67], v[120:127], v12
    s_waitcnt lgkmcnt(5)
    v_smfmac_f32_16x16x64_bf16 v[76:79], v[68:71], v[128:135], v12
    s_waitcnt lgkmcnt(4)
    v_smfmac_f32_16x16x64_bf16 v[76:79], v[72:75], v[136:143], v12
    s_waitcnt lgkmcnt(3)
    v_smfmac_f32_16x16x64_bf16 v[76:79], v[16:19], v[144:151], v12
    s_waitcnt lgkmcnt(2)
    v_smfmac_f32_16x16x64_bf16 v[76:79], v[20:23], v[152:159], v12
    s_waitcnt lgkmcnt(1)
    v_smfmac_f32_16x16x64_bf16 v[76:79], v[24:27], v[160:167], v12
    s_waitcnt lgkmcnt(0)
    v_smfmac_f32_16x16x64_bf16 v[76:79], v[32:35], v[168:175], v12
    s_xor_b32 s87, s85, 1
    s_nop 6
    v_add_f32 v76, v76, v77
    v_add_f32 v78, v78, v79
    v_cvt_pk_bf16_f32 v76, v76, v78
    v_bfi_b32 v76, 1, s85, v76
    buffer_store_dword v76, v9, s[44:47], s80 offen sc1
    v_mov_b32 v16, s87
    v_mov_b32 v17, s87
    v_mov_b32 v18, s87
    v_mov_b32 v19, s87
    v_mov_b32 v20, s87
    v_mov_b32 v21, s87
    v_mov_b32 v22, s87
    v_mov_b32 v23, s87
    v_cndmask_b32 v72, 0, v31, s[64:65]
    v_cndmask_b32 v73, 0, v31, s[68:69]
    v_cndmask_b32 v74, 0, v31, s[70:71]
    v_cndmask_b32 v75, 0, v31, s[12:13]
    s_mul_i32 s74, s73, 98304
    s_add_u32 s79, s73, 2
    s_and_b32 s79, s79, 3
    s_lshl_b32 s79, s79, 14
    s_add_u32 s81, s73, 3
    s_and_b32 s81, s81, 3
    s_lshl_b32 s81, s81, 14
    v_mov_b32 v60, -1
    v_mov_b32 v61, -1
    s_cmp_ge_u32 s73, 52
    s_cbranch_scc1 ks_441
    s_and_b32 s74, s73, 7
    s_mul_i32 s74, s74, 98304
    buffer_store_dword v14, v13, s[44:47], s74 offen sc1
ks_441:
    buffer_store_dwordx2 v[60:61], v4, s[44:47], s79 offen sc1
    buffer_store_dwordx2 v[60:61], v11, s[44:47], s81 offen sc1
    s_add_u32 s81, s73, 1
    s_and_b32 s81, s81, 3
    s_lshl_b32 s81, s81, 14
    s_cmp_lt_u32 s66, 2
    s_cbranch_scc0 xs_442
    s_sleep 4
    s_mov_b32 s76, 30000
    s_cmp_eq_u32 s85, 1
    s_cbranch_scc1 pt1_444
pt_445:
    buffer_load_dwordx4 v[16:19], v10, s[44:47], s80 offen offset:0 sc1
    buffer_load_dwordx4 v[20:23], v10, s[44:47], s80 offen offset:1024 sc1
    s_sub_u32 s76, s76, 1
    s_cbranch_scc1 ptd_443
    s_waitcnt vmcnt(2)
    v_or3_b32 v40, v16, v17, v18
    v_or3_b32 v40, v40, v19, v20
    v_or3_b32 v40, v40, v21, v22
    v_or3_b32 v40, v40, v23, v23
    v_and_b32 v40, 1, v40
    v_cmp_ne_u32 vcc, 0, v40
    s_cbranch_vccnz pt_445
    s_branch ptd_443
pt1_444:
pt_446:
    buffer_load_dwordx4 v[16:19], v10, s[44:47], s80 offen offset:0 sc1
    buffer_load_dwordx4 v[20:23], v10, s[44:47], s80 offen offset:1024 sc1
    s_sub_u32 s76, s76, 1
    s_cbranch_scc1 ptd_443
    s_waitcnt vmcnt(2)
    v_bitop3_b32 v40, v16, v17, v18 bitop3:0x80
    v_bitop3_b32 v40, v40, v19, v20 bitop3:0x80
    v_bitop3_b32 v40, v40, v21, v22 bitop3:0x80
    v_bitop3_b32 v40, v40, v23, v23 bitop3:0x80
    v_and_b32 v40, 1, v40
    v_cmp_ne_u32 vcc, 1, v40
    s_cbranch_vccnz pt_446
ptd_443:
    v_mfma_f32_16x16x32_bf16 v[64:67], v[72:75], v[16:19], 0
    v_mfma_f32_16x16x32_bf16 v[64:67], v[72:75], v[20:23], v[64:67]
    s_nop 7
    v_cvt_pk_bf16_f32 v40, v64, v65
    v_cvt_pk_bf16_f32 v41, v66, v67
    v_min_u32 v40, -2, v40
    v_min_u32 v41, -2, v41
    buffer_store_dwordx2 v[40:41], v11, s[44:47], s81 offen sc1
    s_branch xs2_447
    .p2align 6
xs_442:
    s_waitcnt vmcnt(0)
xs2_447:
    s_barrier
    s_add_u32 s73, s73, 1
    s_cmp_eq_u32 s3, 7
    s_cbranch_scc0 fs_448
    v_mov_b32 v40, 0
    v_mov_b32 v41, s73
    buffer_store_dword v41, v40, s[44:47], s8 offen sc1
fs_448:
    s_branch voloop_430
vodone_431:
    s_barrier
    s_mul_i32 s74, s73, 98304
    s_add_u32 s74, s74, 88080384
    v_min_u32 v14, -2, v14
    buffer_store_dword v14, v13, s[44:47], s74 offen sc1
    s_waitcnt vmcnt(0)
    s_barrier
    s_cmp_eq_u32 s3, 4
    s_cbranch_scc0 fs_449
    v_mov_b32 v40, 0
    v_mov_b32 v41, s84
    buffer_store_dword v41, v40, s[44:47], s8 offen sc1
fs_449:
    s_endpgm
vo10_400:
voloop_450:
    v_mov_b32 v36, 0
    v_mov_b32 v37, 0
    v_mov_b32 v38, 0
    v_mov_b32 v39, 0
    s_and_b32 s72, s73, 3
    s_lshr_b32 s85, s72, 1
    s_lshl_b32 s72, s72, 14
    s_and_b32 s75, s73, 1
    s_mul_i32 s78, s75, 327680
    s_lshl_b32 s75, s75, 13
    s_lshl_b32 s74, s66, 10
    s_add_u32 s75, s75, s74
    v_add_u32 v32, s75, v7
    ds_read_b128 v[32:35], v32 offset:12800
    s_add_u32 s84, s73, 1
    s_add_u32 s38, s72, s28
    s_add_u32 s39, s72, s29
    s_lshr_b32 s74, s28, 2
    s_add_u32 s30, s72, s74
    s_lshr_b32 s74, s29, 2
    s_add_u32 s31, s72, s74
    s_waitcnt vmcnt(0)
    v_mov_b32 v16, -1
    v_mov_b32 v17, -1
    v_mov_b32 v18, -1
    v_mov_b32 v19, -1
    v_mov_b32 v20, -1
    v_mov_b32 v21, -1
    v_mov_b32 v22, -1
    v_mov_b32 v23, -1
    v_mov_b32 v24, -1
    v_mov_b32 v25, -1
    v_mov_b32 v26, -1
    v_mov_b32 v27, -1
    v_mov_b32 v28, -1
    v_mov_b32 v29, -1
    v_mov_b32 v30, -1
    s_barrier
    s_cmp_eq_u32 s73, 63
    s_cbranch_scc1 nopf_452
    s_mul_i32 s74, s84, 393216
    s_and_b32 s75, s84, 1
    s_lshl_b32 s75, s75, 13
    s_lshl_b32 s79, s66, 10
    s_add_u32 s75, s75, s79
    s_add_u32 s75, s75, 12800
    s_mov_b32 m0, s75
    s_add_u32 s79, s74, s82
    buffer_load_dwordx4 v7, s[44:47], s79 offen sc1 lds
    s_add_u32 s75, s75, 4096
    s_mov_b32 m0, s75
    s_add_u32 s79, s74, s83
    buffer_load_dwordx4 v7, s[44:47], s79 offen sc1 lds
nopf_452:
    ds_read_b128 v[40:43], v7 offset:0
    ds_read_b128 v[44:47], v7 offset:1024
    ds_read_b128 v[48:51], v7 offset:2048
    ds_read_b128 v[52:55], v7 offset:3072
    ds_read_b128 v[56:59], v7 offset:4096
    ds_read_b128 v[60:63], v7 offset:5120
    ds_read_b128 v[64:67], v7 offset:6144
    ds_read_b128 v[68:71], v7 offset:7168
    ds_read_b128 v[72:75], v7 offset:8192
    ds_read_b128 v[76:79], v7 offset:9216
    s_waitcnt lgkmcnt(0)
    s_barrier
    v_smfmac_f32_16x16x64_bf16 v[36:39], v[40:43], v[176:183], v12
    v_smfmac_f32_16x16x64_bf16 v[36:39], v[44:47], v[184:191], v12
    v_smfmac_f32_16x16x64_bf16 v[36:39], v[48:51], v[192:199], v12
    v_smfmac_f32_16x16x64_bf16 v[36:39], v[52:55], v[200:207], v12
    v_smfmac_f32_16x16x64_bf16 v[36:39], v[56:59], v[208:215], v12
    v_smfmac_f32_16x16x64_bf16 v[36:39], v[60:63], v[216:223], v12
    v_smfmac_f32_16x16x64_bf16 v[36:39], v[64:67], v[224:231], v12
    v_smfmac_f32_16x16x64_bf16 v[36:39], v[68:71], v[232:239], v12
    v_smfmac_f32_16x16x64_bf16 v[36:39], v[72:75], v[240:247], v12
    v_smfmac_f32_16x16x64_bf16 v[36:39], v[76:79], v[248:255], v12
    s_nop 7
    v_add_f32 v36, v36, v37
    v_add_f32 v38, v38, v39
    v_cvt_pk_bf16_f32 v14, v36, v38
    v_mov_b32 v64, 0x3f803f80
    v_mov_b32 v65, 0x3f803f80
    v_mov_b32 v66, 0x3f803f80
    v_mov_b32 v67, 0x3f803f80
    v_mov_b32 v53, 0
    s_cmp_eq_u32 s73, 63
    s_cbranch_scc1 vodone_451
    s_cmp_ge_u32 s73, 52
    s_cbranch_scc0 ks_453
    s_and_b32 s74, s73, 7
    s_mul_i32 s74, s74, 98304
    buffer_store_dword v14, v13, s[44:47], s74 offen sc1
ks_453:
    s_mov_b32 s76, 30000
    buffer_load_dwordx4 v[16:19], v2, s[44:47], s38 offen sc1
    buffer_load_dwordx4 v[20:23], v2, s[44:47], s39 offen sc1
    buffer_load_dword v28, v3, s[44:47], s30 offen sc1
    buffer_load_dword v29, v3, s[44:47], s31 offen sc1
    s_barrier
    ds_read_b128 v[24:27], v8
    ds_read_b32 v30, v0
sp_454:
    buffer_load_dwordx4 v[16:19], v2, s[44:47], s38 offen sc1
    buffer_load_dwordx4 v[20:23], v2, s[44:47], s39 offen sc1
    buffer_load_dword v28, v3, s[44:47], s30 offen sc1
    buffer_load_dword v29, v3, s[44:47], s31 offen sc1
    s_sub_u32 s76, s76, 1
    s_cbranch_scc1 spd_455
    s_waitcnt vmcnt(4)
    v_max3_u32 v46, v16, v17, v18
    v_max3_u32 v46, v46, v19, v20
    v_max3_u32 v46, v46, v21, v22
    v_max3_u32 v46, v46, v23, v28
    v_max_u32 v46, v46, v29
    v_pk_add_f32 v[40:41], v[16:17], v[20:21]
    v_pk_add_f32 v[42:43], v[18:19], v[22:23]
    v_cmp_eq_u32 vcc, -1, v46
    s_cbranch_vccnz sp_454
spd_455:
    s_waitcnt lgkmcnt(0)
    v_add_f32 v44, v28, v29
    v_pk_add_f32 v[40:41], v[40:41], v[24:25]
    v_pk_add_f32 v[42:43], v[42:43], v[26:27]
    v_add_f32 v44, v44, v30
    v_max3_f32 v45, v40, v41, v42
    v_max3_f32 v45, v45, v43, v44
    s_nop 1
    v_max_f32_dpp v45, v45, v45 row_ror:8 row_mask:0xf bank_mask:0xf
    v_mov_b32 v46, v45
    s_nop 1
    v_permlane16_swap_b32 v45, v46
    v_max_f32 v45, v45, v46
    v_mov_b32 v46, v45
    s_nop 1
    v_permlane32_swap_b32 v45, v46
    v_max_f32 v45, v45, v46
    v_sub_f32 v44, v44, v45
    v_sub_f32 v40, v40, v45
    v_sub_f32 v41, v41, v45
    v_sub_f32 v42, v42, v45
    v_sub_f32 v43, v43, v45
    v_mul_f32 v44, s77, v44
    v_pk_mul_f32 v[40:41], v[40:41], s[36:37]
    v_pk_mul_f32 v[42:43], v[42:43], s[36:37]
    v_exp_f32 v44, v44
    v_exp_f32 v40, v40
    v_exp_f32 v41, v41
    v_exp_f32 v42, v42
    v_exp_f32 v43, v43
    v_mov_b32_dpp v46, v44 row_ror:8 row_mask:0xf bank_mask:0xf
    v_cvt_pk_bf16_f32 v48, v40, v41
    v_cvt_pk_bf16_f32 v49, v42, v43
    v_cvt_pk_bf16_f32 v52, v44, v46
    v_mov_b32_dpp v50, v48 row_ror:8 row_mask:0xf bank_mask:0xf
    v_mov_b32_dpp v51, v49 row_ror:8 row_mask:0xf bank_mask:0xf
    v_mfma_f32_16x16x16_bf16 v[60:63], v[64:65], v[52:53], 0
    v_mfma_f32_16x16x16_bf16 v[56:59], v[14:15], v[52:53], 0
    v_mfma_f32_16x16x32_bf16 v[60:63], v[64:67], v[48:51], v[60:63]
    v_mfma_f32_16x16x32_bf16 v[56:59], v[32:35], v[48:51], v[56:59]
    s_nop 6
    v_rcp_f32 v42, v60
    s_nop 0
    v_mov_b32 v43, v42
    v_pk_mul_f32 v[56:57], v[56:57], v[42:43]
    v_pk_mul_f32 v[58:59], v[58:59], v[42:43]
    v_cvt_pk_bf16_f32 v40, v56, v57
    v_cvt_pk_bf16_f32 v41, v58, v59
    v_min_u32 v40, -2, v40
    v_min_u32 v41, -2, v41
    buffer_store_dwordx2 v[40:41], v4, s[44:47], s72 offen sc1
    s_mul_i32 s74, s73, 98304
    s_add_u32 s79, s73, 2
    s_and_b32 s79, s79, 3
    s_lshl_b32 s79, s79, 14
    s_add_u32 s81, s73, 3
    s_and_b32 s81, s81, 3
    s_lshl_b32 s81, s81, 14
    v_mov_b32 v56, -1
    v_mov_b32 v57, -1
    s_cmp_ge_u32 s73, 52
    s_cbranch_scc1 ks_456
    s_and_b32 s74, s73, 7
    s_mul_i32 s74, s74, 98304
    buffer_store_dword v14, v13, s[44:47], s74 offen sc1
ks_456:
    buffer_store_dwordx2 v[56:57], v4, s[44:47], s79 offen sc1
    s_barrier
    s_sleep 24
    s_waitcnt vmcnt(0)
    s_barrier
    s_add_u32 s73, s73, 1
    s_cmp_eq_u32 s3, 7
    s_cbranch_scc0 fs_457
    v_mov_b32 v40, 0
    v_mov_b32 v41, s73
    buffer_store_dword v41, v40, s[44:47], s8 offen sc1
fs_457:
    s_branch voloop_450
vodone_451:
    s_barrier
    s_mul_i32 s74, s73, 98304
    s_add_u32 s74, s74, 88080384
    v_min_u32 v14, -2, v14
    buffer_store_dword v14, v13, s[44:47], s74 offen sc1
    s_waitcnt vmcnt(0)
    s_barrier
    s_cmp_eq_u32 s3, 4
    s_cbranch_scc0 fs_458
    v_mov_b32 v40, 0
    v_mov_b32 v41, s84
    buffer_store_dword v41, v40, s[44:47], s8 offen sc1
fs_458:
    s_endpgm
L_text_end:

.section .rodata,"a"
.p2align 6
.amdhsa_kernel recurrent_scan__memory_aug_recurrent_mem_tr__glu_gated_bilinear__prompt_kernel
  .amdhsa_next_free_vgpr 256
  .amdhsa_next_free_sgpr 102
  .amdhsa_accum_offset 256
  .amdhsa_group_segment_fixed_size 0
  .amdhsa_kernarg_size 112
  .amdhsa_user_sgpr_count 2
  .amdhsa_user_sgpr_kernarg_segment_ptr 1
  .amdhsa_system_sgpr_workgroup_id_x 1
.end_amdhsa_kernel
```
